```python
import torch

def _softmax(x, axis=-1):
    return torch.softmax(x, dim=axis)
def _gelu(x):
    return torch.nn.functional.gelu(x, approximate="tanh")
def _silu(x):
    return torch.nn.functional.silu(x)
def _sigmoid(x):
    return torch.sigmoid(x)
def _layernorm(x, axis=-1, eps=1e-5):
    m = x.mean(dim=axis, keepdim=True)
    v = x.var(dim=axis, keepdim=True, unbiased=False)
    return (x - m) / torch.sqrt(v + eps)
def _scatter_add(tgt, idx, src, axis=0):
    return tgt.clone().index_add_(axis, idx, src)
def _segment_sum(src, seg, n):
    out = torch.zeros((n,) + src.shape[1:], dtype=src.dtype)
    return out.index_add_(0, seg, src)
def _pad(x, pw):
    flat = tuple(v for pair in reversed(pw) for v in pair)
    return torch.nn.functional.pad(x, flat)

kernel_name = 'gated_mix__sliding_block__moe_arch_mod__prompt'

def setup_inputs():

    _w = (lambda a: (lambda t: t.to(torch.bfloat16) if t.is_floating_point() else t)(torch.as_tensor(a)))
    def _A_setup():
        B, S, D = 1, 2048, 640
        return {
            "x": _w((lambda *s: torch.randn(*s, dtype=torch.bfloat16) * 0.05)(B, S, D)),
            "wqkv": _w((lambda *s: torch.randn(*s, dtype=torch.bfloat16) * 1.6)(D, 3 * D)),
            "wo": _w((lambda *s: torch.randn(*s, dtype=torch.bfloat16) * 0.05)(D, D)),
        }
    _A_in = _A_setup()

    def _B_setup():
        B, S, D, F, C = 1, 2048, 640, 1536, 8
        return {
            "x": _w((lambda *s: torch.randn(*s, dtype=torch.bfloat16) * 0.05)(B, S, D)),
            "w_r": _w((lambda *s: torch.randn(*s, dtype=torch.bfloat16) * 3.2)(D)),
            "w_gate": _w((lambda *s: torch.randn(*s, dtype=torch.bfloat16) * 0.4)(D, F)),
            "w_up": _w((lambda *s: torch.randn(*s, dtype=torch.bfloat16) * 0.4)(D, F)),
            "w_down": _w((lambda *s: torch.randn(*s, dtype=torch.bfloat16) * 0.4)(F, D)),
        }
    _B_in = _B_setup()

    return {
        "A_x": _A_in["x"],
        "A_wqkv": _A_in["wqkv"],
        "A_wo": _A_in["wo"],
        "B_x": _B_in["x"],
        "B_w_r": _B_in["w_r"],
        "B_w_gate": _B_in["w_gate"],
        "B_w_up": _B_in["w_up"],
        "B_w_down": _B_in["w_down"],
        "gate_w": _w((lambda *s: torch.randn(*s, dtype=torch.bfloat16) * 0.05)(640) * 16.0),
    }

def reference(A_x, A_wqkv, A_wo, B_x, B_w_r, B_w_gate, B_w_up, B_w_down, gate_w):
    def _A_ref(x, wqkv, wo):
        B, S, D = x.shape
        H = 32; Dh = D // H; W = 256
        qkv = (lambda x, *d: x.permute(*d))((x @ wqkv).reshape(B, S, 3, H, Dh), 2, 0, 3, 1, 4)
        q, k, v = qkv[0], qkv[1], qkv[2]
        scores = torch.einsum("bhqd,bhkd->bhqk", q, k) * (Dh ** -0.5)
        idx = torch.arange(S)
        mask = (idx[:, None] - idx[None, :] >= 0) & (idx[:, None] - idx[None, :] < W)
        scores = torch.where(mask[None, None], scores, -1e9)
        p = _softmax(scores, axis=-1)
        o = torch.einsum("bhqk,bhkd->bhqd", p, v)
        return (lambda x, *d: x.permute(*d))(o, 0, 2, 1, 3).reshape(B, S, D) @ wo

    def _B_ref(x, w_r, w_gate, w_up, w_down):
        B, S, D = x.shape
        C = 8
        r = x @ w_r
        idx = torch.argsort(-r, axis=-1)[:, :C]
        idx_e = (lambda x, n, axis: torch.repeat_interleave(x, n, dim=axis))(idx.reshape(B, C, 1), D, axis=2)
        x_sel = (lambda x, i, axis: torch.take_along_dim(x, i, dim=axis))(x, idx_e, axis=1)
        g = _silu(x_sel @ w_gate)
        u = x_sel @ w_up
        y = (g * u) @ w_down
        r_sel = _sigmoid((lambda x, i, axis: torch.take_along_dim(x, i, dim=axis))(r, idx, axis=1))
        y = y * r_sel.reshape(B, C, 1)
        b_off = (torch.arange(B) * S).reshape(B, 1)
        flat_idx = (idx + b_off).reshape(B * C)
        zero = (x * 0.0).reshape(B * S, D)
        upd = _scatter_add(zero, flat_idx, y.reshape(B * C, D), axis=0)
        return x + upd.reshape(B, S, D)

    x = A_x
    g = _sigmoid((x * gate_w).sum(-1, keepdims=True))
    a = _A_ref(x, A_wqkv, A_wo)
    b = _B_ref(x, B_w_r, B_w_gate, B_w_up, B_w_down)
    return g * a + (1 - g) * b
```

```asm
; @launch kernel=gated_mix__sliding_block__moe_arch_mod__prompt_kernel grid=(256,1,1) block=(768,1,1) lds=163840
.amdgcn_target "amdgcn-amd-amdhsa--gfx950"
.text
.globl gated_mix__sliding_block__moe_arch_mod__prompt_kernel
.p2align 8
.type gated_mix__sliding_block__moe_arch_mod__prompt_kernel,@function
gated_mix__sliding_block__moe_arch_mod__prompt_kernel:
    s_cmp_ge_u32 s2, 256
    s_cbranch_scc1 .bc_end
    s_load_dwordx4 s[4:7], s[0:1], 0
    s_load_dwordx2 s[8:9], s[0:1], 88
    v_lshrrev_b32 v1, 6, v0
    v_and_b32 v2, 63, v0
    s_and_b32 s24, s2, 7
    v_readfirstlane_b32 s3, v1
    s_lshr_b32 s25, s2, 3
    s_lshr_b32 s26, s24, 1
    s_lshl_b32 s26, s26, 2
    s_and_b32 s27, s25, 3
    s_add_u32 s26, s26, s27
    s_and_b32 s27, s24, 1
    s_mulk_i32 s27, 6
    s_lshr_b32 s28, s25, 2
    s_add_u32 s27, s27, s28
    s_add_u32 s36, s26, s27
    s_mov_b32 s22, 268435456
    s_mov_b32 s23, 0x20000
    s_cmp_ge_u32 s3, 8
    s_cbranch_scc1 .a_aux
    s_cmp_ge_u32 s25, 24
    s_cbranch_scc1 .a_free
    s_cmp_lt_u32 s3, 4
    s_cbranch_scc1 .a_compute
    s_sub_u32 s29, s3, 4
    s_lshl_b32 s30, s26, 7
    s_lshl_b32 s31, s29, 5
    s_add_u32 s30, s30, s31
    s_mulk_i32 s30, 1280
    v_lshrrev_b32 v3, 3, v2
    v_mul_u32_u24 v3, 1280, v3
    v_add_u32 v3, s30, v3
    v_lshrrev_b32 v4, 4, v2
    v_and_b32 v5, 7, v2
    v_xor_b32 v5, v5, v4
    v_lshlrev_b32 v6, 4, v5
    v_xor_b32 v7, 64, v6
    v_add_u32 v8, v3, v6
    v_add_u32 v9, v3, v7
    v_add_u32 v9, 9216, v9
    v_add_u32 v10, 18432, v8
    v_add_u32 v11, 18432, v9
    s_mul_i32 s31, s29, 61440
    s_mul_i32 s32, s27, 320
    s_add_u32 s31, s31, s32
    v_lshlrev_b32 v6, 4, v2
    v_add_u32 v6, s31, v6
    v_add_u32 v5, 0, v2
    v_mul_u32_u24 v5, 3277, v5
    v_lshrrev_b32 v5, 16, v5
    v_mul_u32_u24 v5, 3520, v5
    v_add_u32 v12, v5, v6
    v_add_u32 v5, 64, v2
    v_mul_u32_u24 v5, 3277, v5
    v_lshrrev_b32 v5, 16, v5
    v_mul_u32_u24 v5, 3520, v5
    v_add_u32 v13, v5, v6
    v_add_u32 v5, 128, v2
    v_mul_u32_u24 v5, 3277, v5
    v_lshrrev_b32 v5, 16, v5
    v_and_b32 v7, 8, v5
    v_lshlrev_b32 v7, 2, v7
    v_mul_u32_u24 v5, 3520, v5
    v_add_u32 v14, v5, v6
    v_xor_b32 v14, v14, v7
    v_add_u32 v5, 192, v2
    v_mul_u32_u24 v5, 3277, v5
    v_lshrrev_b32 v5, 16, v5
    v_and_b32 v7, 8, v5
    v_lshlrev_b32 v7, 2, v7
    v_mul_u32_u24 v5, 3520, v5
    v_add_u32 v15, v5, v6
    v_xor_b32 v15, v15, v7
    v_add_u32 v5, 256, v2
    v_mul_u32_u24 v5, 3277, v5
    v_lshrrev_b32 v5, 16, v5
    v_and_b32 v7, 8, v5
    v_lshlrev_b32 v7, 2, v7
    v_mul_u32_u24 v5, 3520, v5
    v_add_u32 v16, v5, v6
    v_xor_b32 v16, v16, v7
    v_add_u32 v16, 4096, v16
    s_lshl_b32 s33, s29, 12
    s_mul_i32 s37, s29, 5120
    s_add_u32 s34, s36, 0
    s_and_b32 s34, s34, 1
    s_add_u32 s34, s34, 0
    s_mul_i32 s35, s34, 245760
    s_lshl_b32 s34, s34, 7
    s_mov_b32 s14, 2621440
    s_mov_b32 s15, 0x20000
    s_mov_b32 s18, 2457600
    s_mov_b32 s19, 0x20000
    s_waitcnt lgkmcnt(0)
    s_mov_b32 s12, s4
    s_mov_b32 s13, s5
    s_mov_b32 s16, s6
    s_mov_b32 s17, s7
    s_add_u32 m0, s33, 0
    s_nop 0
    buffer_load_dwordx4 v8, s[12:15], s34 offen offset:0 lds
    buffer_load_dwordx4 v9, s[12:15], s34 offen offset:1024 lds
    buffer_load_dwordx4 v10, s[12:15], s34 offen offset:2048 lds
    buffer_load_dwordx4 v11, s[12:15], s34 offen offset:3072 lds
    s_add_u32 m0, s37, 16384
    s_nop 0
    buffer_load_dwordx4 v12, s[16:19], s35 offen offset:0 lds
    buffer_load_dwordx4 v13, s[16:19], s35 offen offset:1024 lds
    buffer_load_dwordx4 v14, s[16:19], s35 offen offset:2048 lds
    buffer_load_dwordx4 v15, s[16:19], s35 offen offset:3072 lds
    s_add_u32 m0, s37, 20480
    s_nop 0
    buffer_load_dwordx4 v16, s[16:19], s35 offen lds
    s_add_u32 s34, s36, 1
    s_and_b32 s34, s34, 1
    s_add_u32 s34, s34, 0
    s_mul_i32 s35, s34, 245760
    s_lshl_b32 s34, s34, 7
    s_add_u32 m0, s33, 36864
    s_nop 0
    buffer_load_dwordx4 v8, s[12:15], s34 offen offset:0 lds
    buffer_load_dwordx4 v9, s[12:15], s34 offen offset:1024 lds
    buffer_load_dwordx4 v10, s[12:15], s34 offen offset:2048 lds
    buffer_load_dwordx4 v11, s[12:15], s34 offen offset:3072 lds
    s_add_u32 m0, s37, 53248
    s_nop 0
    buffer_load_dwordx4 v12, s[16:19], s35 offen offset:0 lds
    buffer_load_dwordx4 v13, s[16:19], s35 offen offset:1024 lds
    buffer_load_dwordx4 v14, s[16:19], s35 offen offset:2048 lds
    buffer_load_dwordx4 v15, s[16:19], s35 offen offset:3072 lds
    s_add_u32 m0, s37, 57344
    s_nop 0
    buffer_load_dwordx4 v16, s[16:19], s35 offen lds
    s_add_u32 s34, s36, 2
    s_and_b32 s34, s34, 3
    s_add_u32 s34, s34, 2
    s_mul_i32 s35, s34, 245760
    s_lshl_b32 s34, s34, 7
    s_mov_b32 s20, s8
    s_mov_b32 s21, s9
    s_waitcnt vmcnt(9)
    s_barrier
    s_add_u32 m0, s33, 73728
    s_nop 0
    buffer_load_dwordx4 v8, s[12:15], s34 offen offset:0 lds
    buffer_load_dwordx4 v9, s[12:15], s34 offen offset:1024 lds
    buffer_load_dwordx4 v10, s[12:15], s34 offen offset:2048 lds
    buffer_load_dwordx4 v11, s[12:15], s34 offen offset:3072 lds
    s_add_u32 m0, s37, 90112
    s_nop 0
    buffer_load_dwordx4 v12, s[16:19], s35 offen offset:0 lds
    buffer_load_dwordx4 v13, s[16:19], s35 offen offset:1024 lds
    buffer_load_dwordx4 v14, s[16:19], s35 offen offset:2048 lds
    buffer_load_dwordx4 v15, s[16:19], s35 offen offset:3072 lds
    s_add_u32 m0, s37, 94208
    s_nop 0
    buffer_load_dwordx4 v16, s[16:19], s35 offen lds
    s_add_u32 s34, s36, 3
    s_and_b32 s34, s34, 3
    s_add_u32 s34, s34, 2
    s_mul_i32 s35, s34, 245760
    s_lshl_b32 s34, s34, 7
    s_waitcnt vmcnt(9)
    s_barrier
    s_add_u32 m0, s33, 110592
    s_nop 0
    buffer_load_dwordx4 v8, s[12:15], s34 offen offset:0 lds
    buffer_load_dwordx4 v9, s[12:15], s34 offen offset:1024 lds
    buffer_load_dwordx4 v10, s[12:15], s34 offen offset:2048 lds
    buffer_load_dwordx4 v11, s[12:15], s34 offen offset:3072 lds
    s_add_u32 m0, s37, 126976
    s_nop 0
    buffer_load_dwordx4 v12, s[16:19], s35 offen offset:0 lds
    buffer_load_dwordx4 v13, s[16:19], s35 offen offset:1024 lds
    buffer_load_dwordx4 v14, s[16:19], s35 offen offset:2048 lds
    buffer_load_dwordx4 v15, s[16:19], s35 offen offset:3072 lds
    s_add_u32 m0, s37, 131072
    s_nop 0
    buffer_load_dwordx4 v16, s[16:19], s35 offen lds
    s_add_u32 s34, s36, 4
    s_and_b32 s34, s34, 3
    s_add_u32 s34, s34, 2
    s_mul_i32 s35, s34, 245760
    s_lshl_b32 s34, s34, 7
    s_waitcnt vmcnt(9)
    s_barrier
    s_add_u32 m0, s33, 0
    s_nop 0
    buffer_load_dwordx4 v8, s[12:15], s34 offen offset:0 lds
    buffer_load_dwordx4 v9, s[12:15], s34 offen offset:1024 lds
    buffer_load_dwordx4 v10, s[12:15], s34 offen offset:2048 lds
    buffer_load_dwordx4 v11, s[12:15], s34 offen offset:3072 lds
    s_add_u32 m0, s37, 16384
    s_nop 0
    buffer_load_dwordx4 v12, s[16:19], s35 offen offset:0 lds
    buffer_load_dwordx4 v13, s[16:19], s35 offen offset:1024 lds
    buffer_load_dwordx4 v14, s[16:19], s35 offen offset:2048 lds
    buffer_load_dwordx4 v15, s[16:19], s35 offen offset:3072 lds
    s_add_u32 m0, s37, 20480
    s_nop 0
    buffer_load_dwordx4 v16, s[16:19], s35 offen lds
    s_add_u32 s34, s36, 5
    s_and_b32 s34, s34, 3
    s_add_u32 s34, s34, 2
    s_mul_i32 s35, s34, 245760
    s_lshl_b32 s34, s34, 7
    s_waitcnt vmcnt(9)
    s_barrier
    s_add_u32 m0, s33, 36864
    s_nop 0
    buffer_load_dwordx4 v8, s[12:15], s34 offen offset:0 lds
    buffer_load_dwordx4 v9, s[12:15], s34 offen offset:1024 lds
    buffer_load_dwordx4 v10, s[12:15], s34 offen offset:2048 lds
    buffer_load_dwordx4 v11, s[12:15], s34 offen offset:3072 lds
    s_add_u32 m0, s37, 53248
    s_nop 0
    buffer_load_dwordx4 v12, s[16:19], s35 offen offset:0 lds
    buffer_load_dwordx4 v13, s[16:19], s35 offen offset:1024 lds
    buffer_load_dwordx4 v14, s[16:19], s35 offen offset:2048 lds
    buffer_load_dwordx4 v15, s[16:19], s35 offen offset:3072 lds
    s_add_u32 m0, s37, 57344
    s_nop 0
    buffer_load_dwordx4 v16, s[16:19], s35 offen lds
    s_add_u32 s34, s36, 6
    s_and_b32 s34, s34, 3
    s_add_u32 s34, s34, 6
    s_mul_i32 s35, s34, 245760
    s_lshl_b32 s34, s34, 7
    s_waitcnt vmcnt(9)
    s_barrier
    s_add_u32 m0, s33, 73728
    s_nop 0
    buffer_load_dwordx4 v8, s[12:15], s34 offen offset:0 lds
    buffer_load_dwordx4 v9, s[12:15], s34 offen offset:1024 lds
    buffer_load_dwordx4 v10, s[12:15], s34 offen offset:2048 lds
    buffer_load_dwordx4 v11, s[12:15], s34 offen offset:3072 lds
    s_add_u32 m0, s37, 90112
    s_nop 0
    buffer_load_dwordx4 v12, s[16:19], s35 offen offset:0 lds
    buffer_load_dwordx4 v13, s[16:19], s35 offen offset:1024 lds
    buffer_load_dwordx4 v14, s[16:19], s35 offen offset:2048 lds
    buffer_load_dwordx4 v15, s[16:19], s35 offen offset:3072 lds
    s_add_u32 m0, s37, 94208
    s_nop 0
    buffer_load_dwordx4 v16, s[16:19], s35 offen lds
    s_add_u32 s34, s36, 7
    s_and_b32 s34, s34, 3
    s_add_u32 s34, s34, 6
    s_mul_i32 s35, s34, 245760
    s_lshl_b32 s34, s34, 7
    s_waitcnt vmcnt(9)
    s_barrier
    s_add_u32 m0, s33, 110592
    s_nop 0
    buffer_load_dwordx4 v8, s[12:15], s34 offen offset:0 lds
    buffer_load_dwordx4 v9, s[12:15], s34 offen offset:1024 lds
    buffer_load_dwordx4 v10, s[12:15], s34 offen offset:2048 lds
    buffer_load_dwordx4 v11, s[12:15], s34 offen offset:3072 lds
    s_add_u32 m0, s37, 126976
    s_nop 0
    buffer_load_dwordx4 v12, s[16:19], s35 offen offset:0 lds
    buffer_load_dwordx4 v13, s[16:19], s35 offen offset:1024 lds
    buffer_load_dwordx4 v14, s[16:19], s35 offen offset:2048 lds
    buffer_load_dwordx4 v15, s[16:19], s35 offen offset:3072 lds
    s_add_u32 m0, s37, 131072
    s_nop 0
    buffer_load_dwordx4 v16, s[16:19], s35 offen lds
    s_add_u32 s34, s36, 8
    s_and_b32 s34, s34, 3
    s_add_u32 s34, s34, 6
    s_mul_i32 s35, s34, 245760
    s_lshl_b32 s34, s34, 7
    s_waitcnt vmcnt(9)
    s_barrier
    s_add_u32 m0, s33, 0
    s_nop 0
    buffer_load_dwordx4 v8, s[12:15], s34 offen offset:0 lds
    buffer_load_dwordx4 v9, s[12:15], s34 offen offset:1024 lds
    buffer_load_dwordx4 v10, s[12:15], s34 offen offset:2048 lds
    buffer_load_dwordx4 v11, s[12:15], s34 offen offset:3072 lds
    s_add_u32 m0, s37, 16384
    s_nop 0
    buffer_load_dwordx4 v12, s[16:19], s35 offen offset:0 lds
    buffer_load_dwordx4 v13, s[16:19], s35 offen offset:1024 lds
    buffer_load_dwordx4 v14, s[16:19], s35 offen offset:2048 lds
    buffer_load_dwordx4 v15, s[16:19], s35 offen offset:3072 lds
    s_add_u32 m0, s37, 20480
    s_nop 0
    buffer_load_dwordx4 v16, s[16:19], s35 offen lds
    s_add_u32 s34, s36, 9
    s_and_b32 s34, s34, 3
    s_add_u32 s34, s34, 6
    s_mul_i32 s35, s34, 245760
    s_lshl_b32 s34, s34, 7
    s_waitcnt vmcnt(9)
    s_barrier
    s_add_u32 m0, s33, 36864
    s_nop 0
    buffer_load_dwordx4 v8, s[12:15], s34 offen offset:0 lds
    buffer_load_dwordx4 v9, s[12:15], s34 offen offset:1024 lds
    buffer_load_dwordx4 v10, s[12:15], s34 offen offset:2048 lds
    buffer_load_dwordx4 v11, s[12:15], s34 offen offset:3072 lds
    s_add_u32 m0, s37, 53248
    s_nop 0
    buffer_load_dwordx4 v12, s[16:19], s35 offen offset:0 lds
    buffer_load_dwordx4 v13, s[16:19], s35 offen offset:1024 lds
    buffer_load_dwordx4 v14, s[16:19], s35 offen offset:2048 lds
    buffer_load_dwordx4 v15, s[16:19], s35 offen offset:3072 lds
    s_add_u32 m0, s37, 57344
    s_nop 0
    buffer_load_dwordx4 v16, s[16:19], s35 offen lds
    s_waitcnt vmcnt(9)
    s_barrier
    s_waitcnt vmcnt(0)
    s_barrier
    s_lshl_b32 s40, s25, 3
    s_add_u32 s40, s40, s3
    s_cmp_lg_u32 s40, 4
    s_cbranch_scc1 .a_nowake
    v_mov_b32 v3, 161792
    ds_read_b32 v5, v3 offset:48
    v_lshlrev_b32 v7, 2, v2
    s_lshl_b32 s40, s24, 7
    s_add_u32 s40, s40, 11383296
    s_mov_b32 s46, 0x200000
    .ga_lw1:
    ds_read_b32 v4, v3 offset:128
    s_sub_u32 s46, s46, 1
    s_waitcnt lgkmcnt(0)
    v_readfirstlane_b32 s45, v4
    s_cmp_eq_u32 s46, 0
    s_cbranch_scc1 .ga_lwd2
    s_cmp_ge_u32 s45, 4
    s_cbranch_scc1 .ga_lwd2
    s_sleep 1
    s_branch .ga_lw1
    .ga_lwd2:
    s_mov_b32 exec_lo, -1
    s_mov_b32 exec_hi, 0
    buffer_store_dword v5, v7, s[20:23], s40 offen sc1
    s_mov_b64 exec, -1
.a_nowake:
    s_branch .b_attn
.a_compute:
    s_lshr_b32 s29, s3, 1
    s_and_b32 s30, s3, 1
    v_and_b32 v3, 15, v2
    v_lshrrev_b32 v4, 4, v2
    v_lshrrev_b32 v5, 1, v3
    v_xor_b32 v5, v5, v4
    v_lshlrev_b32 v5, 4, v5
    v_lshl_add_u32 v5, v3, 7, v5
    s_lshl_b32 s31, s29, 13
    v_add_u32 v6, s31, v5
    v_xor_b32 v7, 64, v6
    v_bfe_u32 v5, v2, 2, 2
    v_lshl_add_u32 v5, v4, 3, v5
    v_mul_u32_u24 v5, 320, v5
    v_and_b32 v8, 3, v2
    v_lshl_add_u32 v5, v8, 3, v5
    s_mul_i32 s31, s30, 160
    s_add_u32 s31, s31, 16384
    v_add_u32 v5, s31, v5
    v_and_b32 v9, 1, v4
    v_lshlrev_b32 v9, 5, v9
    s_cmp_eq_u32 s30, 0
    s_cselect_b32 s31, 1, -1
    v_mul_lo_u32 v9, v9, s31
    v_add_u32 v8, v5, v9
    v_sub_u32 v9, v5, v9
    v_add_u32 v10, 73728, v6
    v_add_u32 v11, 73728, v7
    v_add_u32 v12, 73728, v8
    v_add_u32 v13, 73728, v9
    s_cmp_ge_u32 s27, 8
    s_cbranch_scc1 .a_vpath
    v_lshrrev_b32 v14, 5, v2
    v_lshlrev_b32 v14, 11, v14
    v_and_b32 v5, 31, v2
    v_lshl_add_u32 v14, v5, 4, v14
    s_lshl_b32 s36, s27, 1
    s_add_u32 s36, s36, s30
    s_mul_i32 s36, s36, 20480
    s_mul_i32 s37, s26, 327680
    s_add_u32 s36, s36, s37
    s_lshl_b32 s37, s29, 10
    s_add_u32 s36, s36, s37
    s_waitcnt lgkmcnt(0)
    s_mov_b32 s20, s8
    s_mov_b32 s21, s9
    s_barrier
    ds_read_b128 v[16:19], v6 offset:0
    ds_read_b64_tr_b16 v[32:33], v8 offset:0
    ds_read_b64_tr_b16 v[34:35], v8 offset:1280
    ds_read_b128 v[20:23], v6 offset:2048
    ds_read_b128 v[24:27], v6 offset:4096
    ds_read_b128 v[28:31], v6 offset:6144
    ds_read_b64_tr_b16 v[36:37], v9 offset:32
    ds_read_b64_tr_b16 v[38:39], v9 offset:1312
    ds_read_b64_tr_b16 v[40:41], v8 offset:64
    ds_read_b64_tr_b16 v[42:43], v8 offset:1344
    ds_read_b64_tr_b16 v[44:45], v9 offset:96
    ds_read_b64_tr_b16 v[46:47], v9 offset:1376
    ds_read_b64_tr_b16 v[48:49], v8 offset:128
    ds_read_b64_tr_b16 v[50:51], v8 offset:1408
    s_waitcnt lgkmcnt(0)
    v_mfma_f32_16x16x32_bf16 v[88:91], v[32:35], v[16:19], 0
    ds_read_b128 v[52:55], v7 offset:0
    v_mfma_f32_16x16x32_bf16 v[92:95], v[32:35], v[20:23], 0
    ds_read_b64_tr_b16 v[68:69], v8 offset:10240
    v_mfma_f32_16x16x32_bf16 v[96:99], v[32:35], v[24:27], 0
    ds_read_b64_tr_b16 v[70:71], v8 offset:11520
    v_mfma_f32_16x16x32_bf16 v[100:103], v[32:35], v[28:31], 0
    ds_read_b128 v[56:59], v7 offset:2048
    v_mfma_f32_16x16x32_bf16 v[104:107], v[36:39], v[16:19], 0
    ds_read_b128 v[60:63], v7 offset:4096
    v_mfma_f32_16x16x32_bf16 v[108:111], v[36:39], v[20:23], 0
    ds_read_b128 v[64:67], v7 offset:6144
    v_mfma_f32_16x16x32_bf16 v[112:115], v[36:39], v[24:27], 0
    ds_read_b64_tr_b16 v[72:73], v9 offset:10272
    v_mfma_f32_16x16x32_bf16 v[116:119], v[36:39], v[28:31], 0
    ds_read_b64_tr_b16 v[74:75], v9 offset:11552
    v_mfma_f32_16x16x32_bf16 v[120:123], v[40:43], v[16:19], 0
    ds_read_b64_tr_b16 v[76:77], v8 offset:10304
    v_mfma_f32_16x16x32_bf16 v[124:127], v[40:43], v[20:23], 0
    ds_read_b64_tr_b16 v[78:79], v8 offset:11584
    v_mfma_f32_16x16x32_bf16 v[128:131], v[40:43], v[24:27], 0
    ds_read_b64_tr_b16 v[80:81], v9 offset:10336
    v_mfma_f32_16x16x32_bf16 v[132:135], v[40:43], v[28:31], 0
    ds_read_b64_tr_b16 v[82:83], v9 offset:11616
    v_mfma_f32_16x16x32_bf16 v[136:139], v[44:47], v[16:19], 0
    ds_read_b64_tr_b16 v[84:85], v8 offset:10368
    v_mfma_f32_16x16x32_bf16 v[140:143], v[44:47], v[20:23], 0
    ds_read_b64_tr_b16 v[86:87], v8 offset:11648
    v_mfma_f32_16x16x32_bf16 v[144:147], v[44:47], v[24:27], 0
    v_mfma_f32_16x16x32_bf16 v[148:151], v[44:47], v[28:31], 0
    v_mfma_f32_16x16x32_bf16 v[152:155], v[48:51], v[16:19], 0
    v_mfma_f32_16x16x32_bf16 v[156:159], v[48:51], v[20:23], 0
    v_mfma_f32_16x16x32_bf16 v[160:163], v[48:51], v[24:27], 0
    v_mfma_f32_16x16x32_bf16 v[164:167], v[48:51], v[28:31], 0
    s_waitcnt lgkmcnt(0)
    s_barrier
    v_mfma_f32_16x16x32_bf16 v[88:91], v[68:71], v[52:55], v[88:91]
    ds_read_b128 v[16:19], v6 offset:36864
    v_mfma_f32_16x16x32_bf16 v[92:95], v[68:71], v[56:59], v[92:95]
    ds_read_b64_tr_b16 v[32:33], v8 offset:36864
    v_mfma_f32_16x16x32_bf16 v[96:99], v[68:71], v[60:63], v[96:99]
    ds_read_b64_tr_b16 v[34:35], v8 offset:38144
    v_mfma_f32_16x16x32_bf16 v[100:103], v[68:71], v[64:67], v[100:103]
    ds_read_b128 v[20:23], v6 offset:38912
    v_mfma_f32_16x16x32_bf16 v[104:107], v[72:75], v[52:55], v[104:107]
    ds_read_b128 v[24:27], v6 offset:40960
    v_mfma_f32_16x16x32_bf16 v[108:111], v[72:75], v[56:59], v[108:111]
    ds_read_b128 v[28:31], v6 offset:43008
    v_mfma_f32_16x16x32_bf16 v[112:115], v[72:75], v[60:63], v[112:115]
    ds_read_b64_tr_b16 v[36:37], v9 offset:36896
    v_mfma_f32_16x16x32_bf16 v[116:119], v[72:75], v[64:67], v[116:119]
    ds_read_b64_tr_b16 v[38:39], v9 offset:38176
    v_mfma_f32_16x16x32_bf16 v[120:123], v[76:79], v[52:55], v[120:123]
    ds_read_b64_tr_b16 v[40:41], v8 offset:36928
    v_mfma_f32_16x16x32_bf16 v[124:127], v[76:79], v[56:59], v[124:127]
    ds_read_b64_tr_b16 v[42:43], v8 offset:38208
    v_mfma_f32_16x16x32_bf16 v[128:131], v[76:79], v[60:63], v[128:131]
    ds_read_b64_tr_b16 v[44:45], v9 offset:36960
    v_mfma_f32_16x16x32_bf16 v[132:135], v[76:79], v[64:67], v[132:135]
    ds_read_b64_tr_b16 v[46:47], v9 offset:38240
    v_mfma_f32_16x16x32_bf16 v[136:139], v[80:83], v[52:55], v[136:139]
    ds_read_b64_tr_b16 v[48:49], v8 offset:36992
    v_mfma_f32_16x16x32_bf16 v[140:143], v[80:83], v[56:59], v[140:143]
    ds_read_b64_tr_b16 v[50:51], v8 offset:38272
    v_mfma_f32_16x16x32_bf16 v[144:147], v[80:83], v[60:63], v[144:147]
    v_mfma_f32_16x16x32_bf16 v[148:151], v[80:83], v[64:67], v[148:151]
    v_mfma_f32_16x16x32_bf16 v[152:155], v[84:87], v[52:55], v[152:155]
    v_mfma_f32_16x16x32_bf16 v[156:159], v[84:87], v[56:59], v[156:159]
    v_mfma_f32_16x16x32_bf16 v[160:163], v[84:87], v[60:63], v[160:163]
    v_mfma_f32_16x16x32_bf16 v[164:167], v[84:87], v[64:67], v[164:167]
    s_waitcnt lgkmcnt(0)
    v_mfma_f32_16x16x32_bf16 v[88:91], v[32:35], v[16:19], v[88:91]
    ds_read_b128 v[52:55], v7 offset:36864
    v_mfma_f32_16x16x32_bf16 v[92:95], v[32:35], v[20:23], v[92:95]
    ds_read_b64_tr_b16 v[68:69], v8 offset:47104
    v_mfma_f32_16x16x32_bf16 v[96:99], v[32:35], v[24:27], v[96:99]
    ds_read_b64_tr_b16 v[70:71], v8 offset:48384
    v_mfma_f32_16x16x32_bf16 v[100:103], v[32:35], v[28:31], v[100:103]
    ds_read_b128 v[56:59], v7 offset:38912
    v_mfma_f32_16x16x32_bf16 v[104:107], v[36:39], v[16:19], v[104:107]
    ds_read_b128 v[60:63], v7 offset:40960
    v_mfma_f32_16x16x32_bf16 v[108:111], v[36:39], v[20:23], v[108:111]
    ds_read_b128 v[64:67], v7 offset:43008
    v_mfma_f32_16x16x32_bf16 v[112:115], v[36:39], v[24:27], v[112:115]
    ds_read_b64_tr_b16 v[72:73], v9 offset:47136
    v_mfma_f32_16x16x32_bf16 v[116:119], v[36:39], v[28:31], v[116:119]
    ds_read_b64_tr_b16 v[74:75], v9 offset:48416
    v_mfma_f32_16x16x32_bf16 v[120:123], v[40:43], v[16:19], v[120:123]
    ds_read_b64_tr_b16 v[76:77], v8 offset:47168
    v_mfma_f32_16x16x32_bf16 v[124:127], v[40:43], v[20:23], v[124:127]
    ds_read_b64_tr_b16 v[78:79], v8 offset:48448
    v_mfma_f32_16x16x32_bf16 v[128:131], v[40:43], v[24:27], v[128:131]
    ds_read_b64_tr_b16 v[80:81], v9 offset:47200
    v_mfma_f32_16x16x32_bf16 v[132:135], v[40:43], v[28:31], v[132:135]
    ds_read_b64_tr_b16 v[82:83], v9 offset:48480
    v_mfma_f32_16x16x32_bf16 v[136:139], v[44:47], v[16:19], v[136:139]
    ds_read_b64_tr_b16 v[84:85], v8 offset:47232
    v_mfma_f32_16x16x32_bf16 v[140:143], v[44:47], v[20:23], v[140:143]
    ds_read_b64_tr_b16 v[86:87], v8 offset:48512
    v_mfma_f32_16x16x32_bf16 v[144:147], v[44:47], v[24:27], v[144:147]
    v_mfma_f32_16x16x32_bf16 v[148:151], v[44:47], v[28:31], v[148:151]
    v_mfma_f32_16x16x32_bf16 v[152:155], v[48:51], v[16:19], v[152:155]
    v_mfma_f32_16x16x32_bf16 v[156:159], v[48:51], v[20:23], v[156:159]
    v_mfma_f32_16x16x32_bf16 v[160:163], v[48:51], v[24:27], v[160:163]
    v_mfma_f32_16x16x32_bf16 v[164:167], v[48:51], v[28:31], v[164:167]
    s_waitcnt lgkmcnt(0)
    s_barrier
    v_mfma_f32_16x16x32_bf16 v[88:91], v[68:71], v[52:55], v[88:91]
    ds_read_b128 v[16:19], v10 offset:0
    v_mfma_f32_16x16x32_bf16 v[92:95], v[68:71], v[56:59], v[92:95]
    ds_read_b64_tr_b16 v[32:33], v12 offset:0
    v_mfma_f32_16x16x32_bf16 v[96:99], v[68:71], v[60:63], v[96:99]
    ds_read_b64_tr_b16 v[34:35], v12 offset:1280
    v_mfma_f32_16x16x32_bf16 v[100:103], v[68:71], v[64:67], v[100:103]
    ds_read_b128 v[20:23], v10 offset:2048
    v_mfma_f32_16x16x32_bf16 v[104:107], v[72:75], v[52:55], v[104:107]
    ds_read_b128 v[24:27], v10 offset:4096
    v_mfma_f32_16x16x32_bf16 v[108:111], v[72:75], v[56:59], v[108:111]
    ds_read_b128 v[28:31], v10 offset:6144
    v_mfma_f32_16x16x32_bf16 v[112:115], v[72:75], v[60:63], v[112:115]
    ds_read_b64_tr_b16 v[36:37], v13 offset:32
    v_mfma_f32_16x16x32_bf16 v[116:119], v[72:75], v[64:67], v[116:119]
    ds_read_b64_tr_b16 v[38:39], v13 offset:1312
    v_mfma_f32_16x16x32_bf16 v[120:123], v[76:79], v[52:55], v[120:123]
    ds_read_b64_tr_b16 v[40:41], v12 offset:64
    v_mfma_f32_16x16x32_bf16 v[124:127], v[76:79], v[56:59], v[124:127]
    ds_read_b64_tr_b16 v[42:43], v12 offset:1344
    v_mfma_f32_16x16x32_bf16 v[128:131], v[76:79], v[60:63], v[128:131]
    ds_read_b64_tr_b16 v[44:45], v13 offset:96
    v_mfma_f32_16x16x32_bf16 v[132:135], v[76:79], v[64:67], v[132:135]
    ds_read_b64_tr_b16 v[46:47], v13 offset:1376
    v_mfma_f32_16x16x32_bf16 v[136:139], v[80:83], v[52:55], v[136:139]
    ds_read_b64_tr_b16 v[48:49], v12 offset:128
    v_mfma_f32_16x16x32_bf16 v[140:143], v[80:83], v[56:59], v[140:143]
    ds_read_b64_tr_b16 v[50:51], v12 offset:1408
    v_mfma_f32_16x16x32_bf16 v[144:147], v[80:83], v[60:63], v[144:147]
    v_mfma_f32_16x16x32_bf16 v[148:151], v[80:83], v[64:67], v[148:151]
    v_mfma_f32_16x16x32_bf16 v[152:155], v[84:87], v[52:55], v[152:155]
    v_mfma_f32_16x16x32_bf16 v[156:159], v[84:87], v[56:59], v[156:159]
    v_mfma_f32_16x16x32_bf16 v[160:163], v[84:87], v[60:63], v[160:163]
    v_mfma_f32_16x16x32_bf16 v[164:167], v[84:87], v[64:67], v[164:167]
    s_waitcnt lgkmcnt(0)
    v_mfma_f32_16x16x32_bf16 v[88:91], v[32:35], v[16:19], v[88:91]
    ds_read_b128 v[52:55], v11 offset:0
    v_mfma_f32_16x16x32_bf16 v[92:95], v[32:35], v[20:23], v[92:95]
    ds_read_b64_tr_b16 v[68:69], v12 offset:10240
    v_mfma_f32_16x16x32_bf16 v[96:99], v[32:35], v[24:27], v[96:99]
    ds_read_b64_tr_b16 v[70:71], v12 offset:11520
    v_mfma_f32_16x16x32_bf16 v[100:103], v[32:35], v[28:31], v[100:103]
    ds_read_b128 v[56:59], v11 offset:2048
    v_mfma_f32_16x16x32_bf16 v[104:107], v[36:39], v[16:19], v[104:107]
    ds_read_b128 v[60:63], v11 offset:4096
    v_mfma_f32_16x16x32_bf16 v[108:111], v[36:39], v[20:23], v[108:111]
    ds_read_b128 v[64:67], v11 offset:6144
    v_mfma_f32_16x16x32_bf16 v[112:115], v[36:39], v[24:27], v[112:115]
    ds_read_b64_tr_b16 v[72:73], v13 offset:10272
    v_mfma_f32_16x16x32_bf16 v[116:119], v[36:39], v[28:31], v[116:119]
    ds_read_b64_tr_b16 v[74:75], v13 offset:11552
    v_mfma_f32_16x16x32_bf16 v[120:123], v[40:43], v[16:19], v[120:123]
    ds_read_b64_tr_b16 v[76:77], v12 offset:10304
    v_mfma_f32_16x16x32_bf16 v[124:127], v[40:43], v[20:23], v[124:127]
    ds_read_b64_tr_b16 v[78:79], v12 offset:11584
    v_mfma_f32_16x16x32_bf16 v[128:131], v[40:43], v[24:27], v[128:131]
    ds_read_b64_tr_b16 v[80:81], v13 offset:10336
    v_mfma_f32_16x16x32_bf16 v[132:135], v[40:43], v[28:31], v[132:135]
    ds_read_b64_tr_b16 v[82:83], v13 offset:11616
    v_mfma_f32_16x16x32_bf16 v[136:139], v[44:47], v[16:19], v[136:139]
    ds_read_b64_tr_b16 v[84:85], v12 offset:10368
    v_mfma_f32_16x16x32_bf16 v[140:143], v[44:47], v[20:23], v[140:143]
    ds_read_b64_tr_b16 v[86:87], v12 offset:11648
    v_mfma_f32_16x16x32_bf16 v[144:147], v[44:47], v[24:27], v[144:147]
    v_mfma_f32_16x16x32_bf16 v[148:151], v[44:47], v[28:31], v[148:151]
    v_mfma_f32_16x16x32_bf16 v[152:155], v[48:51], v[16:19], v[152:155]
    v_mfma_f32_16x16x32_bf16 v[156:159], v[48:51], v[20:23], v[156:159]
    v_mfma_f32_16x16x32_bf16 v[160:163], v[48:51], v[24:27], v[160:163]
    v_mfma_f32_16x16x32_bf16 v[164:167], v[48:51], v[28:31], v[164:167]
    s_waitcnt lgkmcnt(0)
    s_barrier
    v_mfma_f32_16x16x32_bf16 v[88:91], v[68:71], v[52:55], v[88:91]
    ds_read_b128 v[16:19], v10 offset:36864
    v_mfma_f32_16x16x32_bf16 v[92:95], v[68:71], v[56:59], v[92:95]
    ds_read_b64_tr_b16 v[32:33], v12 offset:36864
    v_mfma_f32_16x16x32_bf16 v[96:99], v[68:71], v[60:63], v[96:99]
    ds_read_b64_tr_b16 v[34:35], v12 offset:38144
    v_mfma_f32_16x16x32_bf16 v[100:103], v[68:71], v[64:67], v[100:103]
    ds_read_b128 v[20:23], v10 offset:38912
    v_mfma_f32_16x16x32_bf16 v[104:107], v[72:75], v[52:55], v[104:107]
    ds_read_b128 v[24:27], v10 offset:40960
    v_mfma_f32_16x16x32_bf16 v[108:111], v[72:75], v[56:59], v[108:111]
    ds_read_b128 v[28:31], v10 offset:43008
    v_mfma_f32_16x16x32_bf16 v[112:115], v[72:75], v[60:63], v[112:115]
    ds_read_b64_tr_b16 v[36:37], v13 offset:36896
    v_mfma_f32_16x16x32_bf16 v[116:119], v[72:75], v[64:67], v[116:119]
    ds_read_b64_tr_b16 v[38:39], v13 offset:38176
    v_mfma_f32_16x16x32_bf16 v[120:123], v[76:79], v[52:55], v[120:123]
    ds_read_b64_tr_b16 v[40:41], v12 offset:36928
    v_mfma_f32_16x16x32_bf16 v[124:127], v[76:79], v[56:59], v[124:127]
    ds_read_b64_tr_b16 v[42:43], v12 offset:38208
    v_mfma_f32_16x16x32_bf16 v[128:131], v[76:79], v[60:63], v[128:131]
    ds_read_b64_tr_b16 v[44:45], v13 offset:36960
    v_mfma_f32_16x16x32_bf16 v[132:135], v[76:79], v[64:67], v[132:135]
    ds_read_b64_tr_b16 v[46:47], v13 offset:38240
    v_mfma_f32_16x16x32_bf16 v[136:139], v[80:83], v[52:55], v[136:139]
    ds_read_b64_tr_b16 v[48:49], v12 offset:36992
    v_mfma_f32_16x16x32_bf16 v[140:143], v[80:83], v[56:59], v[140:143]
    ds_read_b64_tr_b16 v[50:51], v12 offset:38272
    v_mfma_f32_16x16x32_bf16 v[144:147], v[80:83], v[60:63], v[144:147]
    v_mfma_f32_16x16x32_bf16 v[148:151], v[80:83], v[64:67], v[148:151]
    v_mfma_f32_16x16x32_bf16 v[152:155], v[84:87], v[52:55], v[152:155]
    v_mfma_f32_16x16x32_bf16 v[156:159], v[84:87], v[56:59], v[156:159]
    v_mfma_f32_16x16x32_bf16 v[160:163], v[84:87], v[60:63], v[160:163]
    v_mfma_f32_16x16x32_bf16 v[164:167], v[84:87], v[64:67], v[164:167]
    s_waitcnt lgkmcnt(0)
    v_mfma_f32_16x16x32_bf16 v[88:91], v[32:35], v[16:19], v[88:91]
    ds_read_b128 v[52:55], v11 offset:36864
    v_mfma_f32_16x16x32_bf16 v[92:95], v[32:35], v[20:23], v[92:95]
    ds_read_b64_tr_b16 v[68:69], v12 offset:47104
    v_mfma_f32_16x16x32_bf16 v[96:99], v[32:35], v[24:27], v[96:99]
    ds_read_b64_tr_b16 v[70:71], v12 offset:48384
    v_mfma_f32_16x16x32_bf16 v[100:103], v[32:35], v[28:31], v[100:103]
    ds_read_b128 v[56:59], v11 offset:38912
    v_mfma_f32_16x16x32_bf16 v[104:107], v[36:39], v[16:19], v[104:107]
    ds_read_b128 v[60:63], v11 offset:40960
    v_mfma_f32_16x16x32_bf16 v[108:111], v[36:39], v[20:23], v[108:111]
    ds_read_b128 v[64:67], v11 offset:43008
    v_mfma_f32_16x16x32_bf16 v[112:115], v[36:39], v[24:27], v[112:115]
    ds_read_b64_tr_b16 v[72:73], v13 offset:47136
    v_mfma_f32_16x16x32_bf16 v[116:119], v[36:39], v[28:31], v[116:119]
    ds_read_b64_tr_b16 v[74:75], v13 offset:48416
    v_mfma_f32_16x16x32_bf16 v[120:123], v[40:43], v[16:19], v[120:123]
    ds_read_b64_tr_b16 v[76:77], v12 offset:47168
    v_mfma_f32_16x16x32_bf16 v[124:127], v[40:43], v[20:23], v[124:127]
    ds_read_b64_tr_b16 v[78:79], v12 offset:48448
    v_mfma_f32_16x16x32_bf16 v[128:131], v[40:43], v[24:27], v[128:131]
    ds_read_b64_tr_b16 v[80:81], v13 offset:47200
    v_mfma_f32_16x16x32_bf16 v[132:135], v[40:43], v[28:31], v[132:135]
    ds_read_b64_tr_b16 v[82:83], v13 offset:48480
    v_mfma_f32_16x16x32_bf16 v[136:139], v[44:47], v[16:19], v[136:139]
    ds_read_b64_tr_b16 v[84:85], v12 offset:47232
    v_mfma_f32_16x16x32_bf16 v[140:143], v[44:47], v[20:23], v[140:143]
    ds_read_b64_tr_b16 v[86:87], v12 offset:48512
    v_mfma_f32_16x16x32_bf16 v[144:147], v[44:47], v[24:27], v[144:147]
    v_mfma_f32_16x16x32_bf16 v[148:151], v[44:47], v[28:31], v[148:151]
    v_mfma_f32_16x16x32_bf16 v[152:155], v[48:51], v[16:19], v[152:155]
    v_mfma_f32_16x16x32_bf16 v[156:159], v[48:51], v[20:23], v[156:159]
    v_mfma_f32_16x16x32_bf16 v[160:163], v[48:51], v[24:27], v[160:163]
    v_mfma_f32_16x16x32_bf16 v[164:167], v[48:51], v[28:31], v[164:167]
    s_waitcnt lgkmcnt(0)
    s_barrier
    v_mfma_f32_16x16x32_bf16 v[88:91], v[68:71], v[52:55], v[88:91]
    ds_read_b128 v[16:19], v6 offset:0
    v_mfma_f32_16x16x32_bf16 v[92:95], v[68:71], v[56:59], v[92:95]
    ds_read_b64_tr_b16 v[32:33], v8 offset:0
    v_mfma_f32_16x16x32_bf16 v[96:99], v[68:71], v[60:63], v[96:99]
    ds_read_b64_tr_b16 v[34:35], v8 offset:1280
    v_mfma_f32_16x16x32_bf16 v[100:103], v[68:71], v[64:67], v[100:103]
    ds_read_b128 v[20:23], v6 offset:2048
    v_mfma_f32_16x16x32_bf16 v[104:107], v[72:75], v[52:55], v[104:107]
    ds_read_b128 v[24:27], v6 offset:4096
    v_mfma_f32_16x16x32_bf16 v[108:111], v[72:75], v[56:59], v[108:111]
    ds_read_b128 v[28:31], v6 offset:6144
    v_mfma_f32_16x16x32_bf16 v[112:115], v[72:75], v[60:63], v[112:115]
    ds_read_b64_tr_b16 v[36:37], v9 offset:32
    v_mfma_f32_16x16x32_bf16 v[116:119], v[72:75], v[64:67], v[116:119]
    ds_read_b64_tr_b16 v[38:39], v9 offset:1312
    v_mfma_f32_16x16x32_bf16 v[120:123], v[76:79], v[52:55], v[120:123]
    ds_read_b64_tr_b16 v[40:41], v8 offset:64
    v_mfma_f32_16x16x32_bf16 v[124:127], v[76:79], v[56:59], v[124:127]
    ds_read_b64_tr_b16 v[42:43], v8 offset:1344
    v_mfma_f32_16x16x32_bf16 v[128:131], v[76:79], v[60:63], v[128:131]
    ds_read_b64_tr_b16 v[44:45], v9 offset:96
    v_mfma_f32_16x16x32_bf16 v[132:135], v[76:79], v[64:67], v[132:135]
    ds_read_b64_tr_b16 v[46:47], v9 offset:1376
    v_mfma_f32_16x16x32_bf16 v[136:139], v[80:83], v[52:55], v[136:139]
    ds_read_b64_tr_b16 v[48:49], v8 offset:128
    v_mfma_f32_16x16x32_bf16 v[140:143], v[80:83], v[56:59], v[140:143]
    ds_read_b64_tr_b16 v[50:51], v8 offset:1408
    v_mfma_f32_16x16x32_bf16 v[144:147], v[80:83], v[60:63], v[144:147]
    v_mfma_f32_16x16x32_bf16 v[148:151], v[80:83], v[64:67], v[148:151]
    v_mfma_f32_16x16x32_bf16 v[152:155], v[84:87], v[52:55], v[152:155]
    v_mfma_f32_16x16x32_bf16 v[156:159], v[84:87], v[56:59], v[156:159]
    v_mfma_f32_16x16x32_bf16 v[160:163], v[84:87], v[60:63], v[160:163]
    v_mfma_f32_16x16x32_bf16 v[164:167], v[84:87], v[64:67], v[164:167]
    s_waitcnt lgkmcnt(0)
    v_mfma_f32_16x16x32_bf16 v[88:91], v[32:35], v[16:19], v[88:91]
    ds_read_b128 v[52:55], v7 offset:0
    v_mfma_f32_16x16x32_bf16 v[92:95], v[32:35], v[20:23], v[92:95]
    ds_read_b64_tr_b16 v[68:69], v8 offset:10240
    v_mfma_f32_16x16x32_bf16 v[96:99], v[32:35], v[24:27], v[96:99]
    ds_read_b64_tr_b16 v[70:71], v8 offset:11520
    v_mfma_f32_16x16x32_bf16 v[100:103], v[32:35], v[28:31], v[100:103]
    ds_read_b128 v[56:59], v7 offset:2048
    v_mfma_f32_16x16x32_bf16 v[104:107], v[36:39], v[16:19], v[104:107]
    ds_read_b128 v[60:63], v7 offset:4096
    v_mfma_f32_16x16x32_bf16 v[108:111], v[36:39], v[20:23], v[108:111]
    ds_read_b128 v[64:67], v7 offset:6144
    v_mfma_f32_16x16x32_bf16 v[112:115], v[36:39], v[24:27], v[112:115]
    ds_read_b64_tr_b16 v[72:73], v9 offset:10272
    v_mfma_f32_16x16x32_bf16 v[116:119], v[36:39], v[28:31], v[116:119]
    ds_read_b64_tr_b16 v[74:75], v9 offset:11552
    v_mfma_f32_16x16x32_bf16 v[120:123], v[40:43], v[16:19], v[120:123]
    ds_read_b64_tr_b16 v[76:77], v8 offset:10304
    v_mfma_f32_16x16x32_bf16 v[124:127], v[40:43], v[20:23], v[124:127]
    ds_read_b64_tr_b16 v[78:79], v8 offset:11584
    v_mfma_f32_16x16x32_bf16 v[128:131], v[40:43], v[24:27], v[128:131]
    ds_read_b64_tr_b16 v[80:81], v9 offset:10336
    v_mfma_f32_16x16x32_bf16 v[132:135], v[40:43], v[28:31], v[132:135]
    ds_read_b64_tr_b16 v[82:83], v9 offset:11616
    v_mfma_f32_16x16x32_bf16 v[136:139], v[44:47], v[16:19], v[136:139]
    ds_read_b64_tr_b16 v[84:85], v8 offset:10368
    v_mfma_f32_16x16x32_bf16 v[140:143], v[44:47], v[20:23], v[140:143]
    ds_read_b64_tr_b16 v[86:87], v8 offset:11648
    v_mfma_f32_16x16x32_bf16 v[144:147], v[44:47], v[24:27], v[144:147]
    v_mfma_f32_16x16x32_bf16 v[148:151], v[44:47], v[28:31], v[148:151]
    v_mfma_f32_16x16x32_bf16 v[152:155], v[48:51], v[16:19], v[152:155]
    v_mfma_f32_16x16x32_bf16 v[156:159], v[48:51], v[20:23], v[156:159]
    v_mfma_f32_16x16x32_bf16 v[160:163], v[48:51], v[24:27], v[160:163]
    v_mfma_f32_16x16x32_bf16 v[164:167], v[48:51], v[28:31], v[164:167]
    s_waitcnt lgkmcnt(0)
    s_barrier
    v_mfma_f32_16x16x32_bf16 v[88:91], v[68:71], v[52:55], v[88:91]
    ds_read_b128 v[16:19], v6 offset:36864
    v_mfma_f32_16x16x32_bf16 v[92:95], v[68:71], v[56:59], v[92:95]
    ds_read_b64_tr_b16 v[32:33], v8 offset:36864
    v_mfma_f32_16x16x32_bf16 v[96:99], v[68:71], v[60:63], v[96:99]
    ds_read_b64_tr_b16 v[34:35], v8 offset:38144
    v_mfma_f32_16x16x32_bf16 v[100:103], v[68:71], v[64:67], v[100:103]
    ds_read_b128 v[20:23], v6 offset:38912
    v_mfma_f32_16x16x32_bf16 v[104:107], v[72:75], v[52:55], v[104:107]
    ds_read_b128 v[24:27], v6 offset:40960
    v_mfma_f32_16x16x32_bf16 v[108:111], v[72:75], v[56:59], v[108:111]
    ds_read_b128 v[28:31], v6 offset:43008
    v_mfma_f32_16x16x32_bf16 v[112:115], v[72:75], v[60:63], v[112:115]
    ds_read_b64_tr_b16 v[36:37], v9 offset:36896
    v_mfma_f32_16x16x32_bf16 v[116:119], v[72:75], v[64:67], v[116:119]
    ds_read_b64_tr_b16 v[38:39], v9 offset:38176
    v_mfma_f32_16x16x32_bf16 v[120:123], v[76:79], v[52:55], v[120:123]
    ds_read_b64_tr_b16 v[40:41], v8 offset:36928
    v_mfma_f32_16x16x32_bf16 v[124:127], v[76:79], v[56:59], v[124:127]
    ds_read_b64_tr_b16 v[42:43], v8 offset:38208
    v_mfma_f32_16x16x32_bf16 v[128:131], v[76:79], v[60:63], v[128:131]
    ds_read_b64_tr_b16 v[44:45], v9 offset:36960
    v_mfma_f32_16x16x32_bf16 v[132:135], v[76:79], v[64:67], v[132:135]
    ds_read_b64_tr_b16 v[46:47], v9 offset:38240
    v_mfma_f32_16x16x32_bf16 v[136:139], v[80:83], v[52:55], v[136:139]
    ds_read_b64_tr_b16 v[48:49], v8 offset:36992
    v_mfma_f32_16x16x32_bf16 v[140:143], v[80:83], v[56:59], v[140:143]
    ds_read_b64_tr_b16 v[50:51], v8 offset:38272
    v_mfma_f32_16x16x32_bf16 v[144:147], v[80:83], v[60:63], v[144:147]
    v_mfma_f32_16x16x32_bf16 v[148:151], v[80:83], v[64:67], v[148:151]
    v_mfma_f32_16x16x32_bf16 v[152:155], v[84:87], v[52:55], v[152:155]
    v_mfma_f32_16x16x32_bf16 v[156:159], v[84:87], v[56:59], v[156:159]
    v_mfma_f32_16x16x32_bf16 v[160:163], v[84:87], v[60:63], v[160:163]
    v_mfma_f32_16x16x32_bf16 v[164:167], v[84:87], v[64:67], v[164:167]
    s_waitcnt lgkmcnt(0)
    v_mfma_f32_16x16x32_bf16 v[88:91], v[32:35], v[16:19], v[88:91]
    ds_read_b128 v[52:55], v7 offset:36864
    v_mfma_f32_16x16x32_bf16 v[92:95], v[32:35], v[20:23], v[92:95]
    ds_read_b64_tr_b16 v[68:69], v8 offset:47104
    v_mfma_f32_16x16x32_bf16 v[96:99], v[32:35], v[24:27], v[96:99]
    ds_read_b64_tr_b16 v[70:71], v8 offset:48384
    v_mfma_f32_16x16x32_bf16 v[100:103], v[32:35], v[28:31], v[100:103]
    ds_read_b128 v[56:59], v7 offset:38912
    v_mfma_f32_16x16x32_bf16 v[104:107], v[36:39], v[16:19], v[104:107]
    ds_read_b128 v[60:63], v7 offset:40960
    v_mfma_f32_16x16x32_bf16 v[108:111], v[36:39], v[20:23], v[108:111]
    ds_read_b128 v[64:67], v7 offset:43008
    v_mfma_f32_16x16x32_bf16 v[112:115], v[36:39], v[24:27], v[112:115]
    ds_read_b64_tr_b16 v[72:73], v9 offset:47136
    v_mfma_f32_16x16x32_bf16 v[116:119], v[36:39], v[28:31], v[116:119]
    ds_read_b64_tr_b16 v[74:75], v9 offset:48416
    v_mfma_f32_16x16x32_bf16 v[120:123], v[40:43], v[16:19], v[120:123]
    ds_read_b64_tr_b16 v[76:77], v8 offset:47168
    v_mfma_f32_16x16x32_bf16 v[124:127], v[40:43], v[20:23], v[124:127]
    ds_read_b64_tr_b16 v[78:79], v8 offset:48448
    v_mfma_f32_16x16x32_bf16 v[128:131], v[40:43], v[24:27], v[128:131]
    ds_read_b64_tr_b16 v[80:81], v9 offset:47200
    v_mfma_f32_16x16x32_bf16 v[132:135], v[40:43], v[28:31], v[132:135]
    ds_read_b64_tr_b16 v[82:83], v9 offset:48480
    v_mfma_f32_16x16x32_bf16 v[136:139], v[44:47], v[16:19], v[136:139]
    ds_read_b64_tr_b16 v[84:85], v8 offset:47232
    v_mfma_f32_16x16x32_bf16 v[140:143], v[44:47], v[20:23], v[140:143]
    ds_read_b64_tr_b16 v[86:87], v8 offset:48512
    v_mfma_f32_16x16x32_bf16 v[144:147], v[44:47], v[24:27], v[144:147]
    v_mfma_f32_16x16x32_bf16 v[148:151], v[44:47], v[28:31], v[148:151]
    v_mfma_f32_16x16x32_bf16 v[152:155], v[48:51], v[16:19], v[152:155]
    v_mfma_f32_16x16x32_bf16 v[156:159], v[48:51], v[20:23], v[156:159]
    v_mfma_f32_16x16x32_bf16 v[160:163], v[48:51], v[24:27], v[160:163]
    v_mfma_f32_16x16x32_bf16 v[164:167], v[48:51], v[28:31], v[164:167]
    s_waitcnt lgkmcnt(0)
    s_barrier
    v_mfma_f32_16x16x32_bf16 v[88:91], v[68:71], v[52:55], v[88:91]
    ds_read_b128 v[16:19], v10 offset:0
    v_mfma_f32_16x16x32_bf16 v[92:95], v[68:71], v[56:59], v[92:95]
    ds_read_b64_tr_b16 v[32:33], v12 offset:0
    v_mfma_f32_16x16x32_bf16 v[96:99], v[68:71], v[60:63], v[96:99]
    ds_read_b64_tr_b16 v[34:35], v12 offset:1280
    v_mfma_f32_16x16x32_bf16 v[100:103], v[68:71], v[64:67], v[100:103]
    ds_read_b128 v[20:23], v10 offset:2048
    v_mfma_f32_16x16x32_bf16 v[104:107], v[72:75], v[52:55], v[104:107]
    ds_read_b128 v[24:27], v10 offset:4096
    v_mfma_f32_16x16x32_bf16 v[108:111], v[72:75], v[56:59], v[108:111]
    ds_read_b128 v[28:31], v10 offset:6144
    v_mfma_f32_16x16x32_bf16 v[112:115], v[72:75], v[60:63], v[112:115]
    ds_read_b64_tr_b16 v[36:37], v13 offset:32
    v_mfma_f32_16x16x32_bf16 v[116:119], v[72:75], v[64:67], v[116:119]
    ds_read_b64_tr_b16 v[38:39], v13 offset:1312
    v_mfma_f32_16x16x32_bf16 v[120:123], v[76:79], v[52:55], v[120:123]
    ds_read_b64_tr_b16 v[40:41], v12 offset:64
    v_mfma_f32_16x16x32_bf16 v[124:127], v[76:79], v[56:59], v[124:127]
    ds_read_b64_tr_b16 v[42:43], v12 offset:1344
    v_mfma_f32_16x16x32_bf16 v[128:131], v[76:79], v[60:63], v[128:131]
    ds_read_b64_tr_b16 v[44:45], v13 offset:96
    v_mfma_f32_16x16x32_bf16 v[132:135], v[76:79], v[64:67], v[132:135]
    ds_read_b64_tr_b16 v[46:47], v13 offset:1376
    v_mfma_f32_16x16x32_bf16 v[136:139], v[80:83], v[52:55], v[136:139]
    ds_read_b64_tr_b16 v[48:49], v12 offset:128
    v_mfma_f32_16x16x32_bf16 v[140:143], v[80:83], v[56:59], v[140:143]
    ds_read_b64_tr_b16 v[50:51], v12 offset:1408
    v_mfma_f32_16x16x32_bf16 v[144:147], v[80:83], v[60:63], v[144:147]
    v_mfma_f32_16x16x32_bf16 v[148:151], v[80:83], v[64:67], v[148:151]
    v_mfma_f32_16x16x32_bf16 v[152:155], v[84:87], v[52:55], v[152:155]
    v_mfma_f32_16x16x32_bf16 v[156:159], v[84:87], v[56:59], v[156:159]
    v_mfma_f32_16x16x32_bf16 v[160:163], v[84:87], v[60:63], v[160:163]
    v_mfma_f32_16x16x32_bf16 v[164:167], v[84:87], v[64:67], v[164:167]
    s_waitcnt lgkmcnt(0)
    v_mfma_f32_16x16x32_bf16 v[88:91], v[32:35], v[16:19], v[88:91]
    ds_read_b128 v[52:55], v11 offset:0
    v_mfma_f32_16x16x32_bf16 v[92:95], v[32:35], v[20:23], v[92:95]
    ds_read_b64_tr_b16 v[68:69], v12 offset:10240
    v_mfma_f32_16x16x32_bf16 v[96:99], v[32:35], v[24:27], v[96:99]
    ds_read_b64_tr_b16 v[70:71], v12 offset:11520
    v_mfma_f32_16x16x32_bf16 v[100:103], v[32:35], v[28:31], v[100:103]
    ds_read_b128 v[56:59], v11 offset:2048
    v_mfma_f32_16x16x32_bf16 v[104:107], v[36:39], v[16:19], v[104:107]
    ds_read_b128 v[60:63], v11 offset:4096
    v_mfma_f32_16x16x32_bf16 v[108:111], v[36:39], v[20:23], v[108:111]
    ds_read_b128 v[64:67], v11 offset:6144
    v_mfma_f32_16x16x32_bf16 v[112:115], v[36:39], v[24:27], v[112:115]
    ds_read_b64_tr_b16 v[72:73], v13 offset:10272
    v_mfma_f32_16x16x32_bf16 v[116:119], v[36:39], v[28:31], v[116:119]
    ds_read_b64_tr_b16 v[74:75], v13 offset:11552
    v_mfma_f32_16x16x32_bf16 v[120:123], v[40:43], v[16:19], v[120:123]
    ds_read_b64_tr_b16 v[76:77], v12 offset:10304
    v_mfma_f32_16x16x32_bf16 v[124:127], v[40:43], v[20:23], v[124:127]
    ds_read_b64_tr_b16 v[78:79], v12 offset:11584
    v_mfma_f32_16x16x32_bf16 v[128:131], v[40:43], v[24:27], v[128:131]
    ds_read_b64_tr_b16 v[80:81], v13 offset:10336
    v_mfma_f32_16x16x32_bf16 v[132:135], v[40:43], v[28:31], v[132:135]
    ds_read_b64_tr_b16 v[82:83], v13 offset:11616
    v_mfma_f32_16x16x32_bf16 v[136:139], v[44:47], v[16:19], v[136:139]
    ds_read_b64_tr_b16 v[84:85], v12 offset:10368
    v_mfma_f32_16x16x32_bf16 v[140:143], v[44:47], v[20:23], v[140:143]
    ds_read_b64_tr_b16 v[86:87], v12 offset:11648
    v_mfma_f32_16x16x32_bf16 v[144:147], v[44:47], v[24:27], v[144:147]
    v_mfma_f32_16x16x32_bf16 v[148:151], v[44:47], v[28:31], v[148:151]
    v_mfma_f32_16x16x32_bf16 v[152:155], v[48:51], v[16:19], v[152:155]
    v_mfma_f32_16x16x32_bf16 v[156:159], v[48:51], v[20:23], v[156:159]
    v_mfma_f32_16x16x32_bf16 v[160:163], v[48:51], v[24:27], v[160:163]
    v_mfma_f32_16x16x32_bf16 v[164:167], v[48:51], v[28:31], v[164:167]
    s_waitcnt lgkmcnt(0)
    s_barrier
    v_mfma_f32_16x16x32_bf16 v[88:91], v[68:71], v[52:55], v[88:91]
    ds_read_b128 v[16:19], v10 offset:36864
    v_mfma_f32_16x16x32_bf16 v[92:95], v[68:71], v[56:59], v[92:95]
    ds_read_b64_tr_b16 v[32:33], v12 offset:36864
    v_mfma_f32_16x16x32_bf16 v[96:99], v[68:71], v[60:63], v[96:99]
    ds_read_b64_tr_b16 v[34:35], v12 offset:38144
    v_mfma_f32_16x16x32_bf16 v[100:103], v[68:71], v[64:67], v[100:103]
    ds_read_b128 v[20:23], v10 offset:38912
    v_mfma_f32_16x16x32_bf16 v[104:107], v[72:75], v[52:55], v[104:107]
    ds_read_b128 v[24:27], v10 offset:40960
    v_mfma_f32_16x16x32_bf16 v[108:111], v[72:75], v[56:59], v[108:111]
    ds_read_b128 v[28:31], v10 offset:43008
    v_mfma_f32_16x16x32_bf16 v[112:115], v[72:75], v[60:63], v[112:115]
    ds_read_b64_tr_b16 v[36:37], v13 offset:36896
    v_mfma_f32_16x16x32_bf16 v[116:119], v[72:75], v[64:67], v[116:119]
    ds_read_b64_tr_b16 v[38:39], v13 offset:38176
    v_mfma_f32_16x16x32_bf16 v[120:123], v[76:79], v[52:55], v[120:123]
    ds_read_b64_tr_b16 v[40:41], v12 offset:36928
    v_mfma_f32_16x16x32_bf16 v[124:127], v[76:79], v[56:59], v[124:127]
    ds_read_b64_tr_b16 v[42:43], v12 offset:38208
    v_mfma_f32_16x16x32_bf16 v[128:131], v[76:79], v[60:63], v[128:131]
    ds_read_b64_tr_b16 v[44:45], v13 offset:36960
    v_mfma_f32_16x16x32_bf16 v[132:135], v[76:79], v[64:67], v[132:135]
    ds_read_b64_tr_b16 v[46:47], v13 offset:38240
    v_mfma_f32_16x16x32_bf16 v[136:139], v[80:83], v[52:55], v[136:139]
    ds_read_b64_tr_b16 v[48:49], v12 offset:36992
    v_mfma_f32_16x16x32_bf16 v[140:143], v[80:83], v[56:59], v[140:143]
    ds_read_b64_tr_b16 v[50:51], v12 offset:38272
    v_mfma_f32_16x16x32_bf16 v[144:147], v[80:83], v[60:63], v[144:147]
    v_mfma_f32_16x16x32_bf16 v[148:151], v[80:83], v[64:67], v[148:151]
    v_mfma_f32_16x16x32_bf16 v[152:155], v[84:87], v[52:55], v[152:155]
    v_mfma_f32_16x16x32_bf16 v[156:159], v[84:87], v[56:59], v[156:159]
    v_mfma_f32_16x16x32_bf16 v[160:163], v[84:87], v[60:63], v[160:163]
    v_mfma_f32_16x16x32_bf16 v[164:167], v[84:87], v[64:67], v[164:167]
    s_waitcnt lgkmcnt(0)
    v_mfma_f32_16x16x32_bf16 v[88:91], v[32:35], v[16:19], v[88:91]
    ds_read_b128 v[52:55], v11 offset:36864
    v_mfma_f32_16x16x32_bf16 v[92:95], v[32:35], v[20:23], v[92:95]
    ds_read_b64_tr_b16 v[68:69], v12 offset:47104
    v_mfma_f32_16x16x32_bf16 v[96:99], v[32:35], v[24:27], v[96:99]
    ds_read_b64_tr_b16 v[70:71], v12 offset:48384
    v_mfma_f32_16x16x32_bf16 v[100:103], v[32:35], v[28:31], v[100:103]
    ds_read_b128 v[56:59], v11 offset:38912
    v_mfma_f32_16x16x32_bf16 v[104:107], v[36:39], v[16:19], v[104:107]
    ds_read_b128 v[60:63], v11 offset:40960
    v_mfma_f32_16x16x32_bf16 v[108:111], v[36:39], v[20:23], v[108:111]
    ds_read_b128 v[64:67], v11 offset:43008
    v_mfma_f32_16x16x32_bf16 v[112:115], v[36:39], v[24:27], v[112:115]
    ds_read_b64_tr_b16 v[72:73], v13 offset:47136
    v_mfma_f32_16x16x32_bf16 v[116:119], v[36:39], v[28:31], v[116:119]
    ds_read_b64_tr_b16 v[74:75], v13 offset:48416
    v_mfma_f32_16x16x32_bf16 v[120:123], v[40:43], v[16:19], v[120:123]
    ds_read_b64_tr_b16 v[76:77], v12 offset:47168
    v_mfma_f32_16x16x32_bf16 v[124:127], v[40:43], v[20:23], v[124:127]
    ds_read_b64_tr_b16 v[78:79], v12 offset:48448
    v_mfma_f32_16x16x32_bf16 v[128:131], v[40:43], v[24:27], v[128:131]
    ds_read_b64_tr_b16 v[80:81], v13 offset:47200
    v_mfma_f32_16x16x32_bf16 v[132:135], v[40:43], v[28:31], v[132:135]
    ds_read_b64_tr_b16 v[82:83], v13 offset:48480
    v_mfma_f32_16x16x32_bf16 v[136:139], v[44:47], v[16:19], v[136:139]
    ds_read_b64_tr_b16 v[84:85], v12 offset:47232
    v_mfma_f32_16x16x32_bf16 v[140:143], v[44:47], v[20:23], v[140:143]
    ds_read_b64_tr_b16 v[86:87], v12 offset:48512
    v_mfma_f32_16x16x32_bf16 v[144:147], v[44:47], v[24:27], v[144:147]
    v_mfma_f32_16x16x32_bf16 v[148:151], v[44:47], v[28:31], v[148:151]
    v_mfma_f32_16x16x32_bf16 v[152:155], v[48:51], v[16:19], v[152:155]
    v_mfma_f32_16x16x32_bf16 v[156:159], v[48:51], v[20:23], v[156:159]
    v_mfma_f32_16x16x32_bf16 v[160:163], v[48:51], v[24:27], v[160:163]
    v_mfma_f32_16x16x32_bf16 v[164:167], v[48:51], v[28:31], v[164:167]
    s_waitcnt lgkmcnt(0)
    s_barrier
    v_mfma_f32_16x16x32_bf16 v[88:91], v[68:71], v[52:55], v[88:91]
    ds_read_b128 v[16:19], v6 offset:0
    v_mfma_f32_16x16x32_bf16 v[92:95], v[68:71], v[56:59], v[92:95]
    ds_read_b64_tr_b16 v[32:33], v8 offset:0
    v_mfma_f32_16x16x32_bf16 v[96:99], v[68:71], v[60:63], v[96:99]
    ds_read_b64_tr_b16 v[34:35], v8 offset:1280
    v_mfma_f32_16x16x32_bf16 v[100:103], v[68:71], v[64:67], v[100:103]
    ds_read_b128 v[20:23], v6 offset:2048
    v_mfma_f32_16x16x32_bf16 v[104:107], v[72:75], v[52:55], v[104:107]
    ds_read_b128 v[24:27], v6 offset:4096
    v_mfma_f32_16x16x32_bf16 v[108:111], v[72:75], v[56:59], v[108:111]
    ds_read_b128 v[28:31], v6 offset:6144
    v_mfma_f32_16x16x32_bf16 v[112:115], v[72:75], v[60:63], v[112:115]
    ds_read_b64_tr_b16 v[36:37], v9 offset:32
    v_mfma_f32_16x16x32_bf16 v[116:119], v[72:75], v[64:67], v[116:119]
    ds_read_b64_tr_b16 v[38:39], v9 offset:1312
    v_mfma_f32_16x16x32_bf16 v[120:123], v[76:79], v[52:55], v[120:123]
    ds_read_b64_tr_b16 v[40:41], v8 offset:64
    v_mfma_f32_16x16x32_bf16 v[124:127], v[76:79], v[56:59], v[124:127]
    ds_read_b64_tr_b16 v[42:43], v8 offset:1344
    v_mfma_f32_16x16x32_bf16 v[128:131], v[76:79], v[60:63], v[128:131]
    ds_read_b64_tr_b16 v[44:45], v9 offset:96
    v_mfma_f32_16x16x32_bf16 v[132:135], v[76:79], v[64:67], v[132:135]
    ds_read_b64_tr_b16 v[46:47], v9 offset:1376
    v_mfma_f32_16x16x32_bf16 v[136:139], v[80:83], v[52:55], v[136:139]
    ds_read_b64_tr_b16 v[48:49], v8 offset:128
    v_mfma_f32_16x16x32_bf16 v[140:143], v[80:83], v[56:59], v[140:143]
    ds_read_b64_tr_b16 v[50:51], v8 offset:1408
    v_mfma_f32_16x16x32_bf16 v[144:147], v[80:83], v[60:63], v[144:147]
    v_mfma_f32_16x16x32_bf16 v[148:151], v[80:83], v[64:67], v[148:151]
    v_mfma_f32_16x16x32_bf16 v[152:155], v[84:87], v[52:55], v[152:155]
    v_mfma_f32_16x16x32_bf16 v[156:159], v[84:87], v[56:59], v[156:159]
    v_mfma_f32_16x16x32_bf16 v[160:163], v[84:87], v[60:63], v[160:163]
    v_mfma_f32_16x16x32_bf16 v[164:167], v[84:87], v[64:67], v[164:167]
    s_waitcnt lgkmcnt(0)
    v_mfma_f32_16x16x32_bf16 v[88:91], v[32:35], v[16:19], v[88:91]
    ds_read_b128 v[52:55], v7 offset:0
    v_mfma_f32_16x16x32_bf16 v[92:95], v[32:35], v[20:23], v[92:95]
    ds_read_b64_tr_b16 v[68:69], v8 offset:10240
    v_mfma_f32_16x16x32_bf16 v[96:99], v[32:35], v[24:27], v[96:99]
    ds_read_b64_tr_b16 v[70:71], v8 offset:11520
    v_mfma_f32_16x16x32_bf16 v[100:103], v[32:35], v[28:31], v[100:103]
    ds_read_b128 v[56:59], v7 offset:2048
    v_mfma_f32_16x16x32_bf16 v[104:107], v[36:39], v[16:19], v[104:107]
    ds_read_b128 v[60:63], v7 offset:4096
    v_mfma_f32_16x16x32_bf16 v[108:111], v[36:39], v[20:23], v[108:111]
    ds_read_b128 v[64:67], v7 offset:6144
    v_mfma_f32_16x16x32_bf16 v[112:115], v[36:39], v[24:27], v[112:115]
    ds_read_b64_tr_b16 v[72:73], v9 offset:10272
    v_mfma_f32_16x16x32_bf16 v[116:119], v[36:39], v[28:31], v[116:119]
    ds_read_b64_tr_b16 v[74:75], v9 offset:11552
    v_mfma_f32_16x16x32_bf16 v[120:123], v[40:43], v[16:19], v[120:123]
    ds_read_b64_tr_b16 v[76:77], v8 offset:10304
    v_mfma_f32_16x16x32_bf16 v[124:127], v[40:43], v[20:23], v[124:127]
    ds_read_b64_tr_b16 v[78:79], v8 offset:11584
    v_mfma_f32_16x16x32_bf16 v[128:131], v[40:43], v[24:27], v[128:131]
    ds_read_b64_tr_b16 v[80:81], v9 offset:10336
    v_mfma_f32_16x16x32_bf16 v[132:135], v[40:43], v[28:31], v[132:135]
    ds_read_b64_tr_b16 v[82:83], v9 offset:11616
    v_mfma_f32_16x16x32_bf16 v[136:139], v[44:47], v[16:19], v[136:139]
    ds_read_b64_tr_b16 v[84:85], v8 offset:10368
    v_mfma_f32_16x16x32_bf16 v[140:143], v[44:47], v[20:23], v[140:143]
    ds_read_b64_tr_b16 v[86:87], v8 offset:11648
    v_mfma_f32_16x16x32_bf16 v[144:147], v[44:47], v[24:27], v[144:147]
    v_mfma_f32_16x16x32_bf16 v[148:151], v[44:47], v[28:31], v[148:151]
    v_mfma_f32_16x16x32_bf16 v[152:155], v[48:51], v[16:19], v[152:155]
    v_mfma_f32_16x16x32_bf16 v[156:159], v[48:51], v[20:23], v[156:159]
    v_mfma_f32_16x16x32_bf16 v[160:163], v[48:51], v[24:27], v[160:163]
    v_mfma_f32_16x16x32_bf16 v[164:167], v[48:51], v[28:31], v[164:167]
    s_waitcnt lgkmcnt(0)
    s_barrier
    v_mfma_f32_16x16x32_bf16 v[88:91], v[68:71], v[52:55], v[88:91]
    ds_read_b128 v[16:19], v6 offset:36864
    v_mfma_f32_16x16x32_bf16 v[92:95], v[68:71], v[56:59], v[92:95]
    ds_read_b64_tr_b16 v[32:33], v8 offset:36864
    v_mfma_f32_16x16x32_bf16 v[96:99], v[68:71], v[60:63], v[96:99]
    ds_read_b64_tr_b16 v[34:35], v8 offset:38144
    v_mfma_f32_16x16x32_bf16 v[100:103], v[68:71], v[64:67], v[100:103]
    ds_read_b128 v[20:23], v6 offset:38912
    v_mfma_f32_16x16x32_bf16 v[104:107], v[72:75], v[52:55], v[104:107]
    ds_read_b128 v[24:27], v6 offset:40960
    v_mfma_f32_16x16x32_bf16 v[108:111], v[72:75], v[56:59], v[108:111]
    ds_read_b128 v[28:31], v6 offset:43008
    v_mfma_f32_16x16x32_bf16 v[112:115], v[72:75], v[60:63], v[112:115]
    ds_read_b64_tr_b16 v[36:37], v9 offset:36896
    v_mfma_f32_16x16x32_bf16 v[116:119], v[72:75], v[64:67], v[116:119]
    ds_read_b64_tr_b16 v[38:39], v9 offset:38176
    v_mfma_f32_16x16x32_bf16 v[120:123], v[76:79], v[52:55], v[120:123]
    ds_read_b64_tr_b16 v[40:41], v8 offset:36928
    v_mfma_f32_16x16x32_bf16 v[124:127], v[76:79], v[56:59], v[124:127]
    ds_read_b64_tr_b16 v[42:43], v8 offset:38208
    v_mfma_f32_16x16x32_bf16 v[128:131], v[76:79], v[60:63], v[128:131]
    ds_read_b64_tr_b16 v[44:45], v9 offset:36960
    v_mfma_f32_16x16x32_bf16 v[132:135], v[76:79], v[64:67], v[132:135]
    ds_read_b64_tr_b16 v[46:47], v9 offset:38240
    v_mfma_f32_16x16x32_bf16 v[136:139], v[80:83], v[52:55], v[136:139]
    ds_read_b64_tr_b16 v[48:49], v8 offset:36992
    v_mfma_f32_16x16x32_bf16 v[140:143], v[80:83], v[56:59], v[140:143]
    ds_read_b64_tr_b16 v[50:51], v8 offset:38272
    v_mfma_f32_16x16x32_bf16 v[144:147], v[80:83], v[60:63], v[144:147]
    v_mfma_f32_16x16x32_bf16 v[148:151], v[80:83], v[64:67], v[148:151]
    v_mfma_f32_16x16x32_bf16 v[152:155], v[84:87], v[52:55], v[152:155]
    v_mfma_f32_16x16x32_bf16 v[156:159], v[84:87], v[56:59], v[156:159]
    v_mfma_f32_16x16x32_bf16 v[160:163], v[84:87], v[60:63], v[160:163]
    v_mfma_f32_16x16x32_bf16 v[164:167], v[84:87], v[64:67], v[164:167]
    s_waitcnt lgkmcnt(0)
    v_mfma_f32_16x16x32_bf16 v[88:91], v[32:35], v[16:19], v[88:91]
    ds_read_b128 v[52:55], v7 offset:36864
    v_mfma_f32_16x16x32_bf16 v[92:95], v[32:35], v[20:23], v[92:95]
    ds_read_b64_tr_b16 v[68:69], v8 offset:47104
    v_mfma_f32_16x16x32_bf16 v[96:99], v[32:35], v[24:27], v[96:99]
    ds_read_b64_tr_b16 v[70:71], v8 offset:48384
    v_mfma_f32_16x16x32_bf16 v[100:103], v[32:35], v[28:31], v[100:103]
    ds_read_b128 v[56:59], v7 offset:38912
    v_mfma_f32_16x16x32_bf16 v[104:107], v[36:39], v[16:19], v[104:107]
    ds_read_b128 v[60:63], v7 offset:40960
    v_mfma_f32_16x16x32_bf16 v[108:111], v[36:39], v[20:23], v[108:111]
    ds_read_b128 v[64:67], v7 offset:43008
    v_mfma_f32_16x16x32_bf16 v[112:115], v[36:39], v[24:27], v[112:115]
    ds_read_b64_tr_b16 v[72:73], v9 offset:47136
    v_mfma_f32_16x16x32_bf16 v[116:119], v[36:39], v[28:31], v[116:119]
    ds_read_b64_tr_b16 v[74:75], v9 offset:48416
    v_mfma_f32_16x16x32_bf16 v[120:123], v[40:43], v[16:19], v[120:123]
    ds_read_b64_tr_b16 v[76:77], v8 offset:47168
    v_mfma_f32_16x16x32_bf16 v[124:127], v[40:43], v[20:23], v[124:127]
    ds_read_b64_tr_b16 v[78:79], v8 offset:48448
    v_mfma_f32_16x16x32_bf16 v[128:131], v[40:43], v[24:27], v[128:131]
    ds_read_b64_tr_b16 v[80:81], v9 offset:47200
    v_mfma_f32_16x16x32_bf16 v[132:135], v[40:43], v[28:31], v[132:135]
    ds_read_b64_tr_b16 v[82:83], v9 offset:48480
    v_mfma_f32_16x16x32_bf16 v[136:139], v[44:47], v[16:19], v[136:139]
    ds_read_b64_tr_b16 v[84:85], v8 offset:47232
    v_mfma_f32_16x16x32_bf16 v[140:143], v[44:47], v[20:23], v[140:143]
    ds_read_b64_tr_b16 v[86:87], v8 offset:48512
    v_mfma_f32_16x16x32_bf16 v[144:147], v[44:47], v[24:27], v[144:147]
    v_mfma_f32_16x16x32_bf16 v[148:151], v[44:47], v[28:31], v[148:151]
    v_mfma_f32_16x16x32_bf16 v[152:155], v[48:51], v[16:19], v[152:155]
    v_mfma_f32_16x16x32_bf16 v[156:159], v[48:51], v[20:23], v[156:159]
    v_mfma_f32_16x16x32_bf16 v[160:163], v[48:51], v[24:27], v[160:163]
    v_mfma_f32_16x16x32_bf16 v[164:167], v[48:51], v[28:31], v[164:167]
    s_waitcnt lgkmcnt(0)
    v_mfma_f32_16x16x32_bf16 v[88:91], v[68:71], v[52:55], v[88:91]
    v_mfma_f32_16x16x32_bf16 v[92:95], v[68:71], v[56:59], v[92:95]
    v_mfma_f32_16x16x32_bf16 v[96:99], v[68:71], v[60:63], v[96:99]
    v_mfma_f32_16x16x32_bf16 v[100:103], v[68:71], v[64:67], v[100:103]
    v_mfma_f32_16x16x32_bf16 v[104:107], v[72:75], v[52:55], v[104:107]
    v_mfma_f32_16x16x32_bf16 v[108:111], v[72:75], v[56:59], v[108:111]
    v_mfma_f32_16x16x32_bf16 v[112:115], v[72:75], v[60:63], v[112:115]
    v_mfma_f32_16x16x32_bf16 v[116:119], v[72:75], v[64:67], v[116:119]
    v_mfma_f32_16x16x32_bf16 v[120:123], v[76:79], v[52:55], v[120:123]
    v_mfma_f32_16x16x32_bf16 v[124:127], v[76:79], v[56:59], v[124:127]
    v_mfma_f32_16x16x32_bf16 v[128:131], v[76:79], v[60:63], v[128:131]
    v_mfma_f32_16x16x32_bf16 v[132:135], v[76:79], v[64:67], v[132:135]
    v_mfma_f32_16x16x32_bf16 v[136:139], v[80:83], v[52:55], v[136:139]
    v_mfma_f32_16x16x32_bf16 v[140:143], v[80:83], v[56:59], v[140:143]
    v_mfma_f32_16x16x32_bf16 v[144:147], v[80:83], v[60:63], v[144:147]
    v_mfma_f32_16x16x32_bf16 v[148:151], v[80:83], v[64:67], v[148:151]
    v_mfma_f32_16x16x32_bf16 v[152:155], v[84:87], v[52:55], v[152:155]
    v_mfma_f32_16x16x32_bf16 v[156:159], v[84:87], v[56:59], v[156:159]
    v_mfma_f32_16x16x32_bf16 v[160:163], v[84:87], v[60:63], v[160:163]
    v_mfma_f32_16x16x32_bf16 v[164:167], v[84:87], v[64:67], v[164:167]
    v_mov_b32 v3, 161792
    v_mov_b32 v4, 1
    s_mov_b64 exec, 1
    ds_add_u32 v3, v4 offset:128
    s_mov_b64 exec, -1
    v_cvt_pk_bf16_f32 v16, v88, v89
    v_cvt_pk_bf16_f32 v17, v90, v91
    v_cvt_pk_bf16_f32 v18, v92, v93
    v_cvt_pk_bf16_f32 v19, v94, v95
    v_cvt_pk_bf16_f32 v20, v96, v97
    v_cvt_pk_bf16_f32 v21, v98, v99
    v_cvt_pk_bf16_f32 v22, v100, v101
    v_cvt_pk_bf16_f32 v23, v102, v103
    v_permlane16_swap_b32 v16, v18
    v_permlane16_swap_b32 v17, v19
    buffer_store_dwordx4 v[16:19], v14, s[20:23], s36 offen offset:0 sc1
    v_cvt_pk_bf16_f32 v24, v104, v105
    v_cvt_pk_bf16_f32 v25, v106, v107
    v_cvt_pk_bf16_f32 v26, v108, v109
    v_cvt_pk_bf16_f32 v27, v110, v111
    v_permlane16_swap_b32 v20, v22
    v_permlane16_swap_b32 v21, v23
    buffer_store_dwordx4 v[20:23], v14, s[20:23], s36 offen offset:512 sc1
    s_add_u32 s36, s36, 4096
    v_cvt_pk_bf16_f32 v28, v112, v113
    v_cvt_pk_bf16_f32 v29, v114, v115
    v_cvt_pk_bf16_f32 v30, v116, v117
    v_cvt_pk_bf16_f32 v31, v118, v119
    v_permlane16_swap_b32 v24, v26
    v_permlane16_swap_b32 v25, v27
    buffer_store_dwordx4 v[24:27], v14, s[20:23], s36 offen offset:0 sc1
    v_cvt_pk_bf16_f32 v32, v120, v121
    v_cvt_pk_bf16_f32 v33, v122, v123
    v_cvt_pk_bf16_f32 v34, v124, v125
    v_cvt_pk_bf16_f32 v35, v126, v127
    v_permlane16_swap_b32 v28, v30
    v_permlane16_swap_b32 v29, v31
    buffer_store_dwordx4 v[28:31], v14, s[20:23], s36 offen offset:512 sc1
    s_add_u32 s36, s36, 4096
    v_cvt_pk_bf16_f32 v36, v128, v129
    v_cvt_pk_bf16_f32 v37, v130, v131
    v_cvt_pk_bf16_f32 v38, v132, v133
    v_cvt_pk_bf16_f32 v39, v134, v135
    v_permlane16_swap_b32 v32, v34
    v_permlane16_swap_b32 v33, v35
    buffer_store_dwordx4 v[32:35], v14, s[20:23], s36 offen offset:0 sc1
    v_cvt_pk_bf16_f32 v40, v136, v137
    v_cvt_pk_bf16_f32 v41, v138, v139
    v_cvt_pk_bf16_f32 v42, v140, v141
    v_cvt_pk_bf16_f32 v43, v142, v143
    v_permlane16_swap_b32 v36, v38
    v_permlane16_swap_b32 v37, v39
    buffer_store_dwordx4 v[36:39], v14, s[20:23], s36 offen offset:512 sc1
    s_add_u32 s36, s36, 4096
    v_cvt_pk_bf16_f32 v44, v144, v145
    v_cvt_pk_bf16_f32 v45, v146, v147
    v_cvt_pk_bf16_f32 v46, v148, v149
    v_cvt_pk_bf16_f32 v47, v150, v151
    v_permlane16_swap_b32 v40, v42
    v_permlane16_swap_b32 v41, v43
    buffer_store_dwordx4 v[40:43], v14, s[20:23], s36 offen offset:0 sc1
    v_cvt_pk_bf16_f32 v48, v152, v153
    v_cvt_pk_bf16_f32 v49, v154, v155
    v_cvt_pk_bf16_f32 v50, v156, v157
    v_cvt_pk_bf16_f32 v51, v158, v159
    v_permlane16_swap_b32 v44, v46
    v_permlane16_swap_b32 v45, v47
    buffer_store_dwordx4 v[44:47], v14, s[20:23], s36 offen offset:512 sc1
    s_add_u32 s36, s36, 4096
    v_cvt_pk_bf16_f32 v52, v160, v161
    v_cvt_pk_bf16_f32 v53, v162, v163
    v_cvt_pk_bf16_f32 v54, v164, v165
    v_cvt_pk_bf16_f32 v55, v166, v167
    v_permlane16_swap_b32 v48, v50
    v_permlane16_swap_b32 v49, v51
    buffer_store_dwordx4 v[48:51], v14, s[20:23], s36 offen offset:0 sc1
    s_nop 1
    v_permlane16_swap_b32 v52, v54
    v_permlane16_swap_b32 v53, v55
    buffer_store_dwordx4 v[52:55], v14, s[20:23], s36 offen offset:512 sc1
    s_add_u32 s36, s36, 4096
    s_branch .a_signal
.a_vpath:
    v_mul_u32_u24 v14, 10240, v4
    v_lshl_add_u32 v14, v3, 4, v14
    s_lshl_b32 s36, s26, 1
    s_add_u32 s36, s36, s29
    s_mul_i32 s36, s36, 81920
    s_sub_u32 s37, s27, 8
    s_lshl_b32 s37, s37, 1
    s_add_u32 s37, s37, s30
    s_mulk_i32 s37, 1280
    s_add_u32 s36, s36, s37
    s_add_u32 s36, s36, 7864320
    s_add_u32 s37, s36, 40960
    s_waitcnt lgkmcnt(0)
    s_mov_b32 s20, s8
    s_mov_b32 s21, s9
    s_barrier
    ds_read_b128 v[16:19], v6 offset:0
    ds_read_b64_tr_b16 v[32:33], v8 offset:0
    ds_read_b64_tr_b16 v[34:35], v8 offset:1280
    ds_read_b128 v[20:23], v6 offset:2048
    ds_read_b128 v[24:27], v6 offset:4096
    ds_read_b128 v[28:31], v6 offset:6144
    ds_read_b64_tr_b16 v[36:37], v9 offset:32
    ds_read_b64_tr_b16 v[38:39], v9 offset:1312
    ds_read_b64_tr_b16 v[40:41], v8 offset:64
    ds_read_b64_tr_b16 v[42:43], v8 offset:1344
    ds_read_b64_tr_b16 v[44:45], v9 offset:96
    ds_read_b64_tr_b16 v[46:47], v9 offset:1376
    ds_read_b64_tr_b16 v[48:49], v8 offset:128
    ds_read_b64_tr_b16 v[50:51], v8 offset:1408
    s_waitcnt lgkmcnt(0)
    v_mfma_f32_16x16x32_bf16 v[88:91], v[16:19], v[32:35], 0
    ds_read_b128 v[52:55], v7 offset:0
    v_mfma_f32_16x16x32_bf16 v[92:95], v[20:23], v[32:35], 0
    ds_read_b64_tr_b16 v[68:69], v8 offset:10240
    v_mfma_f32_16x16x32_bf16 v[96:99], v[24:27], v[32:35], 0
    ds_read_b64_tr_b16 v[70:71], v8 offset:11520
    v_mfma_f32_16x16x32_bf16 v[100:103], v[28:31], v[32:35], 0
    ds_read_b128 v[56:59], v7 offset:2048
    v_mfma_f32_16x16x32_bf16 v[104:107], v[16:19], v[36:39], 0
    ds_read_b128 v[60:63], v7 offset:4096
    v_mfma_f32_16x16x32_bf16 v[108:111], v[20:23], v[36:39], 0
    ds_read_b128 v[64:67], v7 offset:6144
    v_mfma_f32_16x16x32_bf16 v[112:115], v[24:27], v[36:39], 0
    ds_read_b64_tr_b16 v[72:73], v9 offset:10272
    v_mfma_f32_16x16x32_bf16 v[116:119], v[28:31], v[36:39], 0
    ds_read_b64_tr_b16 v[74:75], v9 offset:11552
    v_mfma_f32_16x16x32_bf16 v[120:123], v[16:19], v[40:43], 0
    ds_read_b64_tr_b16 v[76:77], v8 offset:10304
    v_mfma_f32_16x16x32_bf16 v[124:127], v[20:23], v[40:43], 0
    ds_read_b64_tr_b16 v[78:79], v8 offset:11584
    v_mfma_f32_16x16x32_bf16 v[128:131], v[24:27], v[40:43], 0
    ds_read_b64_tr_b16 v[80:81], v9 offset:10336
    v_mfma_f32_16x16x32_bf16 v[132:135], v[28:31], v[40:43], 0
    ds_read_b64_tr_b16 v[82:83], v9 offset:11616
    v_mfma_f32_16x16x32_bf16 v[136:139], v[16:19], v[44:47], 0
    ds_read_b64_tr_b16 v[84:85], v8 offset:10368
    v_mfma_f32_16x16x32_bf16 v[140:143], v[20:23], v[44:47], 0
    ds_read_b64_tr_b16 v[86:87], v8 offset:11648
    v_mfma_f32_16x16x32_bf16 v[144:147], v[24:27], v[44:47], 0
    v_mfma_f32_16x16x32_bf16 v[148:151], v[28:31], v[44:47], 0
    v_mfma_f32_16x16x32_bf16 v[152:155], v[16:19], v[48:51], 0
    v_mfma_f32_16x16x32_bf16 v[156:159], v[20:23], v[48:51], 0
    v_mfma_f32_16x16x32_bf16 v[160:163], v[24:27], v[48:51], 0
    v_mfma_f32_16x16x32_bf16 v[164:167], v[28:31], v[48:51], 0
    s_waitcnt lgkmcnt(0)
    s_barrier
    v_mfma_f32_16x16x32_bf16 v[88:91], v[52:55], v[68:71], v[88:91]
    ds_read_b128 v[16:19], v6 offset:36864
    v_mfma_f32_16x16x32_bf16 v[92:95], v[56:59], v[68:71], v[92:95]
    ds_read_b64_tr_b16 v[32:33], v8 offset:36864
    v_mfma_f32_16x16x32_bf16 v[96:99], v[60:63], v[68:71], v[96:99]
    ds_read_b64_tr_b16 v[34:35], v8 offset:38144
    v_mfma_f32_16x16x32_bf16 v[100:103], v[64:67], v[68:71], v[100:103]
    ds_read_b128 v[20:23], v6 offset:38912
    v_mfma_f32_16x16x32_bf16 v[104:107], v[52:55], v[72:75], v[104:107]
    ds_read_b128 v[24:27], v6 offset:40960
    v_mfma_f32_16x16x32_bf16 v[108:111], v[56:59], v[72:75], v[108:111]
    ds_read_b128 v[28:31], v6 offset:43008
    v_mfma_f32_16x16x32_bf16 v[112:115], v[60:63], v[72:75], v[112:115]
    ds_read_b64_tr_b16 v[36:37], v9 offset:36896
    v_mfma_f32_16x16x32_bf16 v[116:119], v[64:67], v[72:75], v[116:119]
    ds_read_b64_tr_b16 v[38:39], v9 offset:38176
    v_mfma_f32_16x16x32_bf16 v[120:123], v[52:55], v[76:79], v[120:123]
    ds_read_b64_tr_b16 v[40:41], v8 offset:36928
    v_mfma_f32_16x16x32_bf16 v[124:127], v[56:59], v[76:79], v[124:127]
    ds_read_b64_tr_b16 v[42:43], v8 offset:38208
    v_mfma_f32_16x16x32_bf16 v[128:131], v[60:63], v[76:79], v[128:131]
    ds_read_b64_tr_b16 v[44:45], v9 offset:36960
    v_mfma_f32_16x16x32_bf16 v[132:135], v[64:67], v[76:79], v[132:135]
    ds_read_b64_tr_b16 v[46:47], v9 offset:38240
    v_mfma_f32_16x16x32_bf16 v[136:139], v[52:55], v[80:83], v[136:139]
    ds_read_b64_tr_b16 v[48:49], v8 offset:36992
    v_mfma_f32_16x16x32_bf16 v[140:143], v[56:59], v[80:83], v[140:143]
    ds_read_b64_tr_b16 v[50:51], v8 offset:38272
    v_mfma_f32_16x16x32_bf16 v[144:147], v[60:63], v[80:83], v[144:147]
    v_mfma_f32_16x16x32_bf16 v[148:151], v[64:67], v[80:83], v[148:151]
    v_mfma_f32_16x16x32_bf16 v[152:155], v[52:55], v[84:87], v[152:155]
    v_mfma_f32_16x16x32_bf16 v[156:159], v[56:59], v[84:87], v[156:159]
    v_mfma_f32_16x16x32_bf16 v[160:163], v[60:63], v[84:87], v[160:163]
    v_mfma_f32_16x16x32_bf16 v[164:167], v[64:67], v[84:87], v[164:167]
    s_waitcnt lgkmcnt(0)
    v_mfma_f32_16x16x32_bf16 v[88:91], v[16:19], v[32:35], v[88:91]
    ds_read_b128 v[52:55], v7 offset:36864
    v_mfma_f32_16x16x32_bf16 v[92:95], v[20:23], v[32:35], v[92:95]
    ds_read_b64_tr_b16 v[68:69], v8 offset:47104
    v_mfma_f32_16x16x32_bf16 v[96:99], v[24:27], v[32:35], v[96:99]
    ds_read_b64_tr_b16 v[70:71], v8 offset:48384
    v_mfma_f32_16x16x32_bf16 v[100:103], v[28:31], v[32:35], v[100:103]
    ds_read_b128 v[56:59], v7 offset:38912
    v_mfma_f32_16x16x32_bf16 v[104:107], v[16:19], v[36:39], v[104:107]
    ds_read_b128 v[60:63], v7 offset:40960
    v_mfma_f32_16x16x32_bf16 v[108:111], v[20:23], v[36:39], v[108:111]
    ds_read_b128 v[64:67], v7 offset:43008
    v_mfma_f32_16x16x32_bf16 v[112:115], v[24:27], v[36:39], v[112:115]
    ds_read_b64_tr_b16 v[72:73], v9 offset:47136
    v_mfma_f32_16x16x32_bf16 v[116:119], v[28:31], v[36:39], v[116:119]
    ds_read_b64_tr_b16 v[74:75], v9 offset:48416
    v_mfma_f32_16x16x32_bf16 v[120:123], v[16:19], v[40:43], v[120:123]
    ds_read_b64_tr_b16 v[76:77], v8 offset:47168
    v_mfma_f32_16x16x32_bf16 v[124:127], v[20:23], v[40:43], v[124:127]
    ds_read_b64_tr_b16 v[78:79], v8 offset:48448
    v_mfma_f32_16x16x32_bf16 v[128:131], v[24:27], v[40:43], v[128:131]
    ds_read_b64_tr_b16 v[80:81], v9 offset:47200
    v_mfma_f32_16x16x32_bf16 v[132:135], v[28:31], v[40:43], v[132:135]
    ds_read_b64_tr_b16 v[82:83], v9 offset:48480
    v_mfma_f32_16x16x32_bf16 v[136:139], v[16:19], v[44:47], v[136:139]
    ds_read_b64_tr_b16 v[84:85], v8 offset:47232
    v_mfma_f32_16x16x32_bf16 v[140:143], v[20:23], v[44:47], v[140:143]
    ds_read_b64_tr_b16 v[86:87], v8 offset:48512
    v_mfma_f32_16x16x32_bf16 v[144:147], v[24:27], v[44:47], v[144:147]
    v_mfma_f32_16x16x32_bf16 v[148:151], v[28:31], v[44:47], v[148:151]
    v_mfma_f32_16x16x32_bf16 v[152:155], v[16:19], v[48:51], v[152:155]
    v_mfma_f32_16x16x32_bf16 v[156:159], v[20:23], v[48:51], v[156:159]
    v_mfma_f32_16x16x32_bf16 v[160:163], v[24:27], v[48:51], v[160:163]
    v_mfma_f32_16x16x32_bf16 v[164:167], v[28:31], v[48:51], v[164:167]
    s_waitcnt lgkmcnt(0)
    s_barrier
    v_mfma_f32_16x16x32_bf16 v[88:91], v[52:55], v[68:71], v[88:91]
    ds_read_b128 v[16:19], v10 offset:0
    v_mfma_f32_16x16x32_bf16 v[92:95], v[56:59], v[68:71], v[92:95]
    ds_read_b64_tr_b16 v[32:33], v12 offset:0
    v_mfma_f32_16x16x32_bf16 v[96:99], v[60:63], v[68:71], v[96:99]
    ds_read_b64_tr_b16 v[34:35], v12 offset:1280
    v_mfma_f32_16x16x32_bf16 v[100:103], v[64:67], v[68:71], v[100:103]
    ds_read_b128 v[20:23], v10 offset:2048
    v_mfma_f32_16x16x32_bf16 v[104:107], v[52:55], v[72:75], v[104:107]
    ds_read_b128 v[24:27], v10 offset:4096
    v_mfma_f32_16x16x32_bf16 v[108:111], v[56:59], v[72:75], v[108:111]
    ds_read_b128 v[28:31], v10 offset:6144
    v_mfma_f32_16x16x32_bf16 v[112:115], v[60:63], v[72:75], v[112:115]
    ds_read_b64_tr_b16 v[36:37], v13 offset:32
    v_mfma_f32_16x16x32_bf16 v[116:119], v[64:67], v[72:75], v[116:119]
    ds_read_b64_tr_b16 v[38:39], v13 offset:1312
    v_mfma_f32_16x16x32_bf16 v[120:123], v[52:55], v[76:79], v[120:123]
    ds_read_b64_tr_b16 v[40:41], v12 offset:64
    v_mfma_f32_16x16x32_bf16 v[124:127], v[56:59], v[76:79], v[124:127]
    ds_read_b64_tr_b16 v[42:43], v12 offset:1344
    v_mfma_f32_16x16x32_bf16 v[128:131], v[60:63], v[76:79], v[128:131]
    ds_read_b64_tr_b16 v[44:45], v13 offset:96
    v_mfma_f32_16x16x32_bf16 v[132:135], v[64:67], v[76:79], v[132:135]
    ds_read_b64_tr_b16 v[46:47], v13 offset:1376
    v_mfma_f32_16x16x32_bf16 v[136:139], v[52:55], v[80:83], v[136:139]
    ds_read_b64_tr_b16 v[48:49], v12 offset:128
    v_mfma_f32_16x16x32_bf16 v[140:143], v[56:59], v[80:83], v[140:143]
    ds_read_b64_tr_b16 v[50:51], v12 offset:1408
    v_mfma_f32_16x16x32_bf16 v[144:147], v[60:63], v[80:83], v[144:147]
    v_mfma_f32_16x16x32_bf16 v[148:151], v[64:67], v[80:83], v[148:151]
    v_mfma_f32_16x16x32_bf16 v[152:155], v[52:55], v[84:87], v[152:155]
    v_mfma_f32_16x16x32_bf16 v[156:159], v[56:59], v[84:87], v[156:159]
    v_mfma_f32_16x16x32_bf16 v[160:163], v[60:63], v[84:87], v[160:163]
    v_mfma_f32_16x16x32_bf16 v[164:167], v[64:67], v[84:87], v[164:167]
    s_waitcnt lgkmcnt(0)
    v_mfma_f32_16x16x32_bf16 v[88:91], v[16:19], v[32:35], v[88:91]
    ds_read_b128 v[52:55], v11 offset:0
    v_mfma_f32_16x16x32_bf16 v[92:95], v[20:23], v[32:35], v[92:95]
    ds_read_b64_tr_b16 v[68:69], v12 offset:10240
    v_mfma_f32_16x16x32_bf16 v[96:99], v[24:27], v[32:35], v[96:99]
    ds_read_b64_tr_b16 v[70:71], v12 offset:11520
    v_mfma_f32_16x16x32_bf16 v[100:103], v[28:31], v[32:35], v[100:103]
    ds_read_b128 v[56:59], v11 offset:2048
    v_mfma_f32_16x16x32_bf16 v[104:107], v[16:19], v[36:39], v[104:107]
    ds_read_b128 v[60:63], v11 offset:4096
    v_mfma_f32_16x16x32_bf16 v[108:111], v[20:23], v[36:39], v[108:111]
    ds_read_b128 v[64:67], v11 offset:6144
    v_mfma_f32_16x16x32_bf16 v[112:115], v[24:27], v[36:39], v[112:115]
    ds_read_b64_tr_b16 v[72:73], v13 offset:10272
    v_mfma_f32_16x16x32_bf16 v[116:119], v[28:31], v[36:39], v[116:119]
    ds_read_b64_tr_b16 v[74:75], v13 offset:11552
    v_mfma_f32_16x16x32_bf16 v[120:123], v[16:19], v[40:43], v[120:123]
    ds_read_b64_tr_b16 v[76:77], v12 offset:10304
    v_mfma_f32_16x16x32_bf16 v[124:127], v[20:23], v[40:43], v[124:127]
    ds_read_b64_tr_b16 v[78:79], v12 offset:11584
    v_mfma_f32_16x16x32_bf16 v[128:131], v[24:27], v[40:43], v[128:131]
    ds_read_b64_tr_b16 v[80:81], v13 offset:10336
    v_mfma_f32_16x16x32_bf16 v[132:135], v[28:31], v[40:43], v[132:135]
    ds_read_b64_tr_b16 v[82:83], v13 offset:11616
    v_mfma_f32_16x16x32_bf16 v[136:139], v[16:19], v[44:47], v[136:139]
    ds_read_b64_tr_b16 v[84:85], v12 offset:10368
    v_mfma_f32_16x16x32_bf16 v[140:143], v[20:23], v[44:47], v[140:143]
    ds_read_b64_tr_b16 v[86:87], v12 offset:11648
    v_mfma_f32_16x16x32_bf16 v[144:147], v[24:27], v[44:47], v[144:147]
    v_mfma_f32_16x16x32_bf16 v[148:151], v[28:31], v[44:47], v[148:151]
    v_mfma_f32_16x16x32_bf16 v[152:155], v[16:19], v[48:51], v[152:155]
    v_mfma_f32_16x16x32_bf16 v[156:159], v[20:23], v[48:51], v[156:159]
    v_mfma_f32_16x16x32_bf16 v[160:163], v[24:27], v[48:51], v[160:163]
    v_mfma_f32_16x16x32_bf16 v[164:167], v[28:31], v[48:51], v[164:167]
    s_waitcnt lgkmcnt(0)
    s_barrier
    v_mfma_f32_16x16x32_bf16 v[88:91], v[52:55], v[68:71], v[88:91]
    ds_read_b128 v[16:19], v10 offset:36864
    v_mfma_f32_16x16x32_bf16 v[92:95], v[56:59], v[68:71], v[92:95]
    ds_read_b64_tr_b16 v[32:33], v12 offset:36864
    v_mfma_f32_16x16x32_bf16 v[96:99], v[60:63], v[68:71], v[96:99]
    ds_read_b64_tr_b16 v[34:35], v12 offset:38144
    v_mfma_f32_16x16x32_bf16 v[100:103], v[64:67], v[68:71], v[100:103]
    ds_read_b128 v[20:23], v10 offset:38912
    v_mfma_f32_16x16x32_bf16 v[104:107], v[52:55], v[72:75], v[104:107]
    ds_read_b128 v[24:27], v10 offset:40960
    v_mfma_f32_16x16x32_bf16 v[108:111], v[56:59], v[72:75], v[108:111]
    ds_read_b128 v[28:31], v10 offset:43008
    v_mfma_f32_16x16x32_bf16 v[112:115], v[60:63], v[72:75], v[112:115]
    ds_read_b64_tr_b16 v[36:37], v13 offset:36896
    v_mfma_f32_16x16x32_bf16 v[116:119], v[64:67], v[72:75], v[116:119]
    ds_read_b64_tr_b16 v[38:39], v13 offset:38176
    v_mfma_f32_16x16x32_bf16 v[120:123], v[52:55], v[76:79], v[120:123]
    ds_read_b64_tr_b16 v[40:41], v12 offset:36928
    v_mfma_f32_16x16x32_bf16 v[124:127], v[56:59], v[76:79], v[124:127]
    ds_read_b64_tr_b16 v[42:43], v12 offset:38208
    v_mfma_f32_16x16x32_bf16 v[128:131], v[60:63], v[76:79], v[128:131]
    ds_read_b64_tr_b16 v[44:45], v13 offset:36960
    v_mfma_f32_16x16x32_bf16 v[132:135], v[64:67], v[76:79], v[132:135]
    ds_read_b64_tr_b16 v[46:47], v13 offset:38240
    v_mfma_f32_16x16x32_bf16 v[136:139], v[52:55], v[80:83], v[136:139]
    ds_read_b64_tr_b16 v[48:49], v12 offset:36992
    v_mfma_f32_16x16x32_bf16 v[140:143], v[56:59], v[80:83], v[140:143]
    ds_read_b64_tr_b16 v[50:51], v12 offset:38272
    v_mfma_f32_16x16x32_bf16 v[144:147], v[60:63], v[80:83], v[144:147]
    v_mfma_f32_16x16x32_bf16 v[148:151], v[64:67], v[80:83], v[148:151]
    v_mfma_f32_16x16x32_bf16 v[152:155], v[52:55], v[84:87], v[152:155]
    v_mfma_f32_16x16x32_bf16 v[156:159], v[56:59], v[84:87], v[156:159]
    v_mfma_f32_16x16x32_bf16 v[160:163], v[60:63], v[84:87], v[160:163]
    v_mfma_f32_16x16x32_bf16 v[164:167], v[64:67], v[84:87], v[164:167]
    s_waitcnt lgkmcnt(0)
    v_mfma_f32_16x16x32_bf16 v[88:91], v[16:19], v[32:35], v[88:91]
    ds_read_b128 v[52:55], v11 offset:36864
    v_mfma_f32_16x16x32_bf16 v[92:95], v[20:23], v[32:35], v[92:95]
    ds_read_b64_tr_b16 v[68:69], v12 offset:47104
    v_mfma_f32_16x16x32_bf16 v[96:99], v[24:27], v[32:35], v[96:99]
    ds_read_b64_tr_b16 v[70:71], v12 offset:48384
    v_mfma_f32_16x16x32_bf16 v[100:103], v[28:31], v[32:35], v[100:103]
    ds_read_b128 v[56:59], v11 offset:38912
    v_mfma_f32_16x16x32_bf16 v[104:107], v[16:19], v[36:39], v[104:107]
    ds_read_b128 v[60:63], v11 offset:40960
    v_mfma_f32_16x16x32_bf16 v[108:111], v[20:23], v[36:39], v[108:111]
    ds_read_b128 v[64:67], v11 offset:43008
    v_mfma_f32_16x16x32_bf16 v[112:115], v[24:27], v[36:39], v[112:115]
    ds_read_b64_tr_b16 v[72:73], v13 offset:47136
    v_mfma_f32_16x16x32_bf16 v[116:119], v[28:31], v[36:39], v[116:119]
    ds_read_b64_tr_b16 v[74:75], v13 offset:48416
    v_mfma_f32_16x16x32_bf16 v[120:123], v[16:19], v[40:43], v[120:123]
    ds_read_b64_tr_b16 v[76:77], v12 offset:47168
    v_mfma_f32_16x16x32_bf16 v[124:127], v[20:23], v[40:43], v[124:127]
    ds_read_b64_tr_b16 v[78:79], v12 offset:48448
    v_mfma_f32_16x16x32_bf16 v[128:131], v[24:27], v[40:43], v[128:131]
    ds_read_b64_tr_b16 v[80:81], v13 offset:47200
    v_mfma_f32_16x16x32_bf16 v[132:135], v[28:31], v[40:43], v[132:135]
    ds_read_b64_tr_b16 v[82:83], v13 offset:48480
    v_mfma_f32_16x16x32_bf16 v[136:139], v[16:19], v[44:47], v[136:139]
    ds_read_b64_tr_b16 v[84:85], v12 offset:47232
    v_mfma_f32_16x16x32_bf16 v[140:143], v[20:23], v[44:47], v[140:143]
    ds_read_b64_tr_b16 v[86:87], v12 offset:48512
    v_mfma_f32_16x16x32_bf16 v[144:147], v[24:27], v[44:47], v[144:147]
    v_mfma_f32_16x16x32_bf16 v[148:151], v[28:31], v[44:47], v[148:151]
    v_mfma_f32_16x16x32_bf16 v[152:155], v[16:19], v[48:51], v[152:155]
    v_mfma_f32_16x16x32_bf16 v[156:159], v[20:23], v[48:51], v[156:159]
    v_mfma_f32_16x16x32_bf16 v[160:163], v[24:27], v[48:51], v[160:163]
    v_mfma_f32_16x16x32_bf16 v[164:167], v[28:31], v[48:51], v[164:167]
    s_waitcnt lgkmcnt(0)
    s_barrier
    v_mfma_f32_16x16x32_bf16 v[88:91], v[52:55], v[68:71], v[88:91]
    ds_read_b128 v[16:19], v6 offset:0
    v_mfma_f32_16x16x32_bf16 v[92:95], v[56:59], v[68:71], v[92:95]
    ds_read_b64_tr_b16 v[32:33], v8 offset:0
    v_mfma_f32_16x16x32_bf16 v[96:99], v[60:63], v[68:71], v[96:99]
    ds_read_b64_tr_b16 v[34:35], v8 offset:1280
    v_mfma_f32_16x16x32_bf16 v[100:103], v[64:67], v[68:71], v[100:103]
    ds_read_b128 v[20:23], v6 offset:2048
    v_mfma_f32_16x16x32_bf16 v[104:107], v[52:55], v[72:75], v[104:107]
    ds_read_b128 v[24:27], v6 offset:4096
    v_mfma_f32_16x16x32_bf16 v[108:111], v[56:59], v[72:75], v[108:111]
    ds_read_b128 v[28:31], v6 offset:6144
    v_mfma_f32_16x16x32_bf16 v[112:115], v[60:63], v[72:75], v[112:115]
    ds_read_b64_tr_b16 v[36:37], v9 offset:32
    v_mfma_f32_16x16x32_bf16 v[116:119], v[64:67], v[72:75], v[116:119]
    ds_read_b64_tr_b16 v[38:39], v9 offset:1312
    v_mfma_f32_16x16x32_bf16 v[120:123], v[52:55], v[76:79], v[120:123]
    ds_read_b64_tr_b16 v[40:41], v8 offset:64
    v_mfma_f32_16x16x32_bf16 v[124:127], v[56:59], v[76:79], v[124:127]
    ds_read_b64_tr_b16 v[42:43], v8 offset:1344
    v_mfma_f32_16x16x32_bf16 v[128:131], v[60:63], v[76:79], v[128:131]
    ds_read_b64_tr_b16 v[44:45], v9 offset:96
    v_mfma_f32_16x16x32_bf16 v[132:135], v[64:67], v[76:79], v[132:135]
    ds_read_b64_tr_b16 v[46:47], v9 offset:1376
    v_mfma_f32_16x16x32_bf16 v[136:139], v[52:55], v[80:83], v[136:139]
    ds_read_b64_tr_b16 v[48:49], v8 offset:128
    v_mfma_f32_16x16x32_bf16 v[140:143], v[56:59], v[80:83], v[140:143]
    ds_read_b64_tr_b16 v[50:51], v8 offset:1408
    v_mfma_f32_16x16x32_bf16 v[144:147], v[60:63], v[80:83], v[144:147]
    v_mfma_f32_16x16x32_bf16 v[148:151], v[64:67], v[80:83], v[148:151]
    v_mfma_f32_16x16x32_bf16 v[152:155], v[52:55], v[84:87], v[152:155]
    v_mfma_f32_16x16x32_bf16 v[156:159], v[56:59], v[84:87], v[156:159]
    v_mfma_f32_16x16x32_bf16 v[160:163], v[60:63], v[84:87], v[160:163]
    v_mfma_f32_16x16x32_bf16 v[164:167], v[64:67], v[84:87], v[164:167]
    s_waitcnt lgkmcnt(0)
    v_mfma_f32_16x16x32_bf16 v[88:91], v[16:19], v[32:35], v[88:91]
    ds_read_b128 v[52:55], v7 offset:0
    v_mfma_f32_16x16x32_bf16 v[92:95], v[20:23], v[32:35], v[92:95]
    ds_read_b64_tr_b16 v[68:69], v8 offset:10240
    v_mfma_f32_16x16x32_bf16 v[96:99], v[24:27], v[32:35], v[96:99]
    ds_read_b64_tr_b16 v[70:71], v8 offset:11520
    v_mfma_f32_16x16x32_bf16 v[100:103], v[28:31], v[32:35], v[100:103]
    ds_read_b128 v[56:59], v7 offset:2048
    v_mfma_f32_16x16x32_bf16 v[104:107], v[16:19], v[36:39], v[104:107]
    ds_read_b128 v[60:63], v7 offset:4096
    v_mfma_f32_16x16x32_bf16 v[108:111], v[20:23], v[36:39], v[108:111]
    ds_read_b128 v[64:67], v7 offset:6144
    v_mfma_f32_16x16x32_bf16 v[112:115], v[24:27], v[36:39], v[112:115]
    ds_read_b64_tr_b16 v[72:73], v9 offset:10272
    v_mfma_f32_16x16x32_bf16 v[116:119], v[28:31], v[36:39], v[116:119]
    ds_read_b64_tr_b16 v[74:75], v9 offset:11552
    v_mfma_f32_16x16x32_bf16 v[120:123], v[16:19], v[40:43], v[120:123]
    ds_read_b64_tr_b16 v[76:77], v8 offset:10304
    v_mfma_f32_16x16x32_bf16 v[124:127], v[20:23], v[40:43], v[124:127]
    ds_read_b64_tr_b16 v[78:79], v8 offset:11584
    v_mfma_f32_16x16x32_bf16 v[128:131], v[24:27], v[40:43], v[128:131]
    ds_read_b64_tr_b16 v[80:81], v9 offset:10336
    v_mfma_f32_16x16x32_bf16 v[132:135], v[28:31], v[40:43], v[132:135]
    ds_read_b64_tr_b16 v[82:83], v9 offset:11616
    v_mfma_f32_16x16x32_bf16 v[136:139], v[16:19], v[44:47], v[136:139]
    ds_read_b64_tr_b16 v[84:85], v8 offset:10368
    v_mfma_f32_16x16x32_bf16 v[140:143], v[20:23], v[44:47], v[140:143]
    ds_read_b64_tr_b16 v[86:87], v8 offset:11648
    v_mfma_f32_16x16x32_bf16 v[144:147], v[24:27], v[44:47], v[144:147]
    v_mfma_f32_16x16x32_bf16 v[148:151], v[28:31], v[44:47], v[148:151]
    v_mfma_f32_16x16x32_bf16 v[152:155], v[16:19], v[48:51], v[152:155]
    v_mfma_f32_16x16x32_bf16 v[156:159], v[20:23], v[48:51], v[156:159]
    v_mfma_f32_16x16x32_bf16 v[160:163], v[24:27], v[48:51], v[160:163]
    v_mfma_f32_16x16x32_bf16 v[164:167], v[28:31], v[48:51], v[164:167]
    s_waitcnt lgkmcnt(0)
    s_barrier
    v_mfma_f32_16x16x32_bf16 v[88:91], v[52:55], v[68:71], v[88:91]
    ds_read_b128 v[16:19], v6 offset:36864
    v_mfma_f32_16x16x32_bf16 v[92:95], v[56:59], v[68:71], v[92:95]
    ds_read_b64_tr_b16 v[32:33], v8 offset:36864
    v_mfma_f32_16x16x32_bf16 v[96:99], v[60:63], v[68:71], v[96:99]
    ds_read_b64_tr_b16 v[34:35], v8 offset:38144
    v_mfma_f32_16x16x32_bf16 v[100:103], v[64:67], v[68:71], v[100:103]
    ds_read_b128 v[20:23], v6 offset:38912
    v_mfma_f32_16x16x32_bf16 v[104:107], v[52:55], v[72:75], v[104:107]
    ds_read_b128 v[24:27], v6 offset:40960
    v_mfma_f32_16x16x32_bf16 v[108:111], v[56:59], v[72:75], v[108:111]
    ds_read_b128 v[28:31], v6 offset:43008
    v_mfma_f32_16x16x32_bf16 v[112:115], v[60:63], v[72:75], v[112:115]
    ds_read_b64_tr_b16 v[36:37], v9 offset:36896
    v_mfma_f32_16x16x32_bf16 v[116:119], v[64:67], v[72:75], v[116:119]
    ds_read_b64_tr_b16 v[38:39], v9 offset:38176
    v_mfma_f32_16x16x32_bf16 v[120:123], v[52:55], v[76:79], v[120:123]
    ds_read_b64_tr_b16 v[40:41], v8 offset:36928
    v_mfma_f32_16x16x32_bf16 v[124:127], v[56:59], v[76:79], v[124:127]
    ds_read_b64_tr_b16 v[42:43], v8 offset:38208
    v_mfma_f32_16x16x32_bf16 v[128:131], v[60:63], v[76:79], v[128:131]
    ds_read_b64_tr_b16 v[44:45], v9 offset:36960
    v_mfma_f32_16x16x32_bf16 v[132:135], v[64:67], v[76:79], v[132:135]
    ds_read_b64_tr_b16 v[46:47], v9 offset:38240
    v_mfma_f32_16x16x32_bf16 v[136:139], v[52:55], v[80:83], v[136:139]
    ds_read_b64_tr_b16 v[48:49], v8 offset:36992
    v_mfma_f32_16x16x32_bf16 v[140:143], v[56:59], v[80:83], v[140:143]
    ds_read_b64_tr_b16 v[50:51], v8 offset:38272
    v_mfma_f32_16x16x32_bf16 v[144:147], v[60:63], v[80:83], v[144:147]
    v_mfma_f32_16x16x32_bf16 v[148:151], v[64:67], v[80:83], v[148:151]
    v_mfma_f32_16x16x32_bf16 v[152:155], v[52:55], v[84:87], v[152:155]
    v_mfma_f32_16x16x32_bf16 v[156:159], v[56:59], v[84:87], v[156:159]
    v_mfma_f32_16x16x32_bf16 v[160:163], v[60:63], v[84:87], v[160:163]
    v_mfma_f32_16x16x32_bf16 v[164:167], v[64:67], v[84:87], v[164:167]
    s_waitcnt lgkmcnt(0)
    v_mfma_f32_16x16x32_bf16 v[88:91], v[16:19], v[32:35], v[88:91]
    ds_read_b128 v[52:55], v7 offset:36864
    v_mfma_f32_16x16x32_bf16 v[92:95], v[20:23], v[32:35], v[92:95]
    ds_read_b64_tr_b16 v[68:69], v8 offset:47104
    v_mfma_f32_16x16x32_bf16 v[96:99], v[24:27], v[32:35], v[96:99]
    ds_read_b64_tr_b16 v[70:71], v8 offset:48384
    v_mfma_f32_16x16x32_bf16 v[100:103], v[28:31], v[32:35], v[100:103]
    ds_read_b128 v[56:59], v7 offset:38912
    v_mfma_f32_16x16x32_bf16 v[104:107], v[16:19], v[36:39], v[104:107]
    ds_read_b128 v[60:63], v7 offset:40960
    v_mfma_f32_16x16x32_bf16 v[108:111], v[20:23], v[36:39], v[108:111]
    ds_read_b128 v[64:67], v7 offset:43008
    v_mfma_f32_16x16x32_bf16 v[112:115], v[24:27], v[36:39], v[112:115]
    ds_read_b64_tr_b16 v[72:73], v9 offset:47136
    v_mfma_f32_16x16x32_bf16 v[116:119], v[28:31], v[36:39], v[116:119]
    ds_read_b64_tr_b16 v[74:75], v9 offset:48416
    v_mfma_f32_16x16x32_bf16 v[120:123], v[16:19], v[40:43], v[120:123]
    ds_read_b64_tr_b16 v[76:77], v8 offset:47168
    v_mfma_f32_16x16x32_bf16 v[124:127], v[20:23], v[40:43], v[124:127]
    ds_read_b64_tr_b16 v[78:79], v8 offset:48448
    v_mfma_f32_16x16x32_bf16 v[128:131], v[24:27], v[40:43], v[128:131]
    ds_read_b64_tr_b16 v[80:81], v9 offset:47200
    v_mfma_f32_16x16x32_bf16 v[132:135], v[28:31], v[40:43], v[132:135]
    ds_read_b64_tr_b16 v[82:83], v9 offset:48480
    v_mfma_f32_16x16x32_bf16 v[136:139], v[16:19], v[44:47], v[136:139]
    ds_read_b64_tr_b16 v[84:85], v8 offset:47232
    v_mfma_f32_16x16x32_bf16 v[140:143], v[20:23], v[44:47], v[140:143]
    ds_read_b64_tr_b16 v[86:87], v8 offset:48512
    v_mfma_f32_16x16x32_bf16 v[144:147], v[24:27], v[44:47], v[144:147]
    v_mfma_f32_16x16x32_bf16 v[148:151], v[28:31], v[44:47], v[148:151]
    v_mfma_f32_16x16x32_bf16 v[152:155], v[16:19], v[48:51], v[152:155]
    v_mfma_f32_16x16x32_bf16 v[156:159], v[20:23], v[48:51], v[156:159]
    v_mfma_f32_16x16x32_bf16 v[160:163], v[24:27], v[48:51], v[160:163]
    v_mfma_f32_16x16x32_bf16 v[164:167], v[28:31], v[48:51], v[164:167]
    s_waitcnt lgkmcnt(0)
    s_barrier
    v_mfma_f32_16x16x32_bf16 v[88:91], v[52:55], v[68:71], v[88:91]
    ds_read_b128 v[16:19], v10 offset:0
    v_mfma_f32_16x16x32_bf16 v[92:95], v[56:59], v[68:71], v[92:95]
    ds_read_b64_tr_b16 v[32:33], v12 offset:0
    v_mfma_f32_16x16x32_bf16 v[96:99], v[60:63], v[68:71], v[96:99]
    ds_read_b64_tr_b16 v[34:35], v12 offset:1280
    v_mfma_f32_16x16x32_bf16 v[100:103], v[64:67], v[68:71], v[100:103]
    ds_read_b128 v[20:23], v10 offset:2048
    v_mfma_f32_16x16x32_bf16 v[104:107], v[52:55], v[72:75], v[104:107]
    ds_read_b128 v[24:27], v10 offset:4096
    v_mfma_f32_16x16x32_bf16 v[108:111], v[56:59], v[72:75], v[108:111]
    ds_read_b128 v[28:31], v10 offset:6144
    v_mfma_f32_16x16x32_bf16 v[112:115], v[60:63], v[72:75], v[112:115]
    ds_read_b64_tr_b16 v[36:37], v13 offset:32
    v_mfma_f32_16x16x32_bf16 v[116:119], v[64:67], v[72:75], v[116:119]
    ds_read_b64_tr_b16 v[38:39], v13 offset:1312
    v_mfma_f32_16x16x32_bf16 v[120:123], v[52:55], v[76:79], v[120:123]
    ds_read_b64_tr_b16 v[40:41], v12 offset:64
    v_mfma_f32_16x16x32_bf16 v[124:127], v[56:59], v[76:79], v[124:127]
    ds_read_b64_tr_b16 v[42:43], v12 offset:1344
    v_mfma_f32_16x16x32_bf16 v[128:131], v[60:63], v[76:79], v[128:131]
    ds_read_b64_tr_b16 v[44:45], v13 offset:96
    v_mfma_f32_16x16x32_bf16 v[132:135], v[64:67], v[76:79], v[132:135]
    ds_read_b64_tr_b16 v[46:47], v13 offset:1376
    v_mfma_f32_16x16x32_bf16 v[136:139], v[52:55], v[80:83], v[136:139]
    ds_read_b64_tr_b16 v[48:49], v12 offset:128
    v_mfma_f32_16x16x32_bf16 v[140:143], v[56:59], v[80:83], v[140:143]
    ds_read_b64_tr_b16 v[50:51], v12 offset:1408
    v_mfma_f32_16x16x32_bf16 v[144:147], v[60:63], v[80:83], v[144:147]
    v_mfma_f32_16x16x32_bf16 v[148:151], v[64:67], v[80:83], v[148:151]
    v_mfma_f32_16x16x32_bf16 v[152:155], v[52:55], v[84:87], v[152:155]
    v_mfma_f32_16x16x32_bf16 v[156:159], v[56:59], v[84:87], v[156:159]
    v_mfma_f32_16x16x32_bf16 v[160:163], v[60:63], v[84:87], v[160:163]
    v_mfma_f32_16x16x32_bf16 v[164:167], v[64:67], v[84:87], v[164:167]
    s_waitcnt lgkmcnt(0)
    v_mfma_f32_16x16x32_bf16 v[88:91], v[16:19], v[32:35], v[88:91]
    ds_read_b128 v[52:55], v11 offset:0
    v_mfma_f32_16x16x32_bf16 v[92:95], v[20:23], v[32:35], v[92:95]
    ds_read_b64_tr_b16 v[68:69], v12 offset:10240
    v_mfma_f32_16x16x32_bf16 v[96:99], v[24:27], v[32:35], v[96:99]
    ds_read_b64_tr_b16 v[70:71], v12 offset:11520
    v_mfma_f32_16x16x32_bf16 v[100:103], v[28:31], v[32:35], v[100:103]
    ds_read_b128 v[56:59], v11 offset:2048
    v_mfma_f32_16x16x32_bf16 v[104:107], v[16:19], v[36:39], v[104:107]
    ds_read_b128 v[60:63], v11 offset:4096
    v_mfma_f32_16x16x32_bf16 v[108:111], v[20:23], v[36:39], v[108:111]
    ds_read_b128 v[64:67], v11 offset:6144
    v_mfma_f32_16x16x32_bf16 v[112:115], v[24:27], v[36:39], v[112:115]
    ds_read_b64_tr_b16 v[72:73], v13 offset:10272
    v_mfma_f32_16x16x32_bf16 v[116:119], v[28:31], v[36:39], v[116:119]
    ds_read_b64_tr_b16 v[74:75], v13 offset:11552
    v_mfma_f32_16x16x32_bf16 v[120:123], v[16:19], v[40:43], v[120:123]
    ds_read_b64_tr_b16 v[76:77], v12 offset:10304
    v_mfma_f32_16x16x32_bf16 v[124:127], v[20:23], v[40:43], v[124:127]
    ds_read_b64_tr_b16 v[78:79], v12 offset:11584
    v_mfma_f32_16x16x32_bf16 v[128:131], v[24:27], v[40:43], v[128:131]
    ds_read_b64_tr_b16 v[80:81], v13 offset:10336
    v_mfma_f32_16x16x32_bf16 v[132:135], v[28:31], v[40:43], v[132:135]
    ds_read_b64_tr_b16 v[82:83], v13 offset:11616
    v_mfma_f32_16x16x32_bf16 v[136:139], v[16:19], v[44:47], v[136:139]
    ds_read_b64_tr_b16 v[84:85], v12 offset:10368
    v_mfma_f32_16x16x32_bf16 v[140:143], v[20:23], v[44:47], v[140:143]
    ds_read_b64_tr_b16 v[86:87], v12 offset:11648
    v_mfma_f32_16x16x32_bf16 v[144:147], v[24:27], v[44:47], v[144:147]
    v_mfma_f32_16x16x32_bf16 v[148:151], v[28:31], v[44:47], v[148:151]
    v_mfma_f32_16x16x32_bf16 v[152:155], v[16:19], v[48:51], v[152:155]
    v_mfma_f32_16x16x32_bf16 v[156:159], v[20:23], v[48:51], v[156:159]
    v_mfma_f32_16x16x32_bf16 v[160:163], v[24:27], v[48:51], v[160:163]
    v_mfma_f32_16x16x32_bf16 v[164:167], v[28:31], v[48:51], v[164:167]
    s_waitcnt lgkmcnt(0)
    s_barrier
    v_mfma_f32_16x16x32_bf16 v[88:91], v[52:55], v[68:71], v[88:91]
    ds_read_b128 v[16:19], v10 offset:36864
    v_mfma_f32_16x16x32_bf16 v[92:95], v[56:59], v[68:71], v[92:95]
    ds_read_b64_tr_b16 v[32:33], v12 offset:36864
    v_mfma_f32_16x16x32_bf16 v[96:99], v[60:63], v[68:71], v[96:99]
    ds_read_b64_tr_b16 v[34:35], v12 offset:38144
    v_mfma_f32_16x16x32_bf16 v[100:103], v[64:67], v[68:71], v[100:103]
    ds_read_b128 v[20:23], v10 offset:38912
    v_mfma_f32_16x16x32_bf16 v[104:107], v[52:55], v[72:75], v[104:107]
    ds_read_b128 v[24:27], v10 offset:40960
    v_mfma_f32_16x16x32_bf16 v[108:111], v[56:59], v[72:75], v[108:111]
    ds_read_b128 v[28:31], v10 offset:43008
    v_mfma_f32_16x16x32_bf16 v[112:115], v[60:63], v[72:75], v[112:115]
    ds_read_b64_tr_b16 v[36:37], v13 offset:36896
    v_mfma_f32_16x16x32_bf16 v[116:119], v[64:67], v[72:75], v[116:119]
    ds_read_b64_tr_b16 v[38:39], v13 offset:38176
    v_mfma_f32_16x16x32_bf16 v[120:123], v[52:55], v[76:79], v[120:123]
    ds_read_b64_tr_b16 v[40:41], v12 offset:36928
    v_mfma_f32_16x16x32_bf16 v[124:127], v[56:59], v[76:79], v[124:127]
    ds_read_b64_tr_b16 v[42:43], v12 offset:38208
    v_mfma_f32_16x16x32_bf16 v[128:131], v[60:63], v[76:79], v[128:131]
    ds_read_b64_tr_b16 v[44:45], v13 offset:36960
    v_mfma_f32_16x16x32_bf16 v[132:135], v[64:67], v[76:79], v[132:135]
    ds_read_b64_tr_b16 v[46:47], v13 offset:38240
    v_mfma_f32_16x16x32_bf16 v[136:139], v[52:55], v[80:83], v[136:139]
    ds_read_b64_tr_b16 v[48:49], v12 offset:36992
    v_mfma_f32_16x16x32_bf16 v[140:143], v[56:59], v[80:83], v[140:143]
    ds_read_b64_tr_b16 v[50:51], v12 offset:38272
    v_mfma_f32_16x16x32_bf16 v[144:147], v[60:63], v[80:83], v[144:147]
    v_mfma_f32_16x16x32_bf16 v[148:151], v[64:67], v[80:83], v[148:151]
    v_mfma_f32_16x16x32_bf16 v[152:155], v[52:55], v[84:87], v[152:155]
    v_mfma_f32_16x16x32_bf16 v[156:159], v[56:59], v[84:87], v[156:159]
    v_mfma_f32_16x16x32_bf16 v[160:163], v[60:63], v[84:87], v[160:163]
    v_mfma_f32_16x16x32_bf16 v[164:167], v[64:67], v[84:87], v[164:167]
    s_waitcnt lgkmcnt(0)
    v_mfma_f32_16x16x32_bf16 v[88:91], v[16:19], v[32:35], v[88:91]
    ds_read_b128 v[52:55], v11 offset:36864
    v_mfma_f32_16x16x32_bf16 v[92:95], v[20:23], v[32:35], v[92:95]
    ds_read_b64_tr_b16 v[68:69], v12 offset:47104
    v_mfma_f32_16x16x32_bf16 v[96:99], v[24:27], v[32:35], v[96:99]
    ds_read_b64_tr_b16 v[70:71], v12 offset:48384
    v_mfma_f32_16x16x32_bf16 v[100:103], v[28:31], v[32:35], v[100:103]
    ds_read_b128 v[56:59], v11 offset:38912
    v_mfma_f32_16x16x32_bf16 v[104:107], v[16:19], v[36:39], v[104:107]
    ds_read_b128 v[60:63], v11 offset:40960
    v_mfma_f32_16x16x32_bf16 v[108:111], v[20:23], v[36:39], v[108:111]
    ds_read_b128 v[64:67], v11 offset:43008
    v_mfma_f32_16x16x32_bf16 v[112:115], v[24:27], v[36:39], v[112:115]
    ds_read_b64_tr_b16 v[72:73], v13 offset:47136
    v_mfma_f32_16x16x32_bf16 v[116:119], v[28:31], v[36:39], v[116:119]
    ds_read_b64_tr_b16 v[74:75], v13 offset:48416
    v_mfma_f32_16x16x32_bf16 v[120:123], v[16:19], v[40:43], v[120:123]
    ds_read_b64_tr_b16 v[76:77], v12 offset:47168
    v_mfma_f32_16x16x32_bf16 v[124:127], v[20:23], v[40:43], v[124:127]
    ds_read_b64_tr_b16 v[78:79], v12 offset:48448
    v_mfma_f32_16x16x32_bf16 v[128:131], v[24:27], v[40:43], v[128:131]
    ds_read_b64_tr_b16 v[80:81], v13 offset:47200
    v_mfma_f32_16x16x32_bf16 v[132:135], v[28:31], v[40:43], v[132:135]
    ds_read_b64_tr_b16 v[82:83], v13 offset:48480
    v_mfma_f32_16x16x32_bf16 v[136:139], v[16:19], v[44:47], v[136:139]
    ds_read_b64_tr_b16 v[84:85], v12 offset:47232
    v_mfma_f32_16x16x32_bf16 v[140:143], v[20:23], v[44:47], v[140:143]
    ds_read_b64_tr_b16 v[86:87], v12 offset:48512
    v_mfma_f32_16x16x32_bf16 v[144:147], v[24:27], v[44:47], v[144:147]
    v_mfma_f32_16x16x32_bf16 v[148:151], v[28:31], v[44:47], v[148:151]
    v_mfma_f32_16x16x32_bf16 v[152:155], v[16:19], v[48:51], v[152:155]
    v_mfma_f32_16x16x32_bf16 v[156:159], v[20:23], v[48:51], v[156:159]
    v_mfma_f32_16x16x32_bf16 v[160:163], v[24:27], v[48:51], v[160:163]
    v_mfma_f32_16x16x32_bf16 v[164:167], v[28:31], v[48:51], v[164:167]
    s_waitcnt lgkmcnt(0)
    s_barrier
    v_mfma_f32_16x16x32_bf16 v[88:91], v[52:55], v[68:71], v[88:91]
    ds_read_b128 v[16:19], v6 offset:0
    v_mfma_f32_16x16x32_bf16 v[92:95], v[56:59], v[68:71], v[92:95]
    ds_read_b64_tr_b16 v[32:33], v8 offset:0
    v_mfma_f32_16x16x32_bf16 v[96:99], v[60:63], v[68:71], v[96:99]
    ds_read_b64_tr_b16 v[34:35], v8 offset:1280
    v_mfma_f32_16x16x32_bf16 v[100:103], v[64:67], v[68:71], v[100:103]
    ds_read_b128 v[20:23], v6 offset:2048
    v_mfma_f32_16x16x32_bf16 v[104:107], v[52:55], v[72:75], v[104:107]
    ds_read_b128 v[24:27], v6 offset:4096
    v_mfma_f32_16x16x32_bf16 v[108:111], v[56:59], v[72:75], v[108:111]
    ds_read_b128 v[28:31], v6 offset:6144
    v_mfma_f32_16x16x32_bf16 v[112:115], v[60:63], v[72:75], v[112:115]
    ds_read_b64_tr_b16 v[36:37], v9 offset:32
    v_mfma_f32_16x16x32_bf16 v[116:119], v[64:67], v[72:75], v[116:119]
    ds_read_b64_tr_b16 v[38:39], v9 offset:1312
    v_mfma_f32_16x16x32_bf16 v[120:123], v[52:55], v[76:79], v[120:123]
    ds_read_b64_tr_b16 v[40:41], v8 offset:64
    v_mfma_f32_16x16x32_bf16 v[124:127], v[56:59], v[76:79], v[124:127]
    ds_read_b64_tr_b16 v[42:43], v8 offset:1344
    v_mfma_f32_16x16x32_bf16 v[128:131], v[60:63], v[76:79], v[128:131]
    ds_read_b64_tr_b16 v[44:45], v9 offset:96
    v_mfma_f32_16x16x32_bf16 v[132:135], v[64:67], v[76:79], v[132:135]
    ds_read_b64_tr_b16 v[46:47], v9 offset:1376
    v_mfma_f32_16x16x32_bf16 v[136:139], v[52:55], v[80:83], v[136:139]
    ds_read_b64_tr_b16 v[48:49], v8 offset:128
    v_mfma_f32_16x16x32_bf16 v[140:143], v[56:59], v[80:83], v[140:143]
    ds_read_b64_tr_b16 v[50:51], v8 offset:1408
    v_mfma_f32_16x16x32_bf16 v[144:147], v[60:63], v[80:83], v[144:147]
    v_mfma_f32_16x16x32_bf16 v[148:151], v[64:67], v[80:83], v[148:151]
    v_mfma_f32_16x16x32_bf16 v[152:155], v[52:55], v[84:87], v[152:155]
    v_mfma_f32_16x16x32_bf16 v[156:159], v[56:59], v[84:87], v[156:159]
    v_mfma_f32_16x16x32_bf16 v[160:163], v[60:63], v[84:87], v[160:163]
    v_mfma_f32_16x16x32_bf16 v[164:167], v[64:67], v[84:87], v[164:167]
    s_waitcnt lgkmcnt(0)
    v_mfma_f32_16x16x32_bf16 v[88:91], v[16:19], v[32:35], v[88:91]
    ds_read_b128 v[52:55], v7 offset:0
    v_mfma_f32_16x16x32_bf16 v[92:95], v[20:23], v[32:35], v[92:95]
    ds_read_b64_tr_b16 v[68:69], v8 offset:10240
    v_mfma_f32_16x16x32_bf16 v[96:99], v[24:27], v[32:35], v[96:99]
    ds_read_b64_tr_b16 v[70:71], v8 offset:11520
    v_mfma_f32_16x16x32_bf16 v[100:103], v[28:31], v[32:35], v[100:103]
    ds_read_b128 v[56:59], v7 offset:2048
    v_mfma_f32_16x16x32_bf16 v[104:107], v[16:19], v[36:39], v[104:107]
    ds_read_b128 v[60:63], v7 offset:4096
    v_mfma_f32_16x16x32_bf16 v[108:111], v[20:23], v[36:39], v[108:111]
    ds_read_b128 v[64:67], v7 offset:6144
    v_mfma_f32_16x16x32_bf16 v[112:115], v[24:27], v[36:39], v[112:115]
    ds_read_b64_tr_b16 v[72:73], v9 offset:10272
    v_mfma_f32_16x16x32_bf16 v[116:119], v[28:31], v[36:39], v[116:119]
    ds_read_b64_tr_b16 v[74:75], v9 offset:11552
    v_mfma_f32_16x16x32_bf16 v[120:123], v[16:19], v[40:43], v[120:123]
    ds_read_b64_tr_b16 v[76:77], v8 offset:10304
    v_mfma_f32_16x16x32_bf16 v[124:127], v[20:23], v[40:43], v[124:127]
    ds_read_b64_tr_b16 v[78:79], v8 offset:11584
    v_mfma_f32_16x16x32_bf16 v[128:131], v[24:27], v[40:43], v[128:131]
    ds_read_b64_tr_b16 v[80:81], v9 offset:10336
    v_mfma_f32_16x16x32_bf16 v[132:135], v[28:31], v[40:43], v[132:135]
    ds_read_b64_tr_b16 v[82:83], v9 offset:11616
    v_mfma_f32_16x16x32_bf16 v[136:139], v[16:19], v[44:47], v[136:139]
    ds_read_b64_tr_b16 v[84:85], v8 offset:10368
    v_mfma_f32_16x16x32_bf16 v[140:143], v[20:23], v[44:47], v[140:143]
    ds_read_b64_tr_b16 v[86:87], v8 offset:11648
    v_mfma_f32_16x16x32_bf16 v[144:147], v[24:27], v[44:47], v[144:147]
    v_mfma_f32_16x16x32_bf16 v[148:151], v[28:31], v[44:47], v[148:151]
    v_mfma_f32_16x16x32_bf16 v[152:155], v[16:19], v[48:51], v[152:155]
    v_mfma_f32_16x16x32_bf16 v[156:159], v[20:23], v[48:51], v[156:159]
    v_mfma_f32_16x16x32_bf16 v[160:163], v[24:27], v[48:51], v[160:163]
    v_mfma_f32_16x16x32_bf16 v[164:167], v[28:31], v[48:51], v[164:167]
    s_waitcnt lgkmcnt(0)
    s_barrier
    v_mfma_f32_16x16x32_bf16 v[88:91], v[52:55], v[68:71], v[88:91]
    ds_read_b128 v[16:19], v6 offset:36864
    v_mfma_f32_16x16x32_bf16 v[92:95], v[56:59], v[68:71], v[92:95]
    ds_read_b64_tr_b16 v[32:33], v8 offset:36864
    v_mfma_f32_16x16x32_bf16 v[96:99], v[60:63], v[68:71], v[96:99]
    ds_read_b64_tr_b16 v[34:35], v8 offset:38144
    v_mfma_f32_16x16x32_bf16 v[100:103], v[64:67], v[68:71], v[100:103]
    ds_read_b128 v[20:23], v6 offset:38912
    v_mfma_f32_16x16x32_bf16 v[104:107], v[52:55], v[72:75], v[104:107]
    ds_read_b128 v[24:27], v6 offset:40960
    v_mfma_f32_16x16x32_bf16 v[108:111], v[56:59], v[72:75], v[108:111]
    ds_read_b128 v[28:31], v6 offset:43008
    v_mfma_f32_16x16x32_bf16 v[112:115], v[60:63], v[72:75], v[112:115]
    ds_read_b64_tr_b16 v[36:37], v9 offset:36896
    v_mfma_f32_16x16x32_bf16 v[116:119], v[64:67], v[72:75], v[116:119]
    ds_read_b64_tr_b16 v[38:39], v9 offset:38176
    v_mfma_f32_16x16x32_bf16 v[120:123], v[52:55], v[76:79], v[120:123]
    ds_read_b64_tr_b16 v[40:41], v8 offset:36928
    v_mfma_f32_16x16x32_bf16 v[124:127], v[56:59], v[76:79], v[124:127]
    ds_read_b64_tr_b16 v[42:43], v8 offset:38208
    v_mfma_f32_16x16x32_bf16 v[128:131], v[60:63], v[76:79], v[128:131]
    ds_read_b64_tr_b16 v[44:45], v9 offset:36960
    v_mfma_f32_16x16x32_bf16 v[132:135], v[64:67], v[76:79], v[132:135]
    ds_read_b64_tr_b16 v[46:47], v9 offset:38240
    v_mfma_f32_16x16x32_bf16 v[136:139], v[52:55], v[80:83], v[136:139]
    ds_read_b64_tr_b16 v[48:49], v8 offset:36992
    v_mfma_f32_16x16x32_bf16 v[140:143], v[56:59], v[80:83], v[140:143]
    ds_read_b64_tr_b16 v[50:51], v8 offset:38272
    v_mfma_f32_16x16x32_bf16 v[144:147], v[60:63], v[80:83], v[144:147]
    v_mfma_f32_16x16x32_bf16 v[148:151], v[64:67], v[80:83], v[148:151]
    v_mfma_f32_16x16x32_bf16 v[152:155], v[52:55], v[84:87], v[152:155]
    v_mfma_f32_16x16x32_bf16 v[156:159], v[56:59], v[84:87], v[156:159]
    v_mfma_f32_16x16x32_bf16 v[160:163], v[60:63], v[84:87], v[160:163]
    v_mfma_f32_16x16x32_bf16 v[164:167], v[64:67], v[84:87], v[164:167]
    s_waitcnt lgkmcnt(0)
    v_mfma_f32_16x16x32_bf16 v[88:91], v[16:19], v[32:35], v[88:91]
    ds_read_b128 v[52:55], v7 offset:36864
    v_mfma_f32_16x16x32_bf16 v[92:95], v[20:23], v[32:35], v[92:95]
    ds_read_b64_tr_b16 v[68:69], v8 offset:47104
    v_mfma_f32_16x16x32_bf16 v[96:99], v[24:27], v[32:35], v[96:99]
    ds_read_b64_tr_b16 v[70:71], v8 offset:48384
    v_mfma_f32_16x16x32_bf16 v[100:103], v[28:31], v[32:35], v[100:103]
    ds_read_b128 v[56:59], v7 offset:38912
    v_mfma_f32_16x16x32_bf16 v[104:107], v[16:19], v[36:39], v[104:107]
    ds_read_b128 v[60:63], v7 offset:40960
    v_mfma_f32_16x16x32_bf16 v[108:111], v[20:23], v[36:39], v[108:111]
    ds_read_b128 v[64:67], v7 offset:43008
    v_mfma_f32_16x16x32_bf16 v[112:115], v[24:27], v[36:39], v[112:115]
    ds_read_b64_tr_b16 v[72:73], v9 offset:47136
    v_mfma_f32_16x16x32_bf16 v[116:119], v[28:31], v[36:39], v[116:119]
    ds_read_b64_tr_b16 v[74:75], v9 offset:48416
    v_mfma_f32_16x16x32_bf16 v[120:123], v[16:19], v[40:43], v[120:123]
    ds_read_b64_tr_b16 v[76:77], v8 offset:47168
    v_mfma_f32_16x16x32_bf16 v[124:127], v[20:23], v[40:43], v[124:127]
    ds_read_b64_tr_b16 v[78:79], v8 offset:48448
    v_mfma_f32_16x16x32_bf16 v[128:131], v[24:27], v[40:43], v[128:131]
    ds_read_b64_tr_b16 v[80:81], v9 offset:47200
    v_mfma_f32_16x16x32_bf16 v[132:135], v[28:31], v[40:43], v[132:135]
    ds_read_b64_tr_b16 v[82:83], v9 offset:48480
    v_mfma_f32_16x16x32_bf16 v[136:139], v[16:19], v[44:47], v[136:139]
    ds_read_b64_tr_b16 v[84:85], v8 offset:47232
    v_mfma_f32_16x16x32_bf16 v[140:143], v[20:23], v[44:47], v[140:143]
    ds_read_b64_tr_b16 v[86:87], v8 offset:48512
    v_mfma_f32_16x16x32_bf16 v[144:147], v[24:27], v[44:47], v[144:147]
    v_mfma_f32_16x16x32_bf16 v[148:151], v[28:31], v[44:47], v[148:151]
    v_mfma_f32_16x16x32_bf16 v[152:155], v[16:19], v[48:51], v[152:155]
    v_mfma_f32_16x16x32_bf16 v[156:159], v[20:23], v[48:51], v[156:159]
    v_mfma_f32_16x16x32_bf16 v[160:163], v[24:27], v[48:51], v[160:163]
    v_mfma_f32_16x16x32_bf16 v[164:167], v[28:31], v[48:51], v[164:167]
    s_waitcnt lgkmcnt(0)
    v_mfma_f32_16x16x32_bf16 v[88:91], v[52:55], v[68:71], v[88:91]
    v_mfma_f32_16x16x32_bf16 v[92:95], v[56:59], v[68:71], v[92:95]
    v_mfma_f32_16x16x32_bf16 v[96:99], v[60:63], v[68:71], v[96:99]
    v_mfma_f32_16x16x32_bf16 v[100:103], v[64:67], v[68:71], v[100:103]
    v_mfma_f32_16x16x32_bf16 v[104:107], v[52:55], v[72:75], v[104:107]
    v_mfma_f32_16x16x32_bf16 v[108:111], v[56:59], v[72:75], v[108:111]
    v_mfma_f32_16x16x32_bf16 v[112:115], v[60:63], v[72:75], v[112:115]
    v_mfma_f32_16x16x32_bf16 v[116:119], v[64:67], v[72:75], v[116:119]
    v_mfma_f32_16x16x32_bf16 v[120:123], v[52:55], v[76:79], v[120:123]
    v_mfma_f32_16x16x32_bf16 v[124:127], v[56:59], v[76:79], v[124:127]
    v_mfma_f32_16x16x32_bf16 v[128:131], v[60:63], v[76:79], v[128:131]
    v_mfma_f32_16x16x32_bf16 v[132:135], v[64:67], v[76:79], v[132:135]
    v_mfma_f32_16x16x32_bf16 v[136:139], v[52:55], v[80:83], v[136:139]
    v_mfma_f32_16x16x32_bf16 v[140:143], v[56:59], v[80:83], v[140:143]
    v_mfma_f32_16x16x32_bf16 v[144:147], v[60:63], v[80:83], v[144:147]
    v_mfma_f32_16x16x32_bf16 v[148:151], v[64:67], v[80:83], v[148:151]
    v_mfma_f32_16x16x32_bf16 v[152:155], v[52:55], v[84:87], v[152:155]
    v_mfma_f32_16x16x32_bf16 v[156:159], v[56:59], v[84:87], v[156:159]
    v_mfma_f32_16x16x32_bf16 v[160:163], v[60:63], v[84:87], v[160:163]
    v_mfma_f32_16x16x32_bf16 v[164:167], v[64:67], v[84:87], v[164:167]
    v_mov_b32 v3, 161792
    v_mov_b32 v4, 1
    s_mov_b64 exec, 1
    ds_add_u32 v3, v4 offset:128
    s_mov_b64 exec, -1
    v_cvt_pk_bf16_f32 v16, v88, v89
    v_cvt_pk_bf16_f32 v17, v90, v91
    v_cvt_pk_bf16_f32 v18, v92, v93
    v_cvt_pk_bf16_f32 v19, v94, v95
    v_cvt_pk_bf16_f32 v20, v96, v97
    v_cvt_pk_bf16_f32 v21, v98, v99
    v_cvt_pk_bf16_f32 v22, v100, v101
    v_cvt_pk_bf16_f32 v23, v102, v103
    v_permlane32_swap_b32 v16, v18
    v_permlane32_swap_b32 v17, v19
    buffer_store_dwordx4 v[16:19], v14, s[20:23], s36 offen offset:0 sc1
    v_cvt_pk_bf16_f32 v24, v104, v105
    v_cvt_pk_bf16_f32 v25, v106, v107
    v_cvt_pk_bf16_f32 v26, v108, v109
    v_cvt_pk_bf16_f32 v27, v110, v111
    v_permlane32_swap_b32 v20, v22
    v_permlane32_swap_b32 v21, v23
    buffer_store_dwordx4 v[20:23], v14, s[20:23], s37 offen offset:0 sc1
    v_cvt_pk_bf16_f32 v28, v112, v113
    v_cvt_pk_bf16_f32 v29, v114, v115
    v_cvt_pk_bf16_f32 v30, v116, v117
    v_cvt_pk_bf16_f32 v31, v118, v119
    v_permlane32_swap_b32 v24, v26
    v_permlane32_swap_b32 v25, v27
    buffer_store_dwordx4 v[24:27], v14, s[20:23], s36 offen offset:256 sc1
    v_cvt_pk_bf16_f32 v32, v120, v121
    v_cvt_pk_bf16_f32 v33, v122, v123
    v_cvt_pk_bf16_f32 v34, v124, v125
    v_cvt_pk_bf16_f32 v35, v126, v127
    v_permlane32_swap_b32 v28, v30
    v_permlane32_swap_b32 v29, v31
    buffer_store_dwordx4 v[28:31], v14, s[20:23], s37 offen offset:256 sc1
    v_cvt_pk_bf16_f32 v36, v128, v129
    v_cvt_pk_bf16_f32 v37, v130, v131
    v_cvt_pk_bf16_f32 v38, v132, v133
    v_cvt_pk_bf16_f32 v39, v134, v135
    v_permlane32_swap_b32 v32, v34
    v_permlane32_swap_b32 v33, v35
    buffer_store_dwordx4 v[32:35], v14, s[20:23], s36 offen offset:512 sc1
    v_cvt_pk_bf16_f32 v40, v136, v137
    v_cvt_pk_bf16_f32 v41, v138, v139
    v_cvt_pk_bf16_f32 v42, v140, v141
    v_cvt_pk_bf16_f32 v43, v142, v143
    v_permlane32_swap_b32 v36, v38
    v_permlane32_swap_b32 v37, v39
    buffer_store_dwordx4 v[36:39], v14, s[20:23], s37 offen offset:512 sc1
    v_cvt_pk_bf16_f32 v44, v144, v145
    v_cvt_pk_bf16_f32 v45, v146, v147
    v_cvt_pk_bf16_f32 v46, v148, v149
    v_cvt_pk_bf16_f32 v47, v150, v151
    v_permlane32_swap_b32 v40, v42
    v_permlane32_swap_b32 v41, v43
    buffer_store_dwordx4 v[40:43], v14, s[20:23], s36 offen offset:768 sc1
    v_cvt_pk_bf16_f32 v48, v152, v153
    v_cvt_pk_bf16_f32 v49, v154, v155
    v_cvt_pk_bf16_f32 v50, v156, v157
    v_cvt_pk_bf16_f32 v51, v158, v159
    v_permlane32_swap_b32 v44, v46
    v_permlane32_swap_b32 v45, v47
    buffer_store_dwordx4 v[44:47], v14, s[20:23], s37 offen offset:768 sc1
    v_cvt_pk_bf16_f32 v52, v160, v161
    v_cvt_pk_bf16_f32 v53, v162, v163
    v_cvt_pk_bf16_f32 v54, v164, v165
    v_cvt_pk_bf16_f32 v55, v166, v167
    v_permlane32_swap_b32 v48, v50
    v_permlane32_swap_b32 v49, v51
    buffer_store_dwordx4 v[48:51], v14, s[20:23], s36 offen offset:1024 sc1
    s_nop 1
    v_permlane32_swap_b32 v52, v54
    v_permlane32_swap_b32 v53, v55
    buffer_store_dwordx4 v[52:55], v14, s[20:23], s37 offen offset:1024 sc1
.a_signal:
    s_lshl_b32 s13, s26, 4
    s_add_u32 s13, s13, s27
    s_lshl_b32 s13, s13, 7
    s_add_u32 s13, s13, 11350528
    s_cmp_ge_u32 s27, 0
    s_cselect_b32 s12, 2, 1
    s_branch .b_attn2
.b_attn:
    s_mov_b32 s12, 0
.b_attn2:
    s_lshl_b32 s26, s24, 2
    s_and_b32 s27, s25, 3
    s_add_u32 s26, s26, s27
    s_lshr_b32 s27, s25, 2
    s_lshr_b32 s28, s26, 1
    s_and_b32 s29, s26, 1
    s_mulk_i32 s28, 5
    s_mul_i32 s30, s29, 3
    s_add_u32 s30, s30, s28
    s_add_u32 s31, s28, 2
    s_lshl_b32 s30, s30, 11
    s_lshl_b32 s31, s31, 11
    s_lshl_b32 s32, s27, 2
    s_add_u32 s33, s32, s3
    s_cmp_lt_u32 s33, 4
    s_cselect_b32 s34, 0, 4
    s_sub_u32 s33, s33, s34
    s_lshr_b32 s47, s33, 1
    s_mul_i32 s34, s47, 325632
    s_lshl_b32 s35, s33, 10
    s_add_u32 s34, s34, s35
    s_add_u32 s34, s34, 163840
    s_add_u32 s35, s34, s30
    s_add_u32 s36, s35, 2048
    s_add_u32 s37, s34, s31
    v_lshlrev_b32 v3, 4, v2
    s_mul_i32 s38, s33, 81920
    s_mul_i32 s39, s26, 320
    s_add_u32 s38, s38, s39
    s_add_u32 s38, s38, 7864320
    s_mul_i32 s39, s3, 2688
    s_lshl_b32 s33, s3, 10
    s_lshl_b32 s32, s27, 12
    v_and_b32 v7, 31, v2
    v_lshlrev_b32 v4, 4, v7
    v_lshrrev_b32 v5, 5, v2
    v_lshl_add_u32 v6, v5, 11, v4
    s_lshl_b32 s40, s3, 9
    s_add_u32 s40, s40, s32
    s_lshr_b32 s41, s40, 11
    s_mul_i32 s41, s41, 325632
    s_add_u32 s40, s40, s41
    s_add_u32 s41, s40, s30
    s_add_u32 s42, s40, s31
    s_lshl_b32 s43, s29, 3
    s_add_u32 s42, s42, s43
    v_mov_b32 v12, 161792
    ds_read_b32 v1, v12 offset:48
    v_lshlrev_b32 v0, 2, v2
    v_add_u32 v68, s33, v3
    s_mov_b64 exec, -1
    v_mov_b32 v24, 0x3f803f80
    v_mov_b32 v25, v24
    v_mov_b32 v26, v24
    v_mov_b32 v27, v24
    v_mul_u32_u24 v15, 336, v2
    v_add_u32 v15, s39, v15
    s_lshl_b32 s44, s27, 2
    s_add_u32 s44, s44, s3
    s_cmp_lt_u32 s44, 4
    s_mov_b32 s44, 0x3f800000
    s_cselect_b32 s44, 0x3f80f149, s44
    v_mov_b32 v70, s44
    v_mov_b32 v71, 0
    s_xor_b32 s45, s43, 8
    s_add_u32 s44, s45, s33
    v_lshlrev_b32 v69, 9, v2
    v_add_u32 v69, s44, v69
    v_mov_b32 v13, v15
    s_lshl_b32 s44, s3, 9
    v_lshlrev_b32 v8, 13, v5
    v_add3_u32 v8, v8, v4, s44
    v_add_u32 v9, s43, v4
    v_cmp_eq_u32 vcc, 1, v5
    v_mov_b32 v10, s45
    s_add_u32 s44, s44, 16384
    v_cndmask_b32 v9, v9, v10, vcc
    v_add_u32 v9, s44, v9
    v_bfe_u32 v10, v2, 2, 1
    v_bfe_u32 v11, v2, 3, 1
    v_and_b32 v14, 3, v2
    v_lshl_add_u32 v14, v10, 3, v14
    v_lshl_add_u32 v14, v11, 2, v14
    v_cmp_gt_u32 s[46:47], 16, v7
    v_min_u32 v11, 20, v7
    v_mul_u32_u24 v10, 336, v5
    v_cndmask_b32 v14, v11, v14, s[46:47]
    v_lshl_add_u32 v10, v14, 4, v10
    s_mul_i32 s45, s3, 1344
    s_add_u32 s45, s45, 24576
    v_add_u32 v10, s45, v10
    v_mov_b32 v22, 0
    v_mov_b32 v23, 0
    v_mov_b32 v30, 0
    v_mov_b32 v31, 0
    v_mov_b32 v38, 0
    v_mov_b32 v39, 0
    v_mov_b32 v46, 0
    v_mov_b32 v47, 0
    v_mov_b32 v54, 0
    v_mov_b32 v55, 0
    s_mov_b32 s48, 0xffffffff
    s_mov_b32 s49, 0xfffffff0
    s_mov_b32 s50, 0xfffffffe
    s_mov_b32 s51, 0xffffffe0
    s_mov_b32 s52, 0xfffffffc
    s_mov_b32 s53, 0xffffffc0
    s_mov_b32 s54, 0xfffffff8
    s_mov_b32 s55, 0xffffff80
    s_mov_b32 s56, 0xffffff00
    s_mov_b32 s57, 0xfffff000
    s_mov_b32 s58, 0xfffffe00
    s_mov_b32 s59, 0xffffe000
    s_mov_b32 s60, 0xfffffc00
    s_mov_b32 s61, 0xffffc000
    s_mov_b32 s62, 0xfffff800
    s_mov_b32 s63, 0xffff8000
    s_mov_b32 s64, 0xffff0000
    s_mov_b32 s65, 0xfff00000
    s_mov_b32 s66, 0xfffe0000
    s_mov_b32 s67, 0xffe00000
    s_mov_b32 s68, 0xfffc0000
    s_mov_b32 s69, 0xffc00000
    s_mov_b32 s70, 0xfff80000
    s_mov_b32 s71, 0xff800000
    s_mov_b32 s72, 0xff000000
    s_mov_b32 s73, 0xf0000000
    s_mov_b32 s74, 0xfe000000
    s_mov_b32 s75, 0xe0000000
    s_mov_b32 s76, 0xfc000000
    s_mov_b32 s77, 0xc0000000
    s_mov_b32 s78, 0xf8000000
    s_mov_b32 s79, 0x80000000
    s_mov_b32 s44, 0x3ea52b5b
    s_mov_b32 s45, s44
    s_lshl_b32 s40, s27, 5
    s_add_u32 s40, s40, s26
    s_lshl_b32 s28, s40, 13
    s_lshl_b32 s43, s3, 9
    s_add_u32 s28, s28, s43
    s_add_u32 s28, s28, 5242880
    s_lshl_b32 s29, s40, 11
    s_lshl_b32 s43, s3, 8
    s_add_u32 s29, s29, s43
    s_add_u32 s29, s29, 7340032
    v_mov_b32 v15, 1
    s_cmp_lg_u32 s3, 7
    s_cbranch_scc1 .bc_nomk
    s_lshr_b32 s30, s26, 3
    s_lshl_b32 s46, s27, 1
    s_sub_u32 s46, s46, 2
    v_and_b32 v72, 4, v2
    v_add_u32 v73, s30, v72
    v_lshrrev_b32 v72, 1, v72
    v_xor_b32 v72, 2, v72
    v_and_b32 v74, 3, v2
    v_or_b32 v74, v74, v72
    v_add_u32 v74, s46, v74
    v_max_i32 v74, 0, v74
    v_lshl_add_u32 v73, v74, 4, v73
    v_lshlrev_b32 v73, 7, v73
    s_mov_b32 s30, 11350528
    s_waitcnt lgkmcnt(0)
    s_mov_b32 s47, 0x200000
    .ga_lw3:
    ds_read_b32 v11, v12 offset:60
    s_sub_u32 s47, s47, 1
    s_waitcnt lgkmcnt(0)
    v_readfirstlane_b32 s46, v11
    s_cmp_eq_u32 s47, 0
    s_cbranch_scc1 .ga_lwd4
    s_cmp_ge_u32 s46, 1
    s_cbranch_scc1 .ga_lwd4
    s_sleep 1
    s_branch .ga_lw3
    .ga_lwd4:
    s_mov_b32 s47, 0x200000
    .ga_lw5:
    ds_read_b32 v11, v12 offset:12
    s_sub_u32 s47, s47, 1
    s_waitcnt lgkmcnt(0)
    v_readfirstlane_b32 s46, v11
    s_cmp_eq_u32 s47, 0
    s_cbranch_scc1 .ga_lwd6
    s_cmp_ge_u32 s46, 4
    s_cbranch_scc1 .ga_lwd6
    s_sleep 0
    s_branch .ga_lw5
    .ga_lwd6:
    s_mov_b32 exec_lo, 0xff
    s_mov_b32 exec_hi, 0x0
    s_mov_b32 s46, 0x40000
    .ga_gw7:
    buffer_load_dword v74, v73, s[20:23], s30 offen sc1
    s_sub_u32 s46, s46, 1
    s_waitcnt vmcnt(0)
    v_cmp_ne_u32 vcc, v1, v74
    s_cmp_eq_u32 s46, 0
    s_cbranch_scc1 .ga_gwd8
    s_cbranch_vccz .ga_gwd8
    s_mov_b64 exec, vcc
    s_sleep 1
    s_branch .ga_gw7
    .ga_gwd8:
    s_mov_b64 exec, -1
    s_mov_b64 exec, 1
    ds_add_u32 v12, v15 offset:60
    s_mov_b64 exec, -1
    v_cmp_eq_u32 vcc, 1, v5
    .bc_nomk:
    s_cmp_eq_u32 s12, 0
    s_cbranch_scc1 .a_notlast
    s_mov_b64 exec, 1
    s_waitcnt vmcnt(0)
    ds_add_rtn_u32 v11, v12, v15 offset:12
    s_waitcnt lgkmcnt(0)
    v_readfirstlane_b32 s46, v11
    s_add_u32 s46, s46, s12
    s_cmp_lg_u32 s46, 5
    s_cbranch_scc1 .a_notlast
    s_mov_b32 exec_lo, -1
    buffer_store_dword v1, v0, s[20:23], s13 offen sc1
    .a_notlast:
    s_mov_b64 exec, -1
    s_mov_b32 s47, 0x200000
    .ga_lw9:
    ds_read_b32 v11, v12 offset:60
    s_sub_u32 s47, s47, 1
    s_waitcnt lgkmcnt(0)
    v_readfirstlane_b32 s46, v11
    s_cmp_eq_u32 s47, 0
    s_cbranch_scc1 .ga_lwd10
    s_cmp_ge_u32 s46, 2
    s_cbranch_scc1 .ga_lwd10
    s_sleep 0
    s_branch .ga_lw9
    .ga_lwd10:
    s_add_u32 m0, s33, 0
    s_nop 0
    buffer_load_dwordx4 v3, s[20:23], s35 offen sc1 lds
    s_add_u32 m0, s33, 8192
    s_nop 0
    buffer_load_dwordx4 v3, s[20:23], s36 offen sc1 lds
    s_add_u32 m0, s33, 16384
    s_nop 0
    buffer_load_dwordx4 v3, s[20:23], s37 offen sc1 lds
    buffer_load_dwordx4 v[16:19], v6, s[20:23], s41 offen sc1
    buffer_load_dwordx2 v[20:21], v4, s[20:23], s42 offen sc1
    s_mov_b32 s47, 0x7fff
    s_waitcnt vmcnt(0)
    s_mov_b64 exec, 0xff
    ds_write_b128 v13, v[24:27] offset:24896
    s_mov_b64 exec, 3
    ds_write_b64 v69, v[70:71] offset:16384
    s_mov_b64 exec, 1
    ds_add_u32 v12, v15 offset:36
    s_mov_b64 exec, -1
    s_mov_b32 s41, s28
    s_mov_b32 s42, s29
    v_lshl_add_u32 v6, v5, 12, v4
    v_mov_b32 v11, 0x3f80
    v_lshlrev_b32 v56, 16, v16
    v_and_b32 v57, 0xffff0000, v16
    v_lshlrev_b32 v58, 16, v17
    v_and_b32 v59, 0xffff0000, v17
    v_lshlrev_b32 v60, 16, v18
    v_and_b32 v61, 0xffff0000, v18
    v_lshlrev_b32 v62, 16, v19
    v_and_b32 v63, 0xffff0000, v19
    v_lshlrev_b32 v64, 16, v20
    v_and_b32 v65, 0xffff0000, v20
    v_lshlrev_b32 v66, 16, v21
    v_and_b32 v67, 0xffff0000, v21
    v_pk_mul_f32 v[56:57], v[56:57], s[44:45]
    v_pk_mul_f32 v[58:59], v[58:59], s[44:45]
    v_pk_mul_f32 v[60:61], v[60:61], s[44:45]
    v_pk_mul_f32 v[62:63], v[62:63], s[44:45]
    v_pk_mul_f32 v[64:65], v[64:65], s[44:45]
    v_pk_mul_f32 v[66:67], v[66:67], s[44:45]
    v_cvt_pk_bf16_f32 v16, v56, v57
    v_cvt_pk_bf16_f32 v17, v58, v59
    v_cvt_pk_bf16_f32 v18, v60, v61
    v_cvt_pk_bf16_f32 v19, v62, v63
    v_cvt_pk_bf16_f32 v20, v64, v65
    v_cvt_pk_bf16_f32 v21, v66, v67
    v_cndmask_b32 v20, v20, v11, vcc
    v_cndmask_b32 v21, v21, v22, vcc
    v_mov_b32 v14, v12
    s_cmp_ge_u32 s3, 4
    s_cbranch_scc1 .bc_noprio
    s_setprio 1
    .bc_noprio:
    s_mov_b32 s47, 0x200000
    .ga_lw11:
    ds_read_b32 v11, v14 offset:36
    s_sub_u32 s47, s47, 1
    s_waitcnt lgkmcnt(0)
    v_readfirstlane_b32 s46, v11
    s_cmp_eq_u32 s47, 0
    s_cbranch_scc1 .ga_lwd12
    s_cmp_ge_u32 s46, 8
    s_cbranch_scc1 .ga_lwd12
    s_sleep 0
    s_branch .ga_lw11
    .ga_lwd12:
    ds_read_b128 v[24:27], v8 offset:0
    ds_read_b64 v[28:29], v9 offset:0
    ds_read_b128 v[32:35], v8 offset:4096
    ds_read_b64 v[36:37], v9 offset:4096
    ds_read_b128 v[40:43], v8 offset:512
    ds_read_b64 v[44:45], v9 offset:512
    ds_read_b128 v[48:51], v8 offset:1024
    ds_read_b64 v[52:53], v9 offset:1024
    s_waitcnt lgkmcnt(6)
    v_mfma_f32_32x32x16_bf16 v[88:103], v[24:27], v[16:19], 0
    v_mfma_f32_32x32x16_bf16 v[88:103], v[28:31], v[20:23], v[88:103]
    s_waitcnt lgkmcnt(4)
    v_mfma_f32_32x32x16_bf16 v[104:119], v[32:35], v[16:19], 0
    v_mfma_f32_32x32x16_bf16 v[104:119], v[36:39], v[20:23], v[104:119]
    ds_read_b128 v[24:27], v8 offset:1536
    ds_read_b64 v[28:29], v9 offset:1536
    ds_read_b128 v[32:35], v8 offset:2048
    ds_read_b64 v[36:37], v9 offset:2048
    s_waitcnt lgkmcnt(6)
    v_mfma_f32_32x32x16_bf16 v[120:135], v[40:43], v[16:19], 0
    s_waitcnt lgkmcnt(4)
    v_mfma_f32_32x32x16_bf16 v[136:151], v[48:51], v[16:19], 0
    s_nop 3
    v_cndmask_b32 v88, v88, v104, s[48:49]
    v_cndmask_b32 v89, v89, v105, s[50:51]
    v_cndmask_b32 v90, v90, v106, s[52:53]
    v_cndmask_b32 v91, v91, v107, s[54:55]
    v_cndmask_b32 v92, v92, v108, s[56:57]
    v_cndmask_b32 v93, v93, v109, s[58:59]
    v_cndmask_b32 v94, v94, v110, s[60:61]
    v_cndmask_b32 v95, v95, v111, s[62:63]
    v_cndmask_b32 v96, v96, v112, s[64:65]
    v_cndmask_b32 v97, v97, v113, s[66:67]
    v_cndmask_b32 v98, v98, v114, s[68:69]
    v_cndmask_b32 v99, v99, v115, s[70:71]
    v_cndmask_b32 v100, v100, v116, s[72:73]
    v_cndmask_b32 v101, v101, v117, s[74:75]
    v_cndmask_b32 v102, v102, v118, s[76:77]
    v_cndmask_b32 v103, v103, v119, s[78:79]
    v_max3_f32 v12, v88, v89, v90
    v_max3_f32 v13, v91, v92, v93
    v_max3_f32 v12, v12, v94, v95
    v_max3_f32 v13, v13, v96, v97
    v_max3_f32 v12, v12, v98, v99
    v_max3_f32 v13, v13, v100, v101
    v_max3_f32 v12, v12, v102, v103
    v_max_f32 v12, v12, v13
    v_mov_b32 v13, v12
    s_waitcnt lgkmcnt(2)
    v_mfma_f32_32x32x16_bf16 v[104:119], v[24:27], v[16:19], 0
    v_permlane32_swap_b32 v12, v13
    s_nop 0
    v_max_f32 v12, v12, v13
    v_cvt_pk_bf16_f32 v12, 0, -v12
    v_or_b32 v13, 0x3f80, v12
    v_cndmask_b32 v20, v20, v13, vcc
    v_pk_add_f32 v[88:89], v[88:89], v[12:13] op_sel_hi:[1,0]
    v_pk_add_f32 v[90:91], v[90:91], v[12:13] op_sel_hi:[1,0]
    v_mfma_f32_32x32x16_bf16 v[120:135], v[44:47], v[20:23], v[120:135]
    v_pk_add_f32 v[92:93], v[92:93], v[12:13] op_sel_hi:[1,0]
    v_pk_add_f32 v[94:95], v[94:95], v[12:13] op_sel_hi:[1,0]
    v_pk_add_f32 v[96:97], v[96:97], v[12:13] op_sel_hi:[1,0]
    v_pk_add_f32 v[98:99], v[98:99], v[12:13] op_sel_hi:[1,0]
    v_pk_add_f32 v[100:101], v[100:101], v[12:13] op_sel_hi:[1,0]
    v_pk_add_f32 v[102:103], v[102:103], v[12:13] op_sel_hi:[1,0]
    v_mfma_f32_32x32x16_bf16 v[136:151], v[52:55], v[20:23], v[136:151]
    ds_read_b128 v[40:43], v8 offset:2560
    ds_read_b64 v[44:45], v9 offset:2560
    ds_read_b128 v[48:51], v8 offset:3072
    ds_read_b64 v[52:53], v9 offset:3072
    v_exp_f32 v88, v88
    v_exp_f32 v89, v89
    v_exp_f32 v90, v90
    v_exp_f32 v91, v91
    v_mfma_f32_32x32x16_bf16 v[104:119], v[28:31], v[20:23], v[104:119]
    ds_read_b128 v[24:27], v8 offset:3584
    ds_read_b64 v[28:29], v9 offset:3584
    v_exp_f32 v92, v92
    v_exp_f32 v93, v93
    v_exp_f32 v94, v94
    v_exp_f32 v95, v95
    v_exp_f32 v96, v96
    v_exp_f32 v97, v97
    v_exp_f32 v98, v98
    v_exp_f32 v99, v99
    v_exp_f32 v100, v100
    v_exp_f32 v101, v101
    v_exp_f32 v102, v102
    v_exp_f32 v103, v103
    v_cndmask_b32 v152, 0, v88, s[48:49]
    v_cndmask_b32 v153, 0, v89, s[50:51]
    v_cndmask_b32 v154, 0, v90, s[52:53]
    v_cndmask_b32 v155, 0, v91, s[54:55]
    v_cndmask_b32 v156, 0, v92, s[56:57]
    v_cndmask_b32 v157, 0, v93, s[58:59]
    v_cndmask_b32 v158, 0, v94, s[60:61]
    v_cndmask_b32 v159, 0, v95, s[62:63]
    v_cndmask_b32 v160, 0, v96, s[64:65]
    v_cndmask_b32 v161, 0, v97, s[66:67]
    v_cndmask_b32 v162, 0, v98, s[68:69]
    v_cndmask_b32 v163, 0, v99, s[70:71]
    v_cndmask_b32 v164, 0, v100, s[72:73]
    v_cndmask_b32 v165, 0, v101, s[74:75]
    v_cndmask_b32 v166, 0, v102, s[76:77]
    v_cndmask_b32 v167, 0, v103, s[78:79]
    v_cvt_pk_bf16_f32 v152, v152, v153
    v_cvt_pk_bf16_f32 v153, v154, v155
    v_cvt_pk_bf16_f32 v154, v156, v157
    v_cvt_pk_bf16_f32 v155, v158, v159
    v_cvt_pk_bf16_f32 v156, v160, v161
    v_cvt_pk_bf16_f32 v157, v162, v163
    v_cvt_pk_bf16_f32 v158, v164, v165
    v_cvt_pk_bf16_f32 v159, v166, v167
    v_cvt_pk_bf16_f32 v160, v88, v89
    v_cvt_pk_bf16_f32 v161, v90, v91
    v_cvt_pk_bf16_f32 v162, v92, v93
    v_cvt_pk_bf16_f32 v163, v94, v95
    v_cvt_pk_bf16_f32 v164, v96, v97
    v_cvt_pk_bf16_f32 v165, v98, v99
    v_cvt_pk_bf16_f32 v166, v100, v101
    v_cvt_pk_bf16_f32 v167, v102, v103
    v_xor_b32 v160, v160, v152
    v_xor_b32 v161, v161, v153
    v_xor_b32 v162, v162, v154
    v_xor_b32 v163, v163, v155
    v_xor_b32 v164, v164, v156
    v_xor_b32 v165, v165, v157
    v_xor_b32 v166, v166, v158
    v_xor_b32 v167, v167, v159
    s_waitcnt lgkmcnt(0)
    v_mfma_f32_32x32x16_bf16 v[88:103], v[32:35], v[16:19], 0
    v_exp_f32 v120, v120
    v_exp_f32 v121, v121
    v_exp_f32 v122, v122
    v_exp_f32 v123, v123
    v_exp_f32 v124, v124
    v_exp_f32 v125, v125
    v_exp_f32 v126, v126
    v_exp_f32 v127, v127
    v_mfma_f32_32x32x16_bf16 v[88:103], v[36:39], v[20:23], v[88:103]
    v_exp_f32 v128, v128
    v_exp_f32 v129, v129
    v_exp_f32 v130, v130
    v_exp_f32 v131, v131
    v_exp_f32 v132, v132
    v_exp_f32 v133, v133
    v_exp_f32 v134, v134
    v_exp_f32 v135, v135
    v_cvt_pk_bf16_f32 v120, v120, v121
    v_cvt_pk_bf16_f32 v121, v122, v123
    v_cvt_pk_bf16_f32 v122, v124, v125
    v_cvt_pk_bf16_f32 v123, v126, v127
    v_cvt_pk_bf16_f32 v124, v128, v129
    v_cvt_pk_bf16_f32 v125, v130, v131
    v_cvt_pk_bf16_f32 v126, v132, v133
    v_cvt_pk_bf16_f32 v127, v134, v135
    s_mov_b32 s47, 0x200000
    .ga_lw13:
    ds_read_b32 v11, v14 offset:52
    s_sub_u32 s47, s47, 1
    s_waitcnt lgkmcnt(0)
    v_readfirstlane_b32 s46, v11
    s_cmp_eq_u32 s47, 0
    s_cbranch_scc1 .ga_lwd14
    s_cmp_ge_u32 s46, 8
    s_cbranch_scc1 .ga_lwd14
    s_sleep 0
    s_branch .ga_lw13
    .ga_lwd14:
    ds_read_b128 v[56:59], v10 offset:0
    ds_read_b128 v[60:63], v10 offset:672
    ds_read_b128 v[64:67], v10 offset:10752
    ds_read_b128 v[68:71], v10 offset:11424
    v_exp_f32 v136, v136
    v_exp_f32 v137, v137
    v_exp_f32 v138, v138
    v_exp_f32 v139, v139
    s_waitcnt lgkmcnt(2)
    s_nop 0
    v_mfma_f32_32x32x16_bf16 v[72:87], v[56:59], v[160:163], 0
    v_exp_f32 v140, v140
    v_exp_f32 v141, v141
    v_exp_f32 v142, v142
    v_mfma_f32_32x32x16_bf16 v[72:87], v[60:63], v[164:167], v[72:87]
    ds_read_b128 v[56:59], v10 offset:1344
    ds_read_b128 v[60:63], v10 offset:2016
    v_exp_f32 v143, v143
    v_exp_f32 v144, v144
    v_exp_f32 v145, v145
    s_waitcnt lgkmcnt(2)
    s_nop 0
    v_mfma_f32_32x32x16_bf16 v[72:87], v[64:67], v[152:155], v[72:87]
    v_exp_f32 v146, v146
    v_exp_f32 v147, v147
    v_exp_f32 v148, v148
    v_mfma_f32_32x32x16_bf16 v[72:87], v[68:71], v[156:159], v[72:87]
    ds_read_b128 v[64:67], v10 offset:2688
    ds_read_b128 v[68:71], v10 offset:3360
    v_exp_f32 v149, v149
    v_exp_f32 v150, v150
    v_exp_f32 v151, v151
    s_waitcnt lgkmcnt(2)
    s_nop 0
    v_mfma_f32_32x32x16_bf16 v[72:87], v[56:59], v[120:123], v[72:87]
    v_cvt_pk_bf16_f32 v136, v136, v137
    v_cvt_pk_bf16_f32 v137, v138, v139
    v_cvt_pk_bf16_f32 v138, v140, v141
    v_cvt_pk_bf16_f32 v139, v142, v143
    v_mfma_f32_32x32x16_bf16 v[72:87], v[60:63], v[124:127], v[72:87]
    ds_read_b128 v[56:59], v10 offset:4032
    ds_read_b128 v[60:63], v10 offset:4704
    v_cvt_pk_bf16_f32 v140, v144, v145
    v_cvt_pk_bf16_f32 v141, v146, v147
    v_cvt_pk_bf16_f32 v142, v148, v149
    v_cvt_pk_bf16_f32 v143, v150, v151
    v_mfma_f32_32x32x16_bf16 v[120:135], v[40:43], v[16:19], 0
    v_exp_f32 v104, v104
    v_exp_f32 v105, v105
    v_exp_f32 v106, v106
    v_mfma_f32_32x32x16_bf16 v[120:135], v[44:47], v[20:23], v[120:135]
    v_exp_f32 v107, v107
    v_exp_f32 v108, v108
    v_exp_f32 v109, v109
    s_waitcnt lgkmcnt(2)
    s_nop 0
    v_mfma_f32_32x32x16_bf16 v[72:87], v[64:67], v[136:139], v[72:87]
    v_exp_f32 v110, v110
    v_exp_f32 v111, v111
    v_exp_f32 v112, v112
    v_mfma_f32_32x32x16_bf16 v[72:87], v[68:71], v[140:143], v[72:87]
    ds_read_b128 v[64:67], v10 offset:5376
    ds_read_b128 v[68:71], v10 offset:6048
    v_exp_f32 v113, v113
    v_exp_f32 v114, v114
    v_exp_f32 v115, v115
    v_mfma_f32_32x32x16_bf16 v[136:151], v[48:51], v[16:19], 0
    v_exp_f32 v116, v116
    v_exp_f32 v117, v117
    v_exp_f32 v118, v118
    v_mfma_f32_32x32x16_bf16 v[136:151], v[52:55], v[20:23], v[136:151]
    v_exp_f32 v119, v119
    v_cvt_pk_bf16_f32 v104, v104, v105
    v_cvt_pk_bf16_f32 v105, v106, v107
    v_cvt_pk_bf16_f32 v106, v108, v109
    v_cvt_pk_bf16_f32 v107, v110, v111
    v_cvt_pk_bf16_f32 v108, v112, v113
    v_cvt_pk_bf16_f32 v109, v114, v115
    v_cvt_pk_bf16_f32 v110, v116, v117
    v_cvt_pk_bf16_f32 v111, v118, v119
    s_waitcnt lgkmcnt(2)
    s_nop 0
    v_mfma_f32_32x32x16_bf16 v[72:87], v[56:59], v[104:107], v[72:87]
    v_exp_f32 v88, v88
    v_exp_f32 v89, v89
    v_exp_f32 v90, v90
    v_exp_f32 v91, v91
    v_mfma_f32_32x32x16_bf16 v[72:87], v[60:63], v[108:111], v[72:87]
    ds_read_b128 v[56:59], v10 offset:6720
    ds_read_b128 v[60:63], v10 offset:7392
    v_exp_f32 v92, v92
    v_exp_f32 v93, v93
    v_exp_f32 v94, v94
    v_exp_f32 v95, v95
    v_mfma_f32_32x32x16_bf16 v[104:119], v[24:27], v[16:19], 0
    v_exp_f32 v96, v96
    v_exp_f32 v97, v97
    v_exp_f32 v98, v98
    v_exp_f32 v99, v99
    v_mfma_f32_32x32x16_bf16 v[104:119], v[28:31], v[20:23], v[104:119]
    v_exp_f32 v100, v100
    v_exp_f32 v101, v101
    v_exp_f32 v102, v102
    v_exp_f32 v103, v103
    v_cvt_pk_bf16_f32 v88, v88, v89
    v_cvt_pk_bf16_f32 v89, v90, v91
    v_cvt_pk_bf16_f32 v90, v92, v93
    v_cvt_pk_bf16_f32 v91, v94, v95
    v_cvt_pk_bf16_f32 v92, v96, v97
    v_cvt_pk_bf16_f32 v93, v98, v99
    v_cvt_pk_bf16_f32 v94, v100, v101
    v_cvt_pk_bf16_f32 v95, v102, v103
    s_waitcnt lgkmcnt(2)
    s_nop 0
    v_mfma_f32_32x32x16_bf16 v[72:87], v[64:67], v[88:91], v[72:87]
    v_exp_f32 v120, v120
    v_exp_f32 v121, v121
    v_exp_f32 v122, v122
    v_exp_f32 v123, v123
    v_exp_f32 v124, v124
    v_exp_f32 v125, v125
    v_exp_f32 v126, v126
    v_exp_f32 v127, v127
    v_mfma_f32_32x32x16_bf16 v[72:87], v[68:71], v[92:95], v[72:87]
    ds_read_b128 v[64:67], v10 offset:8064
    ds_read_b128 v[68:71], v10 offset:8736
    v_exp_f32 v128, v128
    v_exp_f32 v129, v129
    v_exp_f32 v130, v130
    v_exp_f32 v131, v131
    v_exp_f32 v132, v132
    v_exp_f32 v133, v133
    v_exp_f32 v134, v134
    v_exp_f32 v135, v135
    v_cvt_pk_bf16_f32 v120, v120, v121
    v_cvt_pk_bf16_f32 v121, v122, v123
    v_cvt_pk_bf16_f32 v122, v124, v125
    v_cvt_pk_bf16_f32 v123, v126, v127
    v_cvt_pk_bf16_f32 v124, v128, v129
    v_cvt_pk_bf16_f32 v125, v130, v131
    v_cvt_pk_bf16_f32 v126, v132, v133
    v_cvt_pk_bf16_f32 v127, v134, v135
    s_waitcnt lgkmcnt(2)
    s_nop 0
    v_mfma_f32_32x32x16_bf16 v[72:87], v[56:59], v[120:123], v[72:87]
    v_exp_f32 v136, v136
    v_exp_f32 v137, v137
    v_exp_f32 v138, v138
    v_exp_f32 v139, v139
    v_exp_f32 v140, v140
    v_exp_f32 v141, v141
    v_exp_f32 v142, v142
    v_exp_f32 v143, v143
    v_mfma_f32_32x32x16_bf16 v[72:87], v[60:63], v[124:127], v[72:87]
    ds_read_b128 v[56:59], v10 offset:9408
    ds_read_b128 v[60:63], v10 offset:10080
    v_exp_f32 v144, v144
    v_exp_f32 v145, v145
    v_exp_f32 v146, v146
    v_exp_f32 v147, v147
    v_exp_f32 v148, v148
    v_exp_f32 v149, v149
    v_exp_f32 v150, v150
    v_exp_f32 v151, v151
    s_mov_b32 s47, 0x200000
    .ga_lw15:
    ds_read_b32 v11, v14 offset:8
    s_sub_u32 s47, s47, 1
    s_waitcnt lgkmcnt(0)
    v_readfirstlane_b32 s46, v11
    s_cmp_eq_u32 s47, 0
    s_cbranch_scc1 .ga_lwd16
    s_cmp_ge_u32 s46, 8
    s_cbranch_scc1 .ga_lwd16
    s_sleep 0
    s_branch .ga_lw15
    .ga_lwd16:
    v_cvt_pk_bf16_f32 v136, v136, v137
    v_cvt_pk_bf16_f32 v137, v138, v139
    v_cvt_pk_bf16_f32 v138, v140, v141
    v_cvt_pk_bf16_f32 v139, v142, v143
    v_cvt_pk_bf16_f32 v140, v144, v145
    v_cvt_pk_bf16_f32 v141, v146, v147
    v_cvt_pk_bf16_f32 v142, v148, v149
    v_cvt_pk_bf16_f32 v143, v150, v151
    s_waitcnt lgkmcnt(2)
    s_nop 0
    v_mfma_f32_32x32x16_bf16 v[72:87], v[64:67], v[136:139], v[72:87]
    v_exp_f32 v104, v104
    v_exp_f32 v105, v105
    v_exp_f32 v106, v106
    v_exp_f32 v107, v107
    v_exp_f32 v108, v108
    v_exp_f32 v109, v109
    v_exp_f32 v110, v110
    v_exp_f32 v111, v111
    v_mfma_f32_32x32x16_bf16 v[72:87], v[68:71], v[140:143], v[72:87]
    v_exp_f32 v112, v112
    v_exp_f32 v113, v113
    v_exp_f32 v114, v114
    v_exp_f32 v115, v115
    v_exp_f32 v116, v116
    v_exp_f32 v117, v117
    v_exp_f32 v118, v118
    v_exp_f32 v119, v119
    v_cvt_pk_bf16_f32 v104, v104, v105
    v_cvt_pk_bf16_f32 v105, v106, v107
    v_cvt_pk_bf16_f32 v106, v108, v109
    v_cvt_pk_bf16_f32 v107, v110, v111
    v_cvt_pk_bf16_f32 v108, v112, v113
    v_cvt_pk_bf16_f32 v109, v114, v115
    v_cvt_pk_bf16_f32 v110, v116, v117
    v_cvt_pk_bf16_f32 v111, v118, v119
    s_waitcnt lgkmcnt(0)
    s_nop 0
    v_mfma_f32_32x32x16_bf16 v[72:87], v[56:59], v[104:107], v[72:87]
    v_mfma_f32_32x32x16_bf16 v[72:87], v[60:63], v[108:111], v[72:87]
    v_lshlrev_b32 v4, 3, v7
    s_and_b32 s46, s3, 4
    s_lshl_b32 s46, s46, 3
    v_add_u32 v7, s46, v14
    s_nop 5
    s_mov_b32 s46, 0x21800000
    s_mov_b32 s47, 0x5d800000
    v_cmp_nle_f32 vcc, s46, v84
    v_cmp_nge_f32 s[44:45], s47, v84
    s_or_b64 vcc, vcc, s[44:45]
    s_cbranch_vccnz .bc_slow
    .bc_norm:
    v_rcp_f32 v12, v84
    s_nop 0
    v_pk_mul_f32 v[72:73], v[72:73], v[12:13] op_sel_hi:[1,0]
    v_pk_mul_f32 v[74:75], v[74:75], v[12:13] op_sel_hi:[1,0]
    v_pk_mul_f32 v[76:77], v[76:77], v[12:13] op_sel_hi:[1,0]
    v_pk_mul_f32 v[78:79], v[78:79], v[12:13] op_sel_hi:[1,0]
    v_pk_mul_f32 v[80:81], v[80:81], v[12:13] op_sel_hi:[1,0]
    v_pk_mul_f32 v[82:83], v[82:83], v[12:13] op_sel_hi:[1,0]
    v_cvt_pk_bf16_f32 v24, v72, v73
    v_cvt_pk_bf16_f32 v25, v74, v75
    v_cvt_pk_bf16_f32 v26, v76, v77
    v_cvt_pk_bf16_f32 v27, v78, v79
    v_cvt_pk_bf16_f32 v28, v80, v81
    v_cvt_pk_bf16_f32 v29, v82, v83
    buffer_store_dwordx4 v[24:27], v6, s[20:23], s41 offen sc1
    s_mov_b32 exec_hi, 0
    buffer_store_dwordx2 v[28:29], v4, s[20:23], s42 offen sc1
    s_mov_b64 exec, 1
    s_waitcnt vmcnt(0)
    ds_add_u32 v7, v15 offset:0
    s_mov_b64 exec, -1
    s_cmp_ge_u32 s3, 4
    s_cbranch_scc1 .bc_end
    s_setprio 0
    s_load_dwordx2 s[16:17], s[0:1], 72
    s_mov_b32 s18, 2621440
    s_mov_b32 s19, 0x20000
    v_mov_b32 v8, v1
    v_mov_b32 v6, v14
    v_and_b32 v7, 7, v2
    s_mov_b32 s54, 0x200000
    .ga_lw17:
    ds_read_b32 v10, v6 offset:44
    s_sub_u32 s54, s54, 1
    s_waitcnt lgkmcnt(0)
    v_readfirstlane_b32 s53, v10
    s_cmp_eq_u32 s54, 0
    s_cbranch_scc1 .ga_lwd18
    s_cmp_ge_u32 s53, 1
    s_cbranch_scc1 .ga_lwd18
    s_sleep 1
    s_branch .ga_lw17
    .ga_lwd18:
    v_lshl_add_u32 v18, v7, 2, v6
    ds_read_b32 v15, v18 offset:64
    s_waitcnt lgkmcnt(0)
    s_lshl_b32 s30, s24, 4
    s_and_b32 s35, s25, 3
    s_lshl_b32 s35, s35, 1
    s_add_u32 s30, s30, s35
    s_and_b32 s35, s3, 1
    s_add_u32 s30, s30, s35
    s_and_b32 s35, s3, 2
    s_lshl_b32 s35, s35, 2
    s_add_u32 s30, s30, s35
    s_lshr_b32 s35, s25, 2
    v_and_b32 v3, 15, v2
    v_lshrrev_b32 v4, 4, v2
    s_lshl_b32 s38, s30, 4
    v_add_u32 v14, s38, v3
    v_mul_u32_u24 v13, 1280, v14
    v_lshl_add_u32 v12, v4, 3, v13
    v_lshl_add_u32 v13, v4, 4, v13
    s_mul_i32 s39, s35, 160
    v_lshlrev_b32 v1, 4, v14
    s_mov_b32 s34, 11309064
    s_mov_b32 s12, s4
    s_mov_b32 s13, s5
    s_mov_b32 s14, 2621440
    s_mov_b32 s15, 0x20000
    v_mov_b32 v9, v1
    v_lshlrev_b32 v5, 12, v4
    v_lshl_add_u32 v7, v3, 3, v5
    v_lshl_add_u32 v5, v3, 4, v5
    s_and_b32 s33, s30, 15
    s_lshl_b32 s31, s33, 8
    s_lshl_b32 s32, s24, 18
    s_add_u32 s31, s31, s32
    s_add_u32 s31, s31, 5242880
    s_lshl_b32 s33, s33, 7
    s_lshl_b32 s32, s24, 16
    s_add_u32 s33, s33, s32
    s_add_u32 s33, s33, 7340032
    s_and_b32 s32, s27, 3
    s_lshl_b32 s32, s32, 16
    v_lshlrev_b32 v1, 4, v2
    v_add_u32 v10, 65536, v1
    v_add_u32 v11, 106496, v1
    v_lshrrev_b32 v15, 4, v15
    v_cmp_eq_u32 vcc, s30, v15
    s_and_b32 s46, s3, 2
    s_lshl_b32 s46, s46, 4
    v_add_u32 v17, s46, v6
    s_and_b32 s45, vcc_lo, 0xff
    buffer_load_dwordx4 v[56:59], v13, s[12:15], s39 offen
    buffer_load_dwordx4 v[60:63], v13, s[12:15], s39 offen offset:64
    buffer_load_dwordx2 v[64:65], v12, s[12:15], s39 offen offset:128
    buffer_load_dwordx2 v[66:67], v9, s[20:23], s34 offen sc1
    s_add_u32 s68, s31, s32
    s_add_u32 s32, s32, 65536
    s_and_b32 s32, s32, 262143
    s_add_u32 s69, s31, s32
    s_add_u32 s32, s32, 65536
    s_and_b32 s32, s32, 262143
    s_add_u32 s70, s31, s32
    s_add_u32 s32, s32, 65536
    s_and_b32 s32, s32, 262143
    s_add_u32 s71, s31, s32
    s_mov_b32 s54, 0x200000
    .ga_lw19:
    ds_read_b32 v15, v6 offset:4
    s_sub_u32 s54, s54, 1
    s_waitcnt lgkmcnt(0)
    v_readfirstlane_b32 s53, v15
    s_cmp_eq_u32 s54, 0
    s_cbranch_scc1 .ga_lwd20
    s_cmp_ge_u32 s53, 2
    s_cbranch_scc1 .ga_lwd20
    s_sleep 1
    s_branch .ga_lw19
    .ga_lwd20:
    v_mov_b32 v0, v17
    ds_read_b128 v[16:19], v10 offset:0
    ds_read_b128 v[20:23], v10 offset:1024
    ds_read_b128 v[24:27], v10 offset:2048
    ds_read_b128 v[28:31], v10 offset:3072
    ds_read_b128 v[32:35], v10 offset:4096
    s_mov_b32 s54, 0x200000
    .ga_lw21:
    ds_read_b32 v15, v0 offset:0
    s_sub_u32 s54, s54, 1
    s_waitcnt lgkmcnt(0)
    v_readfirstlane_b32 s53, v15
    s_cmp_eq_u32 s54, 0
    s_cbranch_scc1 .ga_lwd22
    s_cmp_ge_u32 s53, 4
    s_cbranch_scc1 .ga_lwd22
    s_sleep 1
    s_branch .ga_lw21
    .ga_lwd22:
    s_add_u32 s37, s68, 0
    buffer_load_dwordx4 v[68:71], v5, s[20:23], s37 offen sc1
    s_add_u32 s37, s68, 16384
    buffer_load_dwordx4 v[72:75], v5, s[20:23], s37 offen sc1
    s_add_u32 s37, s68, 32768
    buffer_load_dwordx4 v[76:79], v5, s[20:23], s37 offen sc1
    s_add_u32 s37, s68, 49152
    buffer_load_dwordx4 v[80:83], v5, s[20:23], s37 offen sc1
    s_add_u32 s37, s69, 0
    buffer_load_dwordx4 v[84:87], v5, s[20:23], s37 offen sc1
    s_add_u32 s37, s69, 16384
    buffer_load_dwordx4 v[88:91], v5, s[20:23], s37 offen sc1
    s_add_u32 s37, s69, 32768
    buffer_load_dwordx4 v[92:95], v5, s[20:23], s37 offen sc1
    s_add_u32 s37, s69, 49152
    buffer_load_dwordx4 v[96:99], v5, s[20:23], s37 offen sc1
    s_mov_b32 s55, 0x8000
    s_waitcnt vmcnt(6)
    v_max_u32 v15, v68, v72
    v_cmp_eq_u32 vcc, -1, v15
    s_cbranch_vccnz .bc_retry0
    .bc_ok0:
    s_waitcnt lgkmcnt(4)
    v_mfma_f32_16x16x32_bf16 v[148:151], v[16:19], v[68:71], 0
    ds_read_b128 v[36:39], v10 offset:5120
    s_add_u32 s37, s70, 0
    buffer_load_dwordx4 v[100:103], v5, s[20:23], s37 offen sc1
    s_waitcnt lgkmcnt(4)
    v_mfma_f32_16x16x32_bf16 v[152:155], v[20:23], v[68:71], 0
    ds_read_b128 v[40:43], v10 offset:6144
    s_waitcnt lgkmcnt(4)
    v_mfma_f32_16x16x32_bf16 v[156:159], v[24:27], v[68:71], 0
    ds_read_b128 v[44:47], v10 offset:7168
    s_waitcnt lgkmcnt(4)
    v_mfma_f32_16x16x32_bf16 v[160:163], v[28:31], v[68:71], 0
    ds_read_b128 v[48:51], v10 offset:8192
    s_waitcnt lgkmcnt(4)
    v_mfma_f32_16x16x32_bf16 v[164:167], v[32:35], v[68:71], 0
    ds_read_b128 v[52:55], v10 offset:9216
    s_waitcnt lgkmcnt(4)
    v_mfma_f32_16x16x32_bf16 v[148:151], v[36:39], v[72:75], v[148:151]
    ds_read_b128 v[16:19], v10 offset:10240
    s_add_u32 s37, s70, 16384
    buffer_load_dwordx4 v[104:107], v5, s[20:23], s37 offen sc1
    s_waitcnt lgkmcnt(4)
    v_mfma_f32_16x16x32_bf16 v[152:155], v[40:43], v[72:75], v[152:155]
    ds_read_b128 v[20:23], v10 offset:11264
    s_waitcnt lgkmcnt(4)
    v_mfma_f32_16x16x32_bf16 v[156:159], v[44:47], v[72:75], v[156:159]
    ds_read_b128 v[24:27], v10 offset:12288
    s_waitcnt lgkmcnt(4)
    v_mfma_f32_16x16x32_bf16 v[160:163], v[48:51], v[72:75], v[160:163]
    ds_read_b128 v[28:31], v10 offset:13312
    s_waitcnt vmcnt(5)
    v_max3_u32 v15, v76, v80, v84
    v_cmp_eq_u32 vcc, -1, v15
    s_waitcnt lgkmcnt(4)
    v_mfma_f32_16x16x32_bf16 v[164:167], v[52:55], v[72:75], v[164:167]
    ds_read_b128 v[32:35], v10 offset:14336
    s_cbranch_vccnz .bc_retry2
    .bc_ok2:
    s_waitcnt lgkmcnt(4)
    v_mfma_f32_16x16x32_bf16 v[148:151], v[16:19], v[76:79], v[148:151]
    ds_read_b128 v[36:39], v10 offset:15360
    s_add_u32 s37, s70, 32768
    buffer_load_dwordx4 v[108:111], v5, s[20:23], s37 offen sc1
    s_waitcnt lgkmcnt(4)
    v_mfma_f32_16x16x32_bf16 v[152:155], v[20:23], v[76:79], v[152:155]
    ds_read_b128 v[40:43], v10 offset:16384
    s_waitcnt lgkmcnt(4)
    v_mfma_f32_16x16x32_bf16 v[156:159], v[24:27], v[76:79], v[156:159]
    ds_read_b128 v[44:47], v10 offset:17408
    s_waitcnt lgkmcnt(4)
    v_mfma_f32_16x16x32_bf16 v[160:163], v[28:31], v[76:79], v[160:163]
    ds_read_b128 v[48:51], v10 offset:18432
    s_waitcnt lgkmcnt(4)
    v_mfma_f32_16x16x32_bf16 v[164:167], v[32:35], v[76:79], v[164:167]
    ds_read_b128 v[52:55], v10 offset:19456
    s_waitcnt lgkmcnt(4)
    v_mfma_f32_16x16x32_bf16 v[148:151], v[36:39], v[80:83], v[148:151]
    ds_read_b128 v[16:19], v10 offset:20480
    s_add_u32 s37, s70, 49152
    buffer_load_dwordx4 v[112:115], v5, s[20:23], s37 offen sc1
    s_waitcnt lgkmcnt(4)
    v_mfma_f32_16x16x32_bf16 v[152:155], v[40:43], v[80:83], v[152:155]
    ds_read_b128 v[20:23], v10 offset:21504
    s_waitcnt lgkmcnt(4)
    v_mfma_f32_16x16x32_bf16 v[156:159], v[44:47], v[80:83], v[156:159]
    ds_read_b128 v[24:27], v10 offset:22528
    s_waitcnt lgkmcnt(4)
    v_mfma_f32_16x16x32_bf16 v[160:163], v[48:51], v[80:83], v[160:163]
    ds_read_b128 v[28:31], v10 offset:23552
    s_waitcnt lgkmcnt(4)
    v_mfma_f32_16x16x32_bf16 v[164:167], v[52:55], v[80:83], v[164:167]
    ds_read_b128 v[32:35], v10 offset:24576
    s_waitcnt lgkmcnt(4)
    v_mfma_f32_16x16x32_bf16 v[148:151], v[16:19], v[84:87], v[148:151]
    ds_read_b128 v[36:39], v10 offset:25600
    s_add_u32 s37, s71, 0
    buffer_load_dwordx4 v[116:119], v5, s[20:23], s37 offen sc1
    s_waitcnt lgkmcnt(4)
    v_mfma_f32_16x16x32_bf16 v[152:155], v[20:23], v[84:87], v[152:155]
    ds_read_b128 v[40:43], v10 offset:26624
    s_waitcnt lgkmcnt(4)
    v_mfma_f32_16x16x32_bf16 v[156:159], v[24:27], v[84:87], v[156:159]
    ds_read_b128 v[44:47], v10 offset:27648
    s_waitcnt lgkmcnt(4)
    v_mfma_f32_16x16x32_bf16 v[160:163], v[28:31], v[84:87], v[160:163]
    ds_read_b128 v[48:51], v10 offset:28672
    s_waitcnt vmcnt(5)
    v_max3_u32 v15, v88, v92, v96
    v_cmp_eq_u32 vcc, -1, v15
    s_waitcnt lgkmcnt(4)
    v_mfma_f32_16x16x32_bf16 v[164:167], v[32:35], v[84:87], v[164:167]
    ds_read_b128 v[52:55], v10 offset:29696
    s_cbranch_vccnz .bc_retry5
    .bc_ok5:
    s_waitcnt lgkmcnt(4)
    v_mfma_f32_16x16x32_bf16 v[148:151], v[36:39], v[88:91], v[148:151]
    ds_read_b128 v[16:19], v10 offset:30720
    s_add_u32 s37, s71, 16384
    buffer_load_dwordx4 v[120:123], v5, s[20:23], s37 offen sc1
    s_waitcnt lgkmcnt(4)
    v_mfma_f32_16x16x32_bf16 v[152:155], v[40:43], v[88:91], v[152:155]
    ds_read_b128 v[20:23], v10 offset:31744
    s_waitcnt lgkmcnt(4)
    v_mfma_f32_16x16x32_bf16 v[156:159], v[44:47], v[88:91], v[156:159]
    ds_read_b128 v[24:27], v10 offset:32768
    s_waitcnt lgkmcnt(4)
    v_mfma_f32_16x16x32_bf16 v[160:163], v[48:51], v[88:91], v[160:163]
    ds_read_b128 v[28:31], v10 offset:33792
    s_waitcnt lgkmcnt(4)
    v_mfma_f32_16x16x32_bf16 v[164:167], v[52:55], v[88:91], v[164:167]
    ds_read_b128 v[32:35], v10 offset:34816
    s_waitcnt lgkmcnt(4)
    v_mfma_f32_16x16x32_bf16 v[148:151], v[16:19], v[92:95], v[148:151]
    ds_read_b128 v[36:39], v10 offset:35840
    s_add_u32 s37, s71, 32768
    buffer_load_dwordx4 v[124:127], v5, s[20:23], s37 offen sc1
    s_waitcnt lgkmcnt(4)
    v_mfma_f32_16x16x32_bf16 v[152:155], v[20:23], v[92:95], v[152:155]
    ds_read_b128 v[40:43], v10 offset:36864
    s_waitcnt lgkmcnt(4)
    v_mfma_f32_16x16x32_bf16 v[156:159], v[24:27], v[92:95], v[156:159]
    ds_read_b128 v[44:47], v10 offset:37888
    s_waitcnt lgkmcnt(4)
    v_mfma_f32_16x16x32_bf16 v[160:163], v[28:31], v[92:95], v[160:163]
    ds_read_b128 v[48:51], v10 offset:38912
    s_waitcnt lgkmcnt(4)
    v_mfma_f32_16x16x32_bf16 v[164:167], v[32:35], v[92:95], v[164:167]
    ds_read_b128 v[52:55], v10 offset:39936
    s_waitcnt lgkmcnt(4)
    v_mfma_f32_16x16x32_bf16 v[148:151], v[36:39], v[96:99], v[148:151]
    ds_read_b128 v[16:19], v11 offset:0
    s_add_u32 s37, s71, 49152
    buffer_load_dwordx4 v[128:131], v5, s[20:23], s37 offen sc1
    s_waitcnt lgkmcnt(4)
    v_mfma_f32_16x16x32_bf16 v[152:155], v[40:43], v[96:99], v[152:155]
    ds_read_b128 v[20:23], v11 offset:1024
    s_waitcnt lgkmcnt(4)
    v_mfma_f32_16x16x32_bf16 v[156:159], v[44:47], v[96:99], v[156:159]
    ds_read_b128 v[24:27], v11 offset:2048
    s_waitcnt lgkmcnt(4)
    v_mfma_f32_16x16x32_bf16 v[160:163], v[48:51], v[96:99], v[160:163]
    ds_read_b128 v[28:31], v11 offset:3072
    s_waitcnt vmcnt(5)
    v_max3_u32 v15, v100, v104, v108
    v_cmp_eq_u32 vcc, -1, v15
    s_waitcnt lgkmcnt(4)
    v_mfma_f32_16x16x32_bf16 v[164:167], v[52:55], v[96:99], v[164:167]
    ds_read_b128 v[32:35], v11 offset:4096
    s_cbranch_vccnz .bc_retry8
    .bc_ok8:
    s_waitcnt lgkmcnt(4)
    v_mfma_f32_16x16x32_bf16 v[148:151], v[16:19], v[100:103], v[148:151]
    ds_read_b128 v[36:39], v11 offset:5120
    s_add_u32 s36, s33, 0
    s_add_u32 s37, s33, 2048
    buffer_load_dwordx2 v[132:133], v7, s[20:23], s36 offen sc1
    buffer_load_dwordx2 v[134:135], v7, s[20:23], s37 offen sc1
    s_waitcnt lgkmcnt(4)
    v_mfma_f32_16x16x32_bf16 v[152:155], v[20:23], v[100:103], v[152:155]
    ds_read_b128 v[40:43], v11 offset:6144
    s_waitcnt lgkmcnt(4)
    v_mfma_f32_16x16x32_bf16 v[156:159], v[24:27], v[100:103], v[156:159]
    ds_read_b128 v[44:47], v11 offset:7168
    s_waitcnt lgkmcnt(4)
    v_mfma_f32_16x16x32_bf16 v[160:163], v[28:31], v[100:103], v[160:163]
    ds_read_b128 v[48:51], v11 offset:8192
    s_waitcnt lgkmcnt(4)
    v_mfma_f32_16x16x32_bf16 v[164:167], v[32:35], v[100:103], v[164:167]
    ds_read_b128 v[52:55], v11 offset:9216
    s_waitcnt lgkmcnt(4)
    v_mfma_f32_16x16x32_bf16 v[148:151], v[36:39], v[104:107], v[148:151]
    ds_read_b128 v[16:19], v11 offset:10240
    s_add_u32 s36, s33, 16384
    s_add_u32 s37, s33, 18432
    buffer_load_dwordx2 v[136:137], v7, s[20:23], s36 offen sc1
    buffer_load_dwordx2 v[138:139], v7, s[20:23], s37 offen sc1
    s_waitcnt lgkmcnt(4)
    v_mfma_f32_16x16x32_bf16 v[152:155], v[40:43], v[104:107], v[152:155]
    ds_read_b128 v[20:23], v11 offset:11264
    s_waitcnt lgkmcnt(4)
    v_mfma_f32_16x16x32_bf16 v[156:159], v[44:47], v[104:107], v[156:159]
    ds_read_b128 v[24:27], v11 offset:12288
    s_waitcnt lgkmcnt(4)
    v_mfma_f32_16x16x32_bf16 v[160:163], v[48:51], v[104:107], v[160:163]
    ds_read_b128 v[28:31], v11 offset:13312
    s_waitcnt lgkmcnt(4)
    v_mfma_f32_16x16x32_bf16 v[164:167], v[52:55], v[104:107], v[164:167]
    ds_read_b128 v[32:35], v11 offset:14336
    s_waitcnt lgkmcnt(4)
    v_mfma_f32_16x16x32_bf16 v[148:151], v[16:19], v[108:111], v[148:151]
    ds_read_b128 v[36:39], v11 offset:15360
    s_add_u32 s36, s33, 32768
    s_add_u32 s37, s33, 34816
    buffer_load_dwordx2 v[140:141], v7, s[20:23], s36 offen sc1
    buffer_load_dwordx2 v[142:143], v7, s[20:23], s37 offen sc1
    s_waitcnt lgkmcnt(4)
    v_mfma_f32_16x16x32_bf16 v[152:155], v[20:23], v[108:111], v[152:155]
    ds_read_b128 v[40:43], v11 offset:16384
    s_waitcnt lgkmcnt(4)
    v_mfma_f32_16x16x32_bf16 v[156:159], v[24:27], v[108:111], v[156:159]
    ds_read_b128 v[44:47], v11 offset:17408
    s_waitcnt lgkmcnt(4)
    v_mfma_f32_16x16x32_bf16 v[160:163], v[28:31], v[108:111], v[160:163]
    ds_read_b128 v[48:51], v11 offset:18432
    s_waitcnt vmcnt(8)
    v_max3_u32 v15, v112, v116, v120
    v_cmp_eq_u32 vcc, -1, v15
    s_waitcnt lgkmcnt(4)
    v_mfma_f32_16x16x32_bf16 v[164:167], v[32:35], v[108:111], v[164:167]
    ds_read_b128 v[52:55], v11 offset:19456
    s_cbranch_vccnz .bc_retry11
    .bc_ok11:
    s_waitcnt lgkmcnt(4)
    v_mfma_f32_16x16x32_bf16 v[148:151], v[36:39], v[112:115], v[148:151]
    ds_read_b128 v[16:19], v11 offset:20480
    s_add_u32 s36, s33, 49152
    s_add_u32 s37, s33, 51200
    buffer_load_dwordx2 v[144:145], v7, s[20:23], s36 offen sc1
    buffer_load_dwordx2 v[146:147], v7, s[20:23], s37 offen sc1
    s_waitcnt lgkmcnt(4)
    v_mfma_f32_16x16x32_bf16 v[152:155], v[40:43], v[112:115], v[152:155]
    ds_read_b128 v[20:23], v11 offset:21504
    s_waitcnt lgkmcnt(4)
    v_mfma_f32_16x16x32_bf16 v[156:159], v[44:47], v[112:115], v[156:159]
    ds_read_b128 v[24:27], v11 offset:22528
    s_waitcnt lgkmcnt(4)
    v_mfma_f32_16x16x32_bf16 v[160:163], v[48:51], v[112:115], v[160:163]
    ds_read_b128 v[28:31], v11 offset:23552
    s_waitcnt lgkmcnt(4)
    v_mfma_f32_16x16x32_bf16 v[164:167], v[52:55], v[112:115], v[164:167]
    ds_read_b128 v[32:35], v11 offset:24576
    s_waitcnt lgkmcnt(4)
    v_mfma_f32_16x16x32_bf16 v[148:151], v[16:19], v[116:119], v[148:151]
    ds_read_b128 v[36:39], v11 offset:25600
    s_waitcnt lgkmcnt(4)
    v_mfma_f32_16x16x32_bf16 v[152:155], v[20:23], v[116:119], v[152:155]
    ds_read_b128 v[40:43], v11 offset:26624
    s_waitcnt lgkmcnt(4)
    v_mfma_f32_16x16x32_bf16 v[156:159], v[24:27], v[116:119], v[156:159]
    ds_read_b128 v[44:47], v11 offset:27648
    s_waitcnt lgkmcnt(4)
    v_mfma_f32_16x16x32_bf16 v[160:163], v[28:31], v[116:119], v[160:163]
    ds_read_b128 v[48:51], v11 offset:28672
    s_waitcnt lgkmcnt(4)
    v_mfma_f32_16x16x32_bf16 v[164:167], v[32:35], v[116:119], v[164:167]
    ds_read_b128 v[52:55], v11 offset:29696
    s_waitcnt lgkmcnt(4)
    v_mfma_f32_16x16x32_bf16 v[148:151], v[36:39], v[120:123], v[148:151]
    ds_read_b128 v[16:19], v11 offset:30720
    s_waitcnt lgkmcnt(4)
    v_mfma_f32_16x16x32_bf16 v[152:155], v[40:43], v[120:123], v[152:155]
    ds_read_b128 v[20:23], v11 offset:31744
    s_waitcnt lgkmcnt(4)
    v_mfma_f32_16x16x32_bf16 v[156:159], v[44:47], v[120:123], v[156:159]
    ds_read_b128 v[24:27], v11 offset:32768
    s_waitcnt lgkmcnt(4)
    v_mfma_f32_16x16x32_bf16 v[160:163], v[48:51], v[120:123], v[160:163]
    ds_read_b128 v[28:31], v11 offset:33792
    s_waitcnt vmcnt(8)
    v_max_u32 v15, v124, v128
    v_cmp_eq_u32 vcc, -1, v15
    s_waitcnt lgkmcnt(4)
    v_mfma_f32_16x16x32_bf16 v[164:167], v[52:55], v[120:123], v[164:167]
    ds_read_b128 v[32:35], v11 offset:34816
    s_cbranch_vccnz .bc_retry14
    .bc_ok14:
    s_waitcnt lgkmcnt(4)
    v_mfma_f32_16x16x32_bf16 v[148:151], v[16:19], v[124:127], v[148:151]
    ds_read_b128 v[36:39], v11 offset:35840
    s_waitcnt lgkmcnt(4)
    v_mfma_f32_16x16x32_bf16 v[152:155], v[20:23], v[124:127], v[152:155]
    ds_read_b128 v[40:43], v11 offset:36864
    s_waitcnt lgkmcnt(4)
    v_mfma_f32_16x16x32_bf16 v[156:159], v[24:27], v[124:127], v[156:159]
    ds_read_b128 v[44:47], v11 offset:37888
    s_waitcnt lgkmcnt(4)
    v_mfma_f32_16x16x32_bf16 v[160:163], v[28:31], v[124:127], v[160:163]
    ds_read_b128 v[48:51], v11 offset:38912
    s_waitcnt lgkmcnt(4)
    v_mfma_f32_16x16x32_bf16 v[164:167], v[32:35], v[124:127], v[164:167]
    ds_read_b128 v[52:55], v11 offset:39936
    s_waitcnt lgkmcnt(4)
    v_mfma_f32_16x16x32_bf16 v[148:151], v[36:39], v[128:131], v[148:151]
    ds_read_b128 v[16:19], v1 offset:46080
    s_waitcnt lgkmcnt(4)
    v_mfma_f32_16x16x32_bf16 v[152:155], v[40:43], v[128:131], v[152:155]
    ds_read_b128 v[20:23], v1 offset:47104
    s_waitcnt lgkmcnt(4)
    v_mfma_f32_16x16x32_bf16 v[156:159], v[44:47], v[128:131], v[156:159]
    ds_read_b128 v[24:27], v1 offset:48128
    s_waitcnt lgkmcnt(4)
    v_mfma_f32_16x16x32_bf16 v[160:163], v[48:51], v[128:131], v[160:163]
    ds_read_b128 v[28:31], v1 offset:49152
    s_waitcnt vmcnt(4)
    v_max_u32 v15, v132, v134
    v_max3_u32 v15, v15, v136, v138
    v_cmp_eq_u32 vcc, -1, v15
    s_waitcnt lgkmcnt(4)
    v_mfma_f32_16x16x32_bf16 v[164:167], v[52:55], v[128:131], v[164:167]
    ds_read_b128 v[32:35], v1 offset:50176
    s_cbranch_vccnz .bc_retry16
    .bc_ok16:
    s_waitcnt lgkmcnt(4)
    v_mfma_f32_16x16x32_bf16 v[148:151], v[16:19], v[132:135], v[148:151]
    ds_read_b128 v[36:39], v1 offset:51200
    s_waitcnt lgkmcnt(4)
    v_mfma_f32_16x16x32_bf16 v[152:155], v[20:23], v[132:135], v[152:155]
    ds_read_b128 v[40:43], v1 offset:52224
    s_waitcnt lgkmcnt(4)
    v_mfma_f32_16x16x32_bf16 v[156:159], v[24:27], v[132:135], v[156:159]
    ds_read_b128 v[44:47], v1 offset:53248
    s_waitcnt lgkmcnt(4)
    v_mfma_f32_16x16x32_bf16 v[160:163], v[28:31], v[132:135], v[160:163]
    ds_read_b128 v[48:51], v1 offset:54272
    s_waitcnt lgkmcnt(4)
    v_mfma_f32_16x16x32_bf16 v[164:167], v[32:35], v[132:135], v[164:167]
    ds_read_b128 v[52:55], v1 offset:55296
    s_waitcnt lgkmcnt(4)
    v_mfma_f32_16x16x32_bf16 v[148:151], v[36:39], v[136:139], v[148:151]
    ds_read_b128 v[16:19], v1 offset:56320
    s_waitcnt lgkmcnt(4)
    v_mfma_f32_16x16x32_bf16 v[152:155], v[40:43], v[136:139], v[152:155]
    ds_read_b128 v[20:23], v1 offset:57344
    s_waitcnt lgkmcnt(4)
    v_mfma_f32_16x16x32_bf16 v[156:159], v[44:47], v[136:139], v[156:159]
    ds_read_b128 v[24:27], v1 offset:58368
    s_waitcnt lgkmcnt(4)
    v_mfma_f32_16x16x32_bf16 v[160:163], v[48:51], v[136:139], v[160:163]
    ds_read_b128 v[28:31], v1 offset:59392
    s_waitcnt vmcnt(0)
    v_max_u32 v15, v140, v142
    v_max3_u32 v15, v15, v144, v146
    v_cmp_eq_u32 vcc, -1, v15
    s_waitcnt lgkmcnt(4)
    v_mfma_f32_16x16x32_bf16 v[164:167], v[52:55], v[136:139], v[164:167]
    ds_read_b128 v[32:35], v1 offset:60416
    s_cbranch_vccnz .bc_retry18
    .bc_ok18:
    s_waitcnt lgkmcnt(4)
    v_mfma_f32_16x16x32_bf16 v[148:151], v[16:19], v[140:143], v[148:151]
    ds_read_b128 v[36:39], v11 offset:40960
    s_waitcnt lgkmcnt(4)
    v_mfma_f32_16x16x32_bf16 v[152:155], v[20:23], v[140:143], v[152:155]
    ds_read_b128 v[40:43], v11 offset:41984
    s_waitcnt lgkmcnt(4)
    v_mfma_f32_16x16x32_bf16 v[156:159], v[24:27], v[140:143], v[156:159]
    ds_read_b128 v[44:47], v11 offset:43008
    s_waitcnt lgkmcnt(4)
    v_mfma_f32_16x16x32_bf16 v[160:163], v[28:31], v[140:143], v[160:163]
    ds_read_b128 v[48:51], v11 offset:44032
    s_waitcnt lgkmcnt(4)
    v_mfma_f32_16x16x32_bf16 v[164:167], v[32:35], v[140:143], v[164:167]
    ds_read_b128 v[52:55], v11 offset:45056
    s_waitcnt lgkmcnt(4)
    v_mfma_f32_16x16x32_bf16 v[148:151], v[36:39], v[144:147], v[148:151]
    s_waitcnt lgkmcnt(3)
    v_mfma_f32_16x16x32_bf16 v[152:155], v[40:43], v[144:147], v[152:155]
    s_waitcnt lgkmcnt(2)
    v_mfma_f32_16x16x32_bf16 v[156:159], v[44:47], v[144:147], v[156:159]
    s_waitcnt lgkmcnt(1)
    v_mfma_f32_16x16x32_bf16 v[160:163], v[48:51], v[144:147], v[160:163]
    s_waitcnt lgkmcnt(0)
    v_mfma_f32_16x16x32_bf16 v[164:167], v[52:55], v[144:147], v[164:167]
    s_mov_b32 s53, 0x40000
    s_waitcnt vmcnt(0)
    v_cmp_ne_u32 vcc, v8, v67
    s_cbranch_vccnz .bc_gate
    .bc_gateok:
    v_lshlrev_b32 v68, 16, v56
    v_and_b32 v69, 0xffff0000, v56
    v_lshlrev_b32 v70, 16, v57
    v_and_b32 v71, 0xffff0000, v57
    v_lshlrev_b32 v72, 16, v58
    v_and_b32 v73, 0xffff0000, v58
    v_lshlrev_b32 v74, 16, v59
    v_and_b32 v75, 0xffff0000, v59
    v_lshlrev_b32 v76, 16, v60
    v_and_b32 v77, 0xffff0000, v60
    v_lshlrev_b32 v78, 16, v61
    v_and_b32 v79, 0xffff0000, v61
    v_lshlrev_b32 v80, 16, v62
    v_and_b32 v81, 0xffff0000, v62
    v_lshlrev_b32 v82, 16, v63
    v_and_b32 v83, 0xffff0000, v63
    v_lshlrev_b32 v84, 16, v64
    v_and_b32 v85, 0xffff0000, v64
    v_lshlrev_b32 v86, 16, v65
    v_and_b32 v87, 0xffff0000, v65
    v_sub_f32 v67, 1.0, v66
    s_cmp_lg_u32 s45, 0
    s_cbranch_scc1 .bc_upd
.bc_fin:
    v_cvt_pk_bf16_f32 v67, 0, v67
    v_pk_mul_f32 v[68:69], v[68:69], v[66:67] op_sel:[0,1] op_sel_hi:[1,1]
    v_pk_mul_f32 v[70:71], v[70:71], v[66:67] op_sel:[0,1] op_sel_hi:[1,1]
    v_pk_mul_f32 v[72:73], v[72:73], v[66:67] op_sel:[0,1] op_sel_hi:[1,1]
    v_pk_mul_f32 v[74:75], v[74:75], v[66:67] op_sel:[0,1] op_sel_hi:[1,1]
    v_pk_mul_f32 v[76:77], v[76:77], v[66:67] op_sel:[0,1] op_sel_hi:[1,1]
    v_pk_mul_f32 v[78:79], v[78:79], v[66:67] op_sel:[0,1] op_sel_hi:[1,1]
    v_pk_mul_f32 v[80:81], v[80:81], v[66:67] op_sel:[0,1] op_sel_hi:[1,1]
    v_pk_mul_f32 v[82:83], v[82:83], v[66:67] op_sel:[0,1] op_sel_hi:[1,1]
    v_pk_mul_f32 v[84:85], v[84:85], v[66:67] op_sel:[0,1] op_sel_hi:[1,1]
    v_pk_mul_f32 v[86:87], v[86:87], v[66:67] op_sel:[0,1] op_sel_hi:[1,1]
    v_pk_fma_f32 v[68:69], v[148:149], v[66:67], v[68:69] op_sel_hi:[1,0,1]
    v_pk_fma_f32 v[70:71], v[150:151], v[66:67], v[70:71] op_sel_hi:[1,0,1]
    v_pk_fma_f32 v[72:73], v[152:153], v[66:67], v[72:73] op_sel_hi:[1,0,1]
    v_pk_fma_f32 v[74:75], v[154:155], v[66:67], v[74:75] op_sel_hi:[1,0,1]
    v_pk_fma_f32 v[76:77], v[156:157], v[66:67], v[76:77] op_sel_hi:[1,0,1]
    v_pk_fma_f32 v[78:79], v[158:159], v[66:67], v[78:79] op_sel_hi:[1,0,1]
    v_pk_fma_f32 v[80:81], v[160:161], v[66:67], v[80:81] op_sel_hi:[1,0,1]
    v_pk_fma_f32 v[82:83], v[162:163], v[66:67], v[82:83] op_sel_hi:[1,0,1]
    v_pk_fma_f32 v[84:85], v[164:165], v[66:67], v[84:85] op_sel_hi:[1,0,1]
    v_pk_fma_f32 v[86:87], v[166:167], v[66:67], v[86:87] op_sel_hi:[1,0,1]
    v_cvt_pk_bf16_f32 v24, v68, v69
    v_cvt_pk_bf16_f32 v25, v70, v71
    v_cvt_pk_bf16_f32 v26, v72, v73
    v_cvt_pk_bf16_f32 v27, v74, v75
    v_cvt_pk_bf16_f32 v28, v76, v77
    v_cvt_pk_bf16_f32 v29, v78, v79
    v_cvt_pk_bf16_f32 v30, v80, v81
    v_cvt_pk_bf16_f32 v31, v82, v83
    v_cvt_pk_bf16_f32 v32, v84, v85
    v_cvt_pk_bf16_f32 v33, v86, v87
    buffer_store_dwordx4 v[24:27], v13, s[16:19], s39 offen
    buffer_store_dwordx4 v[28:31], v13, s[16:19], s39 offen offset:64
    buffer_store_dwordx2 v[32:33], v12, s[16:19], s39 offen offset:128
.bc_end:
    s_endpgm
.bc_upd:
    v_lshl_add_u32 v17, v2, 2, v6
    ds_read_b32 v17, v17 offset:64
    v_mov_b32 v18, 152576
    s_mov_b64 s[66:67], 0
    s_waitcnt lgkmcnt(0)
    v_readlane_b32 s46, v17, 0
    v_mov_b32 v19, 152576
    s_nop 0
    v_cmp_eq_u32 vcc, s46, v14
    s_or_b64 s[66:67], s[66:67], vcc
    s_nop 0
    v_cndmask_b32 v18, v18, v19, vcc
    v_readlane_b32 s46, v17, 1
    v_mov_b32 v19, 152896
    s_nop 0
    v_cmp_eq_u32 vcc, s46, v14
    s_or_b64 s[66:67], s[66:67], vcc
    s_nop 0
    v_cndmask_b32 v18, v18, v19, vcc
    v_readlane_b32 s46, v17, 2
    v_mov_b32 v19, 153216
    s_nop 0
    v_cmp_eq_u32 vcc, s46, v14
    s_or_b64 s[66:67], s[66:67], vcc
    s_nop 0
    v_cndmask_b32 v18, v18, v19, vcc
    v_readlane_b32 s46, v17, 3
    v_mov_b32 v19, 153536
    s_nop 0
    v_cmp_eq_u32 vcc, s46, v14
    s_or_b64 s[66:67], s[66:67], vcc
    s_nop 0
    v_cndmask_b32 v18, v18, v19, vcc
    v_readlane_b32 s46, v17, 4
    v_mov_b32 v19, 153856
    s_nop 0
    v_cmp_eq_u32 vcc, s46, v14
    s_or_b64 s[66:67], s[66:67], vcc
    s_nop 0
    v_cndmask_b32 v18, v18, v19, vcc
    v_readlane_b32 s46, v17, 5
    v_mov_b32 v19, 154176
    s_nop 0
    v_cmp_eq_u32 vcc, s46, v14
    s_or_b64 s[66:67], s[66:67], vcc
    s_nop 0
    v_cndmask_b32 v18, v18, v19, vcc
    v_readlane_b32 s46, v17, 6
    v_mov_b32 v19, 154496
    s_nop 0
    v_cmp_eq_u32 vcc, s46, v14
    s_or_b64 s[66:67], s[66:67], vcc
    s_nop 0
    v_cndmask_b32 v18, v18, v19, vcc
    v_readlane_b32 s46, v17, 7
    v_mov_b32 v19, 154816
    s_nop 0
    v_cmp_eq_u32 vcc, s46, v14
    s_or_b64 s[66:67], s[66:67], vcc
    s_nop 0
    v_cndmask_b32 v18, v18, v19, vcc
    v_lshl_add_u32 v19, v4, 4, v18
    v_lshl_add_u32 v18, v4, 5, v18
    s_mov_b32 s54, 0x200000
    .ga_lw23:
    ds_read_b32 v15, v6 offset:16
    s_sub_u32 s54, s54, 1
    s_waitcnt lgkmcnt(0)
    v_readfirstlane_b32 s53, v15
    s_cmp_eq_u32 s54, 0
    s_cbranch_scc1 .ga_lwd24
    s_cmp_ge_u32 s53, 1
    s_cbranch_scc1 .ga_lwd24
    s_sleep 1
    s_branch .ga_lw23
    .ga_lwd24:
    ds_read_b128 v[88:91], v18 offset:0
    ds_read_b128 v[92:95], v18 offset:16
    ds_read_b128 v[96:99], v18 offset:128
    ds_read_b128 v[100:103], v18 offset:144
    ds_read_b128 v[104:107], v19 offset:256
    s_mov_b64 exec, s[66:67]
    s_waitcnt lgkmcnt(0)
    v_pk_add_f32 v[68:69], v[68:69], v[88:89]
    v_pk_add_f32 v[70:71], v[70:71], v[90:91]
    v_pk_add_f32 v[72:73], v[72:73], v[92:93]
    v_pk_add_f32 v[74:75], v[74:75], v[94:95]
    v_pk_add_f32 v[76:77], v[76:77], v[96:97]
    v_pk_add_f32 v[78:79], v[78:79], v[98:99]
    v_pk_add_f32 v[80:81], v[80:81], v[100:101]
    v_pk_add_f32 v[82:83], v[82:83], v[102:103]
    v_pk_add_f32 v[84:85], v[84:85], v[104:105]
    v_pk_add_f32 v[86:87], v[86:87], v[106:107]
    s_mov_b64 exec, -1
    s_branch .bc_fin
.bc_retry0:
    s_add_u32 s37, s68, 0
    buffer_load_dwordx4 v[68:71], v5, s[20:23], s37 offen sc1
    s_add_u32 s37, s68, 16384
    buffer_load_dwordx4 v[72:75], v5, s[20:23], s37 offen sc1
    s_add_u32 s37, s68, 32768
    buffer_load_dwordx4 v[76:79], v5, s[20:23], s37 offen sc1
    s_add_u32 s37, s68, 49152
    buffer_load_dwordx4 v[80:83], v5, s[20:23], s37 offen sc1
    s_add_u32 s37, s69, 0
    buffer_load_dwordx4 v[84:87], v5, s[20:23], s37 offen sc1
    s_max_u32 s55, s55, 1
    s_sub_u32 s55, s55, 1
    s_cmp_lg_u32 s55, 0
    s_waitcnt vmcnt(0)
    v_max_u32 v15, v68, v72
    v_cmp_eq_u32 vcc, -1, v15
    s_cbranch_scc0 .bc_ok0
    s_cbranch_vccnz .bc_retry0
    s_branch .bc_ok0
.bc_retry2:
    s_add_u32 s37, s68, 32768
    buffer_load_dwordx4 v[76:79], v5, s[20:23], s37 offen sc1
    s_add_u32 s37, s68, 49152
    buffer_load_dwordx4 v[80:83], v5, s[20:23], s37 offen sc1
    s_add_u32 s37, s69, 0
    buffer_load_dwordx4 v[84:87], v5, s[20:23], s37 offen sc1
    s_add_u32 s37, s69, 16384
    buffer_load_dwordx4 v[88:91], v5, s[20:23], s37 offen sc1
    s_add_u32 s37, s69, 32768
    buffer_load_dwordx4 v[92:95], v5, s[20:23], s37 offen sc1
    s_add_u32 s37, s69, 49152
    buffer_load_dwordx4 v[96:99], v5, s[20:23], s37 offen sc1
    s_max_u32 s55, s55, 1
    s_sub_u32 s55, s55, 1
    s_cmp_lg_u32 s55, 0
    s_waitcnt vmcnt(0)
    v_max3_u32 v15, v76, v80, v84
    v_cmp_eq_u32 vcc, -1, v15
    s_cbranch_scc0 .bc_ok2
    s_cbranch_vccnz .bc_retry2
    s_branch .bc_ok2
.bc_retry5:
    s_add_u32 s37, s69, 16384
    buffer_load_dwordx4 v[88:91], v5, s[20:23], s37 offen sc1
    s_add_u32 s37, s69, 32768
    buffer_load_dwordx4 v[92:95], v5, s[20:23], s37 offen sc1
    s_add_u32 s37, s69, 49152
    buffer_load_dwordx4 v[96:99], v5, s[20:23], s37 offen sc1
    s_add_u32 s37, s70, 0
    buffer_load_dwordx4 v[100:103], v5, s[20:23], s37 offen sc1
    s_add_u32 s37, s70, 16384
    buffer_load_dwordx4 v[104:107], v5, s[20:23], s37 offen sc1
    s_add_u32 s37, s70, 32768
    buffer_load_dwordx4 v[108:111], v5, s[20:23], s37 offen sc1
    s_max_u32 s55, s55, 1
    s_sub_u32 s55, s55, 1
    s_cmp_lg_u32 s55, 0
    s_waitcnt vmcnt(0)
    v_max3_u32 v15, v88, v92, v96
    v_cmp_eq_u32 vcc, -1, v15
    s_cbranch_scc0 .bc_ok5
    s_cbranch_vccnz .bc_retry5
    s_branch .bc_ok5
.bc_retry8:
    s_add_u32 s37, s70, 0
    buffer_load_dwordx4 v[100:103], v5, s[20:23], s37 offen sc1
    s_add_u32 s37, s70, 16384
    buffer_load_dwordx4 v[104:107], v5, s[20:23], s37 offen sc1
    s_add_u32 s37, s70, 32768
    buffer_load_dwordx4 v[108:111], v5, s[20:23], s37 offen sc1
    s_add_u32 s37, s70, 49152
    buffer_load_dwordx4 v[112:115], v5, s[20:23], s37 offen sc1
    s_add_u32 s37, s71, 0
    buffer_load_dwordx4 v[116:119], v5, s[20:23], s37 offen sc1
    s_add_u32 s37, s71, 16384
    buffer_load_dwordx4 v[120:123], v5, s[20:23], s37 offen sc1
    s_max_u32 s55, s55, 1
    s_sub_u32 s55, s55, 1
    s_cmp_lg_u32 s55, 0
    s_waitcnt vmcnt(0)
    v_max3_u32 v15, v100, v104, v108
    v_cmp_eq_u32 vcc, -1, v15
    s_cbranch_scc0 .bc_ok8
    s_cbranch_vccnz .bc_retry8
    s_branch .bc_ok8
.bc_retry11:
    s_add_u32 s37, s70, 49152
    buffer_load_dwordx4 v[112:115], v5, s[20:23], s37 offen sc1
    s_add_u32 s37, s71, 0
    buffer_load_dwordx4 v[116:119], v5, s[20:23], s37 offen sc1
    s_add_u32 s37, s71, 16384
    buffer_load_dwordx4 v[120:123], v5, s[20:23], s37 offen sc1
    s_add_u32 s37, s71, 32768
    buffer_load_dwordx4 v[124:127], v5, s[20:23], s37 offen sc1
    s_add_u32 s37, s71, 49152
    buffer_load_dwordx4 v[128:131], v5, s[20:23], s37 offen sc1
    s_max_u32 s55, s55, 1
    s_sub_u32 s55, s55, 1
    s_cmp_lg_u32 s55, 0
    s_waitcnt vmcnt(0)
    v_max3_u32 v15, v112, v116, v120
    v_cmp_eq_u32 vcc, -1, v15
    s_cbranch_scc0 .bc_ok11
    s_cbranch_vccnz .bc_retry11
    s_branch .bc_ok11
.bc_retry14:
    s_add_u32 s37, s71, 32768
    buffer_load_dwordx4 v[124:127], v5, s[20:23], s37 offen sc1
    s_add_u32 s37, s71, 49152
    buffer_load_dwordx4 v[128:131], v5, s[20:23], s37 offen sc1
    s_add_u32 s36, s33, 0
    s_add_u32 s37, s33, 2048
    buffer_load_dwordx2 v[132:133], v7, s[20:23], s36 offen sc1
    buffer_load_dwordx2 v[134:135], v7, s[20:23], s37 offen sc1
    s_add_u32 s36, s33, 16384
    s_add_u32 s37, s33, 18432
    buffer_load_dwordx2 v[136:137], v7, s[20:23], s36 offen sc1
    buffer_load_dwordx2 v[138:139], v7, s[20:23], s37 offen sc1
    s_max_u32 s55, s55, 1
    s_sub_u32 s55, s55, 1
    s_cmp_lg_u32 s55, 0
    s_waitcnt vmcnt(0)
    v_max_u32 v15, v124, v128
    v_cmp_eq_u32 vcc, -1, v15
    s_cbranch_scc0 .bc_ok14
    s_cbranch_vccnz .bc_retry14
    s_branch .bc_ok14
.bc_retry16:
    s_add_u32 s36, s33, 0
    s_add_u32 s37, s33, 2048
    buffer_load_dwordx2 v[132:133], v7, s[20:23], s36 offen sc1
    buffer_load_dwordx2 v[134:135], v7, s[20:23], s37 offen sc1
    s_add_u32 s36, s33, 16384
    s_add_u32 s37, s33, 18432
    buffer_load_dwordx2 v[136:137], v7, s[20:23], s36 offen sc1
    buffer_load_dwordx2 v[138:139], v7, s[20:23], s37 offen sc1
    s_add_u32 s36, s33, 32768
    s_add_u32 s37, s33, 34816
    buffer_load_dwordx2 v[140:141], v7, s[20:23], s36 offen sc1
    buffer_load_dwordx2 v[142:143], v7, s[20:23], s37 offen sc1
    s_add_u32 s36, s33, 49152
    s_add_u32 s37, s33, 51200
    buffer_load_dwordx2 v[144:145], v7, s[20:23], s36 offen sc1
    buffer_load_dwordx2 v[146:147], v7, s[20:23], s37 offen sc1
    s_max_u32 s55, s55, 1
    s_sub_u32 s55, s55, 1
    s_cmp_lg_u32 s55, 0
    s_waitcnt vmcnt(0)
    v_max_u32 v15, v132, v134
    v_max3_u32 v15, v15, v136, v138
    v_cmp_eq_u32 vcc, -1, v15
    s_cbranch_scc0 .bc_ok16
    s_cbranch_vccnz .bc_retry16
    s_branch .bc_ok16
.bc_retry18:
    s_add_u32 s36, s33, 32768
    s_add_u32 s37, s33, 34816
    buffer_load_dwordx2 v[140:141], v7, s[20:23], s36 offen sc1
    buffer_load_dwordx2 v[142:143], v7, s[20:23], s37 offen sc1
    s_add_u32 s36, s33, 49152
    s_add_u32 s37, s33, 51200
    buffer_load_dwordx2 v[144:145], v7, s[20:23], s36 offen sc1
    buffer_load_dwordx2 v[146:147], v7, s[20:23], s37 offen sc1
    s_max_u32 s55, s55, 1
    s_sub_u32 s55, s55, 1
    s_cmp_lg_u32 s55, 0
    s_waitcnt vmcnt(0)
    v_max_u32 v15, v140, v142
    v_max3_u32 v15, v15, v144, v146
    v_cmp_eq_u32 vcc, -1, v15
    s_cbranch_scc0 .bc_ok18
    s_cbranch_vccnz .bc_retry18
    s_branch .bc_ok18
    .bc_gate:
    buffer_load_dwordx2 v[66:67], v9, s[20:23], s34 offen sc1
    s_sub_u32 s53, s53, 1
    s_waitcnt vmcnt(0)
    v_cmp_ne_u32 vcc, v8, v67
    s_cmp_eq_u32 s53, 0
    s_cbranch_scc1 .bc_gateok
    s_cbranch_vccnz .bc_gate
    s_branch .bc_gateok
.a_aux:
    s_load_dwordx2 s[64:65], s[0:1], 80
    s_mov_b32 s66, 256
    s_mov_b32 s67, 0x20000
    v_mov_b32 v120, 0
    s_sub_u32 s3, s3, 8
    s_cmp_lg_u32 s3, 0
    s_cbranch_scc1 .a_cpf
    s_getpc_b64 s[60:61]
    .a_pc:
    s_sub_u32 s60, s60, .a_pc-gated_mix__sliding_block__moe_arch_mod__prompt_kernel
    s_subb_u32 s61, s61, 0
    s_lshl_b32 s62, s25, 4
    v_add_u32 v60, s62, v2
    v_lshlrev_b32 v60, 7, v60
    v_min_u32 v60, .code_hot_end-gated_mix__sliding_block__moe_arch_mod__prompt_kernel-4, v60
    s_mov_b64 exec, 0xffff
    global_load_dword v61, v60, s[60:61]
    s_mov_b64 exec, -1
    v_lshlrev_b32 v9, 2, v2
    v_add_u32 v9, 161792, v9
    s_sub_u32 s54, s25, 24
    s_cmp_lt_u32 s54, 6
    s_cselect_b32 s54, 0, 2
    v_mov_b32 v8, 0
    v_writelane_b32 v8, s54, 2
    s_cmp_lt_u32 s25, 24
    s_cselect_b32 s54, 1, 0
    v_writelane_b32 v8, s54, 15
    ds_write_b32 v9, v8
    .a_cpf:
    s_memrealtime s[58:59]
    s_waitcnt lgkmcnt(0)
    s_mov_b32 s20, s8
    s_mov_b32 s21, s9
    s_lshl_b32 s57, s2, 2
    s_add_u32 s57, s57, s3
    s_cmp_lg_u32 s57, 1
    s_cbranch_scc1 .a_notag
    s_or_b32 s58, s58, 1
    v_mov_b32 v121, s58
    s_mov_b64 exec, 1
    buffer_store_dword v121, v120, s[64:67], 0 offen sc1
    s_mov_b64 exec, -1
    .a_notag:
    s_cmp_ge_u32 s25, 24
    s_cbranch_scc1 .a_rg
    s_mul_i32 s70, s27, 40960
    s_mul_i32 s71, s26, 327680
    s_add_u32 s70, s70, s71
    s_mul_i32 s71, s3, 10240
    s_add_u32 s70, s70, s71
    s_lshl_b32 s71, s26, 4
    s_add_u32 s71, s71, s27
    s_lshl_b32 s71, s71, 7
    s_add_u32 s71, s71, 11350528
    v_mov_b32 v100, -1
    v_mov_b32 v101, -1
    v_mov_b32 v102, -1
    v_mov_b32 v103, -1
    v_lshlrev_b32 v104, 4, v2
    v_lshlrev_b32 v105, 2, v2
    s_barrier
    s_barrier
    s_cmp_lg_u32 s3, 3
    s_cbranch_scc1 .ga_ih25
    s_mov_b64 exec, 1
    buffer_load_dword v121, v120, s[64:67], 0 offen sc1
    s_mov_b64 exec, -1
.ga_ih25:
    s_barrier
    s_barrier
    s_cmp_lg_u32 s3, 3
    s_cbranch_scc1 .ga_ih26
    s_mov_b64 exec, 1
    s_mov_b32 s56, 0x40000
    .ga_ip27:
    s_sub_u32 s56, s56, 1
    s_waitcnt vmcnt(0)
    v_cmp_eq_u32 vcc, 0, v121
    s_cmp_eq_u32 s56, 0
    s_cbranch_scc1 .ga_ipd28
    s_cbranch_vccz .ga_ipd28
    s_sleep 2
    buffer_load_dword v121, v120, s[64:67], 0 offen sc1
    s_branch .ga_ip27
    .ga_ipd28:
    v_mov_b32 v122, 161792
    ds_write_b32 v122, v121 offset:48
    s_mov_b64 exec, -1
    s_waitcnt lgkmcnt(0)
.ga_ih26:
    s_barrier
    s_barrier
    s_barrier
    s_barrier
    s_barrier
    s_barrier
.b_aux:
    s_setprio 3
    v_and_b32 v7, 7, v2
    v_lshlrev_b32 v22, 4, v2
    v_mov_b32 v6, 161792
    ds_read_b32 v8, v6 offset:48
    v_mov_b32 v9, 1
    v_lshlrev_b32 v0, 2, v2
    v_lshlrev_b32 v16, 7, v2
    s_waitcnt lgkmcnt(0)
    s_cmp_eq_u32 s3, 0
    s_cbranch_scc1 .bc_phasec
    s_cmp_eq_u32 s3, 1
    s_cbranch_scc1 .bc_getsel
    v_lshlrev_b32 v17, 11, v2
    s_mov_b32 s57, 11352448
    v_mov_b32 v11, 8
    s_cmp_lg_u32 s3, 3
    s_cbranch_scc1 .bc_nowc
    s_mov_b32 s54, 0x200000
    .ga_lw29:
    ds_read_b32 v10, v6 offset:36
    s_sub_u32 s54, s54, 1
    s_waitcnt lgkmcnt(0)
    v_readfirstlane_b32 s53, v10
    s_cmp_eq_u32 s54, 0
    s_cbranch_scc1 .ga_lwd30
    s_cmp_ge_u32 s53, 8
    s_cbranch_scc1 .ga_lwd30
    s_sleep 2
    s_branch .ga_lw29
    .ga_lwd30:
    s_mov_b32 exec_lo, 0xffff
    s_mov_b32 exec_hi, 0x0
    s_mov_b32 s53, 0x40000
    .ga_gw31:
    buffer_load_dword v10, v17, s[20:23], s57 offen sc1
    s_sub_u32 s53, s53, 1
    s_waitcnt vmcnt(0)
    v_cmp_ne_u32 vcc, v8, v10
    s_cmp_eq_u32 s53, 0
    s_cbranch_scc1 .ga_gwd32
    s_cbranch_vccz .ga_gwd32
    s_mov_b64 exec, vcc
    s_sleep 2
    s_branch .ga_gw31
    .ga_gwd32:
    s_mov_b64 exec, -1
    s_mov_b32 s57, 11391488
    s_mov_b32 exec_lo, 0xffffffff
    s_mov_b32 exec_hi, 0xffffffff
    s_mov_b32 s53, 0x40000
    .ga_gw33:
    buffer_load_dword v10, v16, s[20:23], s57 offen sc1
    s_sub_u32 s53, s53, 1
    s_waitcnt vmcnt(0)
    v_cmp_ne_u32 vcc, v8, v10
    s_cmp_eq_u32 s53, 0
    s_cbranch_scc1 .ga_gwd34
    s_cbranch_vccz .ga_gwd34
    s_mov_b64 exec, vcc
    s_sleep 2
    s_branch .ga_gw33
    .ga_gwd34:
    s_mov_b64 exec, -1
    s_mov_b64 exec, 1
    ds_add_u32 v6, v11 offset:8
    s_mov_b64 exec, -1
.bc_nowc:
    s_cmp_lg_u32 s3, 2
    s_cbranch_scc1 .bc_nov
    s_lshl_b32 s58, s24, 2
    s_and_b32 s59, s25, 3
    s_add_u32 s58, s58, s59
    s_mul_i32 s58, s58, 320
    s_lshr_b32 s59, s25, 2
    s_mul_i32 s60, s59, 327680
    s_add_u32 s58, s58, s60
    s_add_u32 s58, s58, 7864320
    s_cmp_eq_u32 s59, 0
    s_cselect_b32 s59, 0, 327680
    s_sub_u32 s59, s58, s59
    v_mul_u32_u24 v14, 3121, v2
    v_lshrrev_b32 v14, 16, v14
    v_mul_u32_u24 v14, 9904, v14
    v_add_u32 v14, v14, v22
    v_mov_b32 v11, 8
    s_lshr_b32 s60, s25, 2
    s_lshl_b32 s60, s60, 1
    s_sub_u32 s60, s60, 2
    v_add_u32 v15, s60, v2
    v_max_i32 v15, 0, v15
    v_lshlrev_b32 v15, 11, v15
    s_lshr_b32 s61, s24, 1
    s_lshl_b32 s61, s61, 7
    s_add_u32 s61, s61, 11351552
    s_mov_b32 s54, 0x200000
    .ga_lw35:
    ds_read_b32 v10, v6 offset:36
    s_sub_u32 s54, s54, 1
    s_waitcnt lgkmcnt(0)
    v_readfirstlane_b32 s53, v10
    s_cmp_eq_u32 s54, 0
    s_cbranch_scc1 .ga_lwd36
    s_cmp_ge_u32 s53, 1
    s_cbranch_scc1 .ga_lwd36
    s_sleep 0
    s_branch .ga_lw35
    .ga_lwd36:
    s_mov_b32 exec_lo, 0xf
    s_mov_b32 exec_hi, 0x0
    s_mov_b32 s53, 0x40000
    .ga_gw37:
    buffer_load_dword v10, v15, s[20:23], s61 offen sc1
    s_sub_u32 s53, s53, 1
    s_waitcnt vmcnt(0)
    v_cmp_ne_u32 vcc, v8, v10
    s_cmp_eq_u32 s53, 0
    s_cbranch_scc1 .ga_gwd38
    s_cbranch_vccz .ga_gwd38
    s_mov_b64 exec, vcc
    s_sleep 1
    s_branch .ga_gw37
    .ga_gwd38:
    s_mov_b64 exec, -1
    s_mov_b32 exec_lo, 0xffefffff
    s_mov_b32 exec_hi, 0x3ffffdff
    s_mov_b32 m0, 24576
    s_add_u32 s60, s59, 0
    buffer_load_dwordx4 v14, s[20:23], s60 offen sc1 lds
    s_mov_b32 m0, 25584
    s_add_u32 s60, s59, 30720
    buffer_load_dwordx4 v14, s[20:23], s60 offen sc1 lds
    s_mov_b32 m0, 26592
    s_add_u32 s60, s59, 61440
    buffer_load_dwordx4 v14, s[20:23], s60 offen sc1 lds
    s_mov_b32 m0, 27600
    s_add_u32 s60, s59, 92160
    buffer_load_dwordx4 v14, s[20:23], s60 offen sc1 lds
    s_mov_b32 m0, 28608
    s_add_u32 s60, s59, 122880
    buffer_load_dwordx4 v14, s[20:23], s60 offen sc1 lds
    s_mov_b32 m0, 29616
    s_add_u32 s60, s59, 153600
    buffer_load_dwordx4 v14, s[20:23], s60 offen sc1 lds
    s_mov_b32 m0, 30624
    s_add_u32 s60, s59, 184320
    buffer_load_dwordx4 v14, s[20:23], s60 offen sc1 lds
    s_mov_b32 m0, 31632
    s_add_u32 s60, s59, 215040
    buffer_load_dwordx4 v14, s[20:23], s60 offen sc1 lds
    s_mov_b32 m0, 32640
    s_add_u32 s60, s59, 245760
    buffer_load_dwordx4 v14, s[20:23], s60 offen sc1 lds
    s_mov_b32 m0, 33648
    s_add_u32 s60, s59, 276480
    buffer_load_dwordx4 v14, s[20:23], s60 offen sc1 lds
    s_mov_b32 exec_hi, 0x1ff
    s_mov_b32 m0, 34656
    s_add_u32 s60, s59, 307200
    buffer_load_dwordx4 v14, s[20:23], s60 offen sc1 lds
    s_mov_b32 exec_hi, 0x3ffffdff
    s_mov_b32 m0, 35328
    s_add_u32 s60, s58, 0
    buffer_load_dwordx4 v14, s[20:23], s60 offen sc1 lds
    s_mov_b32 m0, 36336
    s_add_u32 s60, s58, 30720
    buffer_load_dwordx4 v14, s[20:23], s60 offen sc1 lds
    s_mov_b32 m0, 37344
    s_add_u32 s60, s58, 61440
    buffer_load_dwordx4 v14, s[20:23], s60 offen sc1 lds
    s_mov_b32 m0, 38352
    s_add_u32 s60, s58, 92160
    buffer_load_dwordx4 v14, s[20:23], s60 offen sc1 lds
    s_mov_b32 m0, 39360
    s_add_u32 s60, s58, 122880
    buffer_load_dwordx4 v14, s[20:23], s60 offen sc1 lds
    s_mov_b32 m0, 40368
    s_add_u32 s60, s58, 153600
    buffer_load_dwordx4 v14, s[20:23], s60 offen sc1 lds
    s_mov_b32 m0, 41376
    s_add_u32 s60, s58, 184320
    buffer_load_dwordx4 v14, s[20:23], s60 offen sc1 lds
    s_mov_b32 m0, 42384
    s_add_u32 s60, s58, 215040
    buffer_load_dwordx4 v14, s[20:23], s60 offen sc1 lds
    s_mov_b32 m0, 43392
    s_add_u32 s60, s58, 245760
    buffer_load_dwordx4 v14, s[20:23], s60 offen sc1 lds
    s_mov_b32 m0, 44400
    s_add_u32 s60, s58, 276480
    buffer_load_dwordx4 v14, s[20:23], s60 offen sc1 lds
    s_mov_b32 exec_hi, 0x1ff
    s_mov_b32 m0, 45408
    s_add_u32 s60, s58, 307200
    buffer_load_dwordx4 v14, s[20:23], s60 offen sc1 lds
    s_mov_b32 exec_hi, 0x3ffffdff
    s_waitcnt vmcnt(0)
    s_mov_b64 exec, 1
    ds_add_u32 v6, v11 offset:52
    s_mov_b64 exec, -1
.bc_nov:
    s_mov_b32 s54, 0x200000
    .ga_lw39:
    ds_read_b32 v10, v6 offset:52
    s_sub_u32 s54, s54, 1
    s_waitcnt lgkmcnt(0)
    v_readfirstlane_b32 s53, v10
    s_cmp_eq_u32 s54, 0
    s_cbranch_scc1 .ga_lwd40
    s_cmp_ge_u32 s53, 8
    s_cbranch_scc1 .ga_lwd40
    s_sleep 2
    s_branch .ga_lw39
    .ga_lwd40:
    s_mov_b32 s54, 0x200000
    .ga_lw41:
    ds_read_b32 v10, v6 offset:8
    s_sub_u32 s54, s54, 1
    s_waitcnt lgkmcnt(0)
    v_readfirstlane_b32 s53, v10
    s_cmp_eq_u32 s54, 0
    s_cbranch_scc1 .ga_lwd42
    s_cmp_ge_u32 s53, 10
    s_cbranch_scc1 .ga_lwd42
    s_sleep 2
    s_branch .ga_lw41
    .ga_lwd42:
    v_lshlrev_b32 v3, 4, v2
    s_lshr_b32 s61, s25, 2
    s_mul_i32 s58, s61, 102400
    s_add_u32 s58, s58, 10485760
    s_and_b32 s59, s3, 1
    s_mul_i32 s59, s59, 10240
    s_add_u32 s58, s58, s59
    s_and_b32 s60, s61, 3
    s_mul_i32 s60, s60, 20480
    s_add_u32 s61, s58, s60
    s_add_u32 m0, s59, 65536
    s_add_u32 s62, s61, 0
    buffer_load_dwordx4 v3, s[20:23], s62 offen offset:0 sc1 lds
    buffer_load_dwordx4 v3, s[20:23], s62 offen offset:1024 sc1 lds
    buffer_load_dwordx4 v3, s[20:23], s62 offen offset:2048 sc1 lds
    buffer_load_dwordx4 v3, s[20:23], s62 offen offset:3072 sc1 lds
    s_add_u32 m0, s59, 69632
    s_add_u32 s62, s61, 4096
    buffer_load_dwordx4 v3, s[20:23], s62 offen offset:0 sc1 lds
    buffer_load_dwordx4 v3, s[20:23], s62 offen offset:1024 sc1 lds
    buffer_load_dwordx4 v3, s[20:23], s62 offen offset:2048 sc1 lds
    buffer_load_dwordx4 v3, s[20:23], s62 offen offset:3072 sc1 lds
    s_add_u32 m0, s59, 73728
    s_add_u32 s62, s61, 8192
    buffer_load_dwordx4 v3, s[20:23], s62 offen offset:0 sc1 lds
    buffer_load_dwordx4 v3, s[20:23], s62 offen offset:1024 sc1 lds
    s_add_u32 s60, s60, 20480
    s_cmp_eq_u32 s60, 81920
    s_cselect_b32 s60, 0, s60
    s_add_u32 s61, s58, s60
    s_add_u32 m0, s59, 86016
    s_add_u32 s62, s61, 0
    buffer_load_dwordx4 v3, s[20:23], s62 offen offset:0 sc1 lds
    buffer_load_dwordx4 v3, s[20:23], s62 offen offset:1024 sc1 lds
    buffer_load_dwordx4 v3, s[20:23], s62 offen offset:2048 sc1 lds
    buffer_load_dwordx4 v3, s[20:23], s62 offen offset:3072 sc1 lds
    s_add_u32 m0, s59, 90112
    s_add_u32 s62, s61, 4096
    buffer_load_dwordx4 v3, s[20:23], s62 offen offset:0 sc1 lds
    buffer_load_dwordx4 v3, s[20:23], s62 offen offset:1024 sc1 lds
    buffer_load_dwordx4 v3, s[20:23], s62 offen offset:2048 sc1 lds
    buffer_load_dwordx4 v3, s[20:23], s62 offen offset:3072 sc1 lds
    s_add_u32 m0, s59, 94208
    s_add_u32 s62, s61, 8192
    buffer_load_dwordx4 v3, s[20:23], s62 offen offset:0 sc1 lds
    buffer_load_dwordx4 v3, s[20:23], s62 offen offset:1024 sc1 lds
    s_add_u32 s60, s60, 20480
    s_cmp_eq_u32 s60, 81920
    s_cselect_b32 s60, 0, s60
    s_add_u32 s61, s58, s60
    s_add_u32 m0, s59, 106496
    s_add_u32 s62, s61, 0
    buffer_load_dwordx4 v3, s[20:23], s62 offen offset:0 sc1 lds
    buffer_load_dwordx4 v3, s[20:23], s62 offen offset:1024 sc1 lds
    buffer_load_dwordx4 v3, s[20:23], s62 offen offset:2048 sc1 lds
    buffer_load_dwordx4 v3, s[20:23], s62 offen offset:3072 sc1 lds
    s_add_u32 m0, s59, 110592
    s_add_u32 s62, s61, 4096
    buffer_load_dwordx4 v3, s[20:23], s62 offen offset:0 sc1 lds
    buffer_load_dwordx4 v3, s[20:23], s62 offen offset:1024 sc1 lds
    buffer_load_dwordx4 v3, s[20:23], s62 offen offset:2048 sc1 lds
    buffer_load_dwordx4 v3, s[20:23], s62 offen offset:3072 sc1 lds
    s_add_u32 m0, s59, 114688
    s_add_u32 s62, s61, 8192
    buffer_load_dwordx4 v3, s[20:23], s62 offen offset:0 sc1 lds
    buffer_load_dwordx4 v3, s[20:23], s62 offen offset:1024 sc1 lds
    s_add_u32 s60, s60, 20480
    s_cmp_eq_u32 s60, 81920
    s_cselect_b32 s60, 0, s60
    s_add_u32 s61, s58, s60
    s_add_u32 m0, s59, 126976
    s_add_u32 s62, s61, 0
    buffer_load_dwordx4 v3, s[20:23], s62 offen offset:0 sc1 lds
    buffer_load_dwordx4 v3, s[20:23], s62 offen offset:1024 sc1 lds
    buffer_load_dwordx4 v3, s[20:23], s62 offen offset:2048 sc1 lds
    buffer_load_dwordx4 v3, s[20:23], s62 offen offset:3072 sc1 lds
    s_add_u32 m0, s59, 131072
    s_add_u32 s62, s61, 4096
    buffer_load_dwordx4 v3, s[20:23], s62 offen offset:0 sc1 lds
    buffer_load_dwordx4 v3, s[20:23], s62 offen offset:1024 sc1 lds
    buffer_load_dwordx4 v3, s[20:23], s62 offen offset:2048 sc1 lds
    buffer_load_dwordx4 v3, s[20:23], s62 offen offset:3072 sc1 lds
    s_add_u32 m0, s59, 135168
    s_add_u32 s62, s61, 8192
    buffer_load_dwordx4 v3, s[20:23], s62 offen offset:0 sc1 lds
    buffer_load_dwordx4 v3, s[20:23], s62 offen offset:1024 sc1 lds
    s_lshr_b32 s61, s25, 2
    s_mul_i32 s58, s61, 102400
    s_and_b32 s59, s3, 1
    s_mul_i32 s60, s59, 10240
    s_add_u32 s58, s58, s60
    s_add_u32 s58, s58, 10567680
    s_add_u32 s60, s60, 46080
    s_cmp_eq_u32 s59, 0
    s_mov_b32 s59, 147456
    s_cselect_b32 s59, 51200, s59
    s_mov_b32 m0, s60
    s_add_u32 s62, s58, 0
    buffer_load_dwordx4 v22, s[20:23], s62 offen offset:0 sc1 lds
    buffer_load_dwordx4 v22, s[20:23], s62 offen offset:1024 sc1 lds
    buffer_load_dwordx4 v22, s[20:23], s62 offen offset:2048 sc1 lds
    buffer_load_dwordx4 v22, s[20:23], s62 offen offset:3072 sc1 lds
    s_add_u32 m0, s60, 4096
    s_add_u32 s62, s62, 4096
    buffer_load_dwordx4 v22, s[20:23], s62 offen sc1 lds
    s_mov_b32 m0, s59
    s_add_u32 s62, s58, 5120
    buffer_load_dwordx4 v22, s[20:23], s62 offen offset:0 sc1 lds
    buffer_load_dwordx4 v22, s[20:23], s62 offen offset:1024 sc1 lds
    buffer_load_dwordx4 v22, s[20:23], s62 offen offset:2048 sc1 lds
    buffer_load_dwordx4 v22, s[20:23], s62 offen offset:3072 sc1 lds
    s_add_u32 m0, s59, 4096
    s_add_u32 s62, s62, 4096
    buffer_load_dwordx4 v22, s[20:23], s62 offen sc1 lds
    s_waitcnt vmcnt(0)
    s_mov_b64 exec, 1
    ds_add_u32 v6, v9 offset:4
    s_mov_b64 exec, -1
    s_branch .bc_phasec
.bc_getsel:
    s_mov_b32 s54, 0x200000
    .ga_lw43:
    ds_read_b32 v10, v6 offset:52
    s_sub_u32 s54, s54, 1
    s_waitcnt lgkmcnt(0)
    v_readfirstlane_b32 s53, v10
    s_cmp_eq_u32 s54, 0
    s_cbranch_scc1 .ga_lwd44
    s_cmp_ge_u32 s53, 8
    s_cbranch_scc1 .ga_lwd44
    s_sleep 2
    s_branch .ga_lw43
    .ga_lwd44:
    v_lshlrev_b32 v11, 3, v2
    v_add_u32 v14, v0, v6
    s_mov_b32 s46, 11350016
    s_mov_b32 s53, 0x40000
    s_mov_b64 exec, 0xffff
    .bc_sl:
    buffer_load_dwordx2 v[12:13], v11, s[20:23], s46 offen sc1
    s_sub_u32 s53, s53, 1
    s_waitcnt vmcnt(0)
    v_cmp_ne_u32 vcc, v8, v13
    s_cmp_eq_u32 s53, 0
    s_cbranch_scc1 .bc_slok
    s_cbranch_vccz .bc_slok
    s_sleep 4
    s_branch .bc_sl
    .bc_slok:
    ds_write_b32 v14, v12 offset:64
    ds_write_b32 v6, v9 offset:44
    s_mov_b64 exec, -1
.bc_phasec:
    s_cmp_lg_u32 s3, 1
    s_cbranch_scc1 .bc_end
    v_mov_b32 v1, v8
    v_mov_b32 v18, v12
    v_lshlrev_b32 v3, 4, v2
    s_lshl_b32 s30, s24, 4
    s_and_b32 s27, s25, 3
    s_lshl_b32 s27, s27, 1
    s_add_u32 s30, s30, s27
    s_lshr_b32 s27, s25, 2
    v_lshrrev_b32 v19, 4, v18
    v_and_b32 v19, -10, v19
    v_cmp_eq_u32 vcc, s30, v19
    s_and_b32 s45, vcc_lo, 0xff
    s_cbranch_scc0 .bc_end
    s_mul_i32 s43, s27, 320
    s_add_u32 s43, s43, 12595712
    v_add_u32 v8, 155136, v3
    v_add_u32 v10, 152576, v3
    v_mul_u32_u24 v7, 3277, v2
    v_lshrrev_b32 v7, 16, v7
    v_mul_u32_u24 v7, 20160, v7
    v_add_u32 v7, v7, v3
    .bc_slot:
    s_ff1_i32_b32 s47, s45
    s_mul_i32 s50, s47, 2560
    s_add_u32 s50, s50, s43
    s_mov_b32 s56, 0x3f80
    s_mov_b32 s57, 1.0
    s_add_u32 s46, s47, 8
    v_readlane_b32 s49, v18, s46
    s_mov_b32 exec_hi, 0x0fffffff
    s_mov_b32 s51, 0x20000
    .ga_tg45:
    s_mov_b32 s46, s50
    buffer_load_dwordx4 v[52:55], v7, s[20:23], s46 offen sc1
    s_add_u32 s46, s46, 61440
    buffer_load_dwordx4 v[56:59], v7, s[20:23], s46 offen sc1
    s_add_u32 s46, s46, 61440
    buffer_load_dwordx4 v[60:63], v7, s[20:23], s46 offen sc1
    s_add_u32 s46, s46, 61440
    buffer_load_dwordx4 v[64:67], v7, s[20:23], s46 offen sc1
    s_add_u32 s46, s46, 61440
    buffer_load_dwordx4 v[68:71], v7, s[20:23], s46 offen sc1
    s_add_u32 s46, s46, 61440
    buffer_load_dwordx4 v[72:75], v7, s[20:23], s46 offen sc1
    s_add_u32 s46, s46, 61440
    buffer_load_dwordx4 v[76:79], v7, s[20:23], s46 offen sc1
    s_add_u32 s46, s46, 61440
    buffer_load_dwordx4 v[80:83], v7, s[20:23], s46 offen sc1
    s_sub_u32 s51, s51, 1
    s_waitcnt vmcnt(7)
    v_and_b32 v20, v53, v55
    v_or_b32 v21, v53, v55
    s_waitcnt vmcnt(6)
    v_bitop3_b32 v20, v20, v57, v59 bitop3:0x80
    v_or3_b32 v21, v21, v57, v59
    s_waitcnt vmcnt(5)
    v_bitop3_b32 v20, v20, v61, v63 bitop3:0x80
    v_or3_b32 v21, v21, v61, v63
    s_waitcnt vmcnt(4)
    v_bitop3_b32 v20, v20, v65, v67 bitop3:0x80
    v_or3_b32 v21, v21, v65, v67
    s_waitcnt vmcnt(3)
    v_bitop3_b32 v20, v20, v69, v71 bitop3:0x80
    v_or3_b32 v21, v21, v69, v71
    s_waitcnt vmcnt(2)
    v_bitop3_b32 v20, v20, v73, v75 bitop3:0x80
    v_or3_b32 v21, v21, v73, v75
    s_waitcnt vmcnt(1)
    v_bitop3_b32 v20, v20, v77, v79 bitop3:0x80
    v_or3_b32 v21, v21, v77, v79
    s_waitcnt vmcnt(0)
    v_bitop3_b32 v20, v20, v81, v83 bitop3:0x80
    v_or3_b32 v21, v21, v81, v83
    v_xor_b32 v20, v20, v1
    v_xor_b32 v21, v21, v1
    v_or_b32 v20, v20, v21
    v_cmp_ne_u32 vcc, 0, v20
    s_cmp_eq_u32 s51, 0
    s_cbranch_scc1 .ga_tgd46
    s_cbranch_vccz .ga_tgd46
    s_sleep 4
    s_branch .ga_tg45
    .ga_tgd46:
    v_dot2_f32_bf16 v40, v52, s56, 0
    v_dot2_f32_bf16 v41, v52, s57, 0
    v_dot2_f32_bf16 v42, v54, s56, 0
    v_dot2_f32_bf16 v43, v54, s57, 0
    v_dot2_f32_bf16 v40, v56, s56, v40
    v_dot2_f32_bf16 v41, v56, s57, v41
    v_dot2_f32_bf16 v42, v58, s56, v42
    v_dot2_f32_bf16 v43, v58, s57, v43
    v_dot2_f32_bf16 v40, v60, s56, v40
    v_dot2_f32_bf16 v41, v60, s57, v41
    v_dot2_f32_bf16 v42, v62, s56, v42
    v_dot2_f32_bf16 v43, v62, s57, v43
    v_dot2_f32_bf16 v40, v64, s56, v40
    v_dot2_f32_bf16 v41, v64, s57, v41
    v_dot2_f32_bf16 v42, v66, s56, v42
    v_dot2_f32_bf16 v43, v66, s57, v43
    v_dot2_f32_bf16 v40, v68, s56, v40
    v_dot2_f32_bf16 v41, v68, s57, v41
    v_dot2_f32_bf16 v42, v70, s56, v42
    v_dot2_f32_bf16 v43, v70, s57, v43
    v_dot2_f32_bf16 v40, v72, s56, v40
    v_dot2_f32_bf16 v41, v72, s57, v41
    v_dot2_f32_bf16 v42, v74, s56, v42
    v_dot2_f32_bf16 v43, v74, s57, v43
    v_dot2_f32_bf16 v40, v76, s56, v40
    v_dot2_f32_bf16 v41, v76, s57, v41
    v_dot2_f32_bf16 v42, v78, s56, v42
    v_dot2_f32_bf16 v43, v78, s57, v43
    v_dot2_f32_bf16 v40, v80, s56, v40
    v_dot2_f32_bf16 v41, v80, s57, v41
    v_dot2_f32_bf16 v42, v82, s56, v42
    v_dot2_f32_bf16 v43, v82, s57, v43
    s_mov_b64 exec, -1
    s_nop 1
    ds_write_b128 v8, v[40:43]
    s_mul_i32 s48, s47, 320
    v_add_u32 v11, s48, v10
    s_waitcnt lgkmcnt(0)
    ds_read_b128 v[44:47], v8 offset:320
    ds_read_b128 v[48:51], v8 offset:640
    s_waitcnt lgkmcnt(0)
    v_add_f32 v40, v40, v44
    v_add_f32 v41, v41, v45
    v_add_f32 v42, v42, v46
    v_add_f32 v43, v43, v47
    v_add_f32 v40, v40, v48
    v_add_f32 v41, v41, v49
    v_add_f32 v42, v42, v50
    v_add_f32 v43, v43, v51
    v_cvt_pk_bf16_f32 v40, 0, v40
    v_cvt_pk_bf16_f32 v41, 0, v41
    v_cvt_pk_bf16_f32 v42, 0, v42
    v_cvt_pk_bf16_f32 v43, 0, v43
    v_mul_f32 v40, s49, v40
    v_mul_f32 v41, s49, v41
    v_mul_f32 v42, s49, v42
    v_mul_f32 v43, s49, v43
    s_mov_b64 exec, 0xfffff
    ds_write_b128 v11, v[40:43]
    s_mov_b64 exec, -1
    s_bitset0_b32 s45, s47
    s_cmp_eq_u32 s45, 0
    s_cbranch_scc0 .bc_slot
    ds_write_b32 v6, v9 offset:16
    s_endpgm
.a_rg:
    s_setprio 3
    s_lshr_b32 s30, s3, 1
    s_lshl_b32 s30, s30, 5
    s_add_u32 s30, s30, 32
    s_load_dwordx2 s[44:45], s[0:1], s30
    s_mov_b32 s46, 1280
    s_mov_b32 s47, 0x20000
    s_lshl_b32 s68, s24, 3
    s_add_u32 s68, s68, s25
    s_sub_u32 s68, s68, 24
    s_lshl_b32 s68, s68, 2
    s_add_u32 s68, s68, s3
    s_mul_i32 s69, s68, 10240
    v_lshrrev_b32 v13, 3, v2
    v_and_b32 v14, 7, v2
    v_lshlrev_b32 v14, 4, v14
    v_mul_u32_u24 v15, 1280, v13
    v_add_u32 v15, v15, v14
    v_add_u32 v14, 156672, v14
    v_lshlrev_b32 v7, 4, v2
    v_mov_b32 v26, 161792
    v_mov_b32 v27, 1
    s_mov_b32 s12, s4
    s_mov_b32 s13, s5
    s_mov_b32 s14, 2621440
    s_mov_b32 s15, 0x20000
    buffer_load_dwordx4 v[124:127], v15, s[12:15], s69 offen offset:0
    buffer_load_dwordx4 v[128:131], v15, s[12:15], s69 offen offset:128
    buffer_load_dwordx4 v[132:135], v15, s[12:15], s69 offen offset:256
    buffer_load_dwordx4 v[136:139], v15, s[12:15], s69 offen offset:384
    buffer_load_dwordx4 v[140:143], v15, s[12:15], s69 offen offset:512
    buffer_load_dwordx4 v[144:147], v15, s[12:15], s69 offen offset:640
    buffer_load_dwordx4 v[148:151], v15, s[12:15], s69 offen offset:768
    buffer_load_dwordx4 v[152:155], v15, s[12:15], s69 offen offset:896
    buffer_load_dwordx4 v[156:159], v15, s[12:15], s69 offen offset:1024
    buffer_load_dwordx4 v[160:163], v15, s[12:15], s69 offen offset:1152
    s_lshl_b32 s71, s3, 10
    s_add_u32 m0, s71, 156672
    s_and_b32 s71, s71, 1024
    s_waitcnt lgkmcnt(0)
    buffer_load_dwordx4 v7, s[44:47], s71 offen lds
    s_mov_b64 exec, 1
    buffer_load_dword v121, v120, s[64:67], 0 offen sc1
    s_mov_b64 exec, -1
    s_barrier
    s_mov_b64 exec, 1
    s_mov_b32 s56, 0x40000
    .ga_ip47:
    s_sub_u32 s56, s56, 1
    s_waitcnt vmcnt(0)
    v_cmp_eq_u32 vcc, 0, v121
    s_cmp_eq_u32 s56, 0
    s_cbranch_scc1 .ga_ipd48
    s_cbranch_vccz .ga_ipd48
    s_sleep 2
    buffer_load_dword v121, v120, s[64:67], 0 offen sc1
    s_branch .ga_ip47
    .ga_ipd48:
    v_mov_b32 v122, 161792
    ds_write_b32 v122, v121 offset:48
    s_mov_b64 exec, -1
    s_waitcnt lgkmcnt(0)
    s_mov_b64 exec, 1
    ds_add_u32 v26, v27 offset:56
    s_mov_b64 exec, -1
    s_mov_b32 s54, 0x200000
    .ga_lw49:
    ds_read_b32 v31, v26 offset:48
    s_sub_u32 s54, s54, 1
    s_waitcnt lgkmcnt(0)
    v_readfirstlane_b32 s53, v31
    s_cmp_eq_u32 s54, 0
    s_cbranch_scc1 .ga_lwd50
    s_cmp_ge_u32 s53, 1
    s_cbranch_scc1 .ga_lwd50
    s_sleep 0
    s_branch .ga_lw49
    .ga_lwd50:
    s_mov_b32 s54, 0x200000
    .ga_lw51:
    ds_read_b32 v28, v26 offset:56
    s_sub_u32 s54, s54, 1
    s_waitcnt lgkmcnt(0)
    v_readfirstlane_b32 s53, v28
    s_cmp_eq_u32 s54, 0
    s_cbranch_scc1 .ga_lwd52
    s_cmp_ge_u32 s53, 4
    s_cbranch_scc1 .ga_lwd52
    s_sleep 0
    s_branch .ga_lw51
    .ga_lwd52:
    s_mov_b64 exec, 1
    ds_add_u32 v26, v27 offset:56
    s_mov_b64 exec, -1
    ds_read_b128 v[40:43], v14 offset:0
    ds_read_b128 v[44:47], v14 offset:2048
    ds_read_b128 v[48:51], v14 offset:128
    ds_read_b128 v[52:55], v14 offset:2176
    ds_read_b128 v[56:59], v14 offset:256
    ds_read_b128 v[60:63], v14 offset:2304
    ds_read_b128 v[64:67], v14 offset:384
    ds_read_b128 v[68:71], v14 offset:2432
    ds_read_b128 v[72:75], v14 offset:512
    ds_read_b128 v[76:79], v14 offset:2560
    s_waitcnt lgkmcnt(4)
    ds_read_b128 v[80:83], v14 offset:640
    ds_read_b128 v[84:87], v14 offset:2688
    ds_read_b128 v[88:91], v14 offset:768
    ds_read_b128 v[92:95], v14 offset:2816
    ds_read_b128 v[96:99], v14 offset:896
    ds_read_b128 v[100:103], v14 offset:2944
    ds_read_b128 v[104:107], v14 offset:1024
    ds_read_b128 v[108:111], v14 offset:3072
    ds_read_b128 v[112:115], v14 offset:1152
    ds_read_b128 v[116:119], v14 offset:3200
    s_waitcnt lgkmcnt(14)
    v_dot2_f32_bf16 v34, v124, v40, 0
    v_dot2_f32_bf16 v32, v124, v44, 0
    v_dot2_f32_bf16 v35, v125, v41, 0
    v_dot2_f32_bf16 v33, v125, v45, 0
    v_dot2_f32_bf16 v34, v126, v42, v34
    v_dot2_f32_bf16 v32, v126, v46, v32
    v_dot2_f32_bf16 v35, v127, v43, v35
    v_dot2_f32_bf16 v33, v127, v47, v33
    s_waitcnt lgkmcnt(14)
    v_dot2_f32_bf16 v34, v128, v48, v34
    v_dot2_f32_bf16 v32, v128, v52, v32
    v_dot2_f32_bf16 v35, v129, v49, v35
    v_dot2_f32_bf16 v33, v129, v53, v33
    v_dot2_f32_bf16 v34, v130, v50, v34
    v_dot2_f32_bf16 v32, v130, v54, v32
    v_dot2_f32_bf16 v35, v131, v51, v35
    v_dot2_f32_bf16 v33, v131, v55, v33
    s_waitcnt lgkmcnt(14)
    v_dot2_f32_bf16 v34, v132, v56, v34
    v_dot2_f32_bf16 v32, v132, v60, v32
    v_dot2_f32_bf16 v35, v133, v57, v35
    v_dot2_f32_bf16 v33, v133, v61, v33
    v_dot2_f32_bf16 v34, v134, v58, v34
    v_dot2_f32_bf16 v32, v134, v62, v32
    v_dot2_f32_bf16 v35, v135, v59, v35
    v_dot2_f32_bf16 v33, v135, v63, v33
    s_waitcnt lgkmcnt(12)
    v_dot2_f32_bf16 v34, v136, v64, v34
    v_dot2_f32_bf16 v32, v136, v68, v32
    v_dot2_f32_bf16 v35, v137, v65, v35
    v_dot2_f32_bf16 v33, v137, v69, v33
    v_dot2_f32_bf16 v34, v138, v66, v34
    v_dot2_f32_bf16 v32, v138, v70, v32
    v_dot2_f32_bf16 v35, v139, v67, v35
    v_dot2_f32_bf16 v33, v139, v71, v33
    s_waitcnt lgkmcnt(10)
    v_dot2_f32_bf16 v34, v140, v72, v34
    v_dot2_f32_bf16 v32, v140, v76, v32
    v_dot2_f32_bf16 v35, v141, v73, v35
    v_dot2_f32_bf16 v33, v141, v77, v33
    v_dot2_f32_bf16 v34, v142, v74, v34
    v_dot2_f32_bf16 v32, v142, v78, v32
    v_dot2_f32_bf16 v35, v143, v75, v35
    v_dot2_f32_bf16 v33, v143, v79, v33
    s_waitcnt lgkmcnt(8)
    v_dot2_f32_bf16 v34, v144, v80, v34
    v_dot2_f32_bf16 v32, v144, v84, v32
    v_dot2_f32_bf16 v35, v145, v81, v35
    v_dot2_f32_bf16 v33, v145, v85, v33
    v_dot2_f32_bf16 v34, v146, v82, v34
    v_dot2_f32_bf16 v32, v146, v86, v32
    v_dot2_f32_bf16 v35, v147, v83, v35
    v_dot2_f32_bf16 v33, v147, v87, v33
    s_waitcnt lgkmcnt(6)
    v_dot2_f32_bf16 v34, v148, v88, v34
    v_dot2_f32_bf16 v32, v148, v92, v32
    v_dot2_f32_bf16 v35, v149, v89, v35
    v_dot2_f32_bf16 v33, v149, v93, v33
    v_dot2_f32_bf16 v34, v150, v90, v34
    v_dot2_f32_bf16 v32, v150, v94, v32
    v_dot2_f32_bf16 v35, v151, v91, v35
    v_dot2_f32_bf16 v33, v151, v95, v33
    s_waitcnt lgkmcnt(4)
    v_dot2_f32_bf16 v34, v152, v96, v34
    v_dot2_f32_bf16 v32, v152, v100, v32
    v_dot2_f32_bf16 v35, v153, v97, v35
    v_dot2_f32_bf16 v33, v153, v101, v33
    v_dot2_f32_bf16 v34, v154, v98, v34
    v_dot2_f32_bf16 v32, v154, v102, v32
    v_dot2_f32_bf16 v35, v155, v99, v35
    v_dot2_f32_bf16 v33, v155, v103, v33
    s_waitcnt lgkmcnt(2)
    v_dot2_f32_bf16 v34, v156, v104, v34
    v_dot2_f32_bf16 v32, v156, v108, v32
    v_dot2_f32_bf16 v35, v157, v105, v35
    v_dot2_f32_bf16 v33, v157, v109, v33
    v_dot2_f32_bf16 v34, v158, v106, v34
    v_dot2_f32_bf16 v32, v158, v110, v32
    v_dot2_f32_bf16 v35, v159, v107, v35
    v_dot2_f32_bf16 v33, v159, v111, v33
    s_waitcnt lgkmcnt(0)
    v_dot2_f32_bf16 v34, v160, v112, v34
    v_dot2_f32_bf16 v32, v160, v116, v32
    v_dot2_f32_bf16 v35, v161, v113, v35
    v_dot2_f32_bf16 v33, v161, v117, v33
    v_dot2_f32_bf16 v34, v162, v114, v34
    v_dot2_f32_bf16 v32, v162, v118, v32
    v_dot2_f32_bf16 v35, v163, v115, v35
    v_dot2_f32_bf16 v33, v163, v119, v33
    v_lshlrev_b32 v22, 3, v2
    v_lshrrev_b32 v23, 1, v2
    v_lshlrev_b32 v23, 3, v23
    v_and_b32 v24, 1, v2
    v_add_u32 v23, v23, v24
    v_lshlrev_b32 v23, 2, v23
    s_mov_b32 s70, 0xaaaaaaaa
    s_mov_b32 s71, s70
    v_add_f32 v32, v32, v33
    v_add_f32 v34, v34, v35
    s_nop 0
    v_add_f32_dpp v32, v32, v32 quad_perm:[1,0,3,2] row_mask:0xf bank_mask:0xf
    v_add_f32_dpp v34, v34, v34 quad_perm:[1,0,3,2] row_mask:0xf bank_mask:0xf
    s_nop 0
    v_add_f32_dpp v32, v32, v32 quad_perm:[2,3,0,1] row_mask:0xf bank_mask:0xf
    v_add_f32_dpp v34, v34, v34 quad_perm:[2,3,0,1] row_mask:0xf bank_mask:0xf
    s_nop 0
    v_add_f32_dpp v32, v32, v32 row_half_mirror row_mask:0xf bank_mask:0xf
    v_add_f32_dpp v34, v34, v34 row_half_mirror row_mask:0xf bank_mask:0xf
    v_cvt_pk_bf16_f32 v32, 0, v32
    v_cvt_pk_bf16_f32 v34, 0, v34
    v_mul_f32 v32, 0xbfb8aa3b, v32
    v_exp_f32 v32, v32
    v_mov_b32 v25, v31
    v_add_f32 v32, 1.0, v32
    v_rcp_f32 v32, v32
    v_ashrrev_i32 v20, 31, v34
    v_or_b32 v20, 0x80000000, v20
    v_cvt_pk_bf16_f32 v32, 0, v32
    v_xor_b32 v20, v20, v34
    v_and_b32 v20, 0xffff0000, v20
    s_lshl_b32 s69, s68, 3
    s_sub_u32 s69, 2047, s69
    v_sub_u32 v21, s69, v13
    v_or_b32 v20, v20, v21
    v_cndmask_b32 v20, v20, v32, s[70:71]
    ds_bpermute_b32 v24, v23, v20
    s_lshl_b32 s69, s68, 7
    s_add_u32 s69, s69, 11309056
    s_mov_b64 exec, 0xffff
    s_waitcnt lgkmcnt(0)
    buffer_store_dwordx2 v[24:25], v22, s[20:23], s69 offen sc1
    s_mov_b64 exec, -1
    s_mov_b64 exec, 1
    ds_add_u32 v26, v27 offset:56
    s_mov_b64 exec, -1
    s_cmp_lg_u32 s3, 3
    s_cbranch_scc1 .a_nomk
    v_mov_b32 v9, 0
    s_lshl_b32 s57, s24, 7
    s_add_u32 s57, s57, 11383296
    s_mov_b32 exec_lo, 0x1
    s_mov_b32 exec_hi, 0x0
    s_mov_b32 s53, 0x40000
    .ga_gw53:
    buffer_load_dword v10, v9, s[20:23], s57 offen sc1
    s_sub_u32 s53, s53, 1
    s_waitcnt vmcnt(0)
    v_cmp_ne_u32 vcc, v31, v10
    s_cmp_eq_u32 s53, 0
    s_cbranch_scc1 .ga_gwd54
    s_cbranch_vccz .ga_gwd54
    s_mov_b64 exec, vcc
    s_sleep 4
    s_branch .ga_gw53
    .ga_gwd54:
    s_mov_b64 exec, -1
    s_mov_b64 exec, 1
    ds_add_u32 v26, v27 offset:60
    s_mov_b64 exec, -1
.a_nomk:
    s_cmp_ge_u32 s25, 30
    s_cbranch_scc1 .b_aux
    s_cmp_ge_u32 s3, 2
    s_cbranch_scc1 .b_aux
    s_mul_i32 s47, s24, 6
    s_add_u32 s47, s47, s25
    s_sub_u32 s47, s47, 24
    s_lshr_b32 s48, s47, 1
    s_and_b32 s49, s47, 1
    v_mov_b32 v1, v31
    v_mov_b32 v3, v26
    v_mov_b32 v0, 1
    v_lshrrev_b32 v4, 4, v2
    v_and_b32 v12, 7, v2
    v_and_b32 v5, 3, v2
    v_bfe_u32 v14, v2, 2, 2
    v_lshl_add_u32 v9, v4, 3, v14
    v_lshlrev_b32 v10, 7, v9
    v_lshl_add_u32 v10, v5, 3, v10
    v_lshrrev_b32 v14, 1, v14
    v_and_b32 v15, 1, v4
    v_lshl_add_u32 v14, v15, 1, v14
    s_lshl_b32 s36, s3, 1
    v_xor_b32 v14, s36, v14
    v_lshl_add_u32 v10, v14, 5, v10
    v_add_u32 v32, 49152, v10
    v_xor_b32 v33, 32, v32
    v_add_u32 v34, 40960, v32
    v_add_u32 v35, 40960, v33
    v_mul_u32_u24 v11, 640, v9
    v_lshl_add_u32 v11, v5, 3, v11
    s_mul_i32 s37, s3, 320
    v_add_u32 v11, s37, v11
    v_mul_u32_u24 v13, 656, v12
    v_lshl_add_u32 v13, v4, 4, v13
    v_add_u32 v13, 131072, v13
    v_lshlrev_b32 v14, 4, v12
    v_lshl_add_u32 v14, v4, 7, v14
    v_lshlrev_b32 v9, 7, v12
    v_add_u32 v9, 160768, v9
    v_lshl_add_u32 v8, v4, 3, v9
    s_lshl_b32 s37, s3, 6
    v_add_u32 v8, s37, v8
    v_lshl_add_u32 v9, v4, 4, v9
    v_mul_u32_u24 v15, 2560, v12
    v_lshl_add_u32 v15, v4, 4, v15
    v_and_b32 v10, 8, v2
    v_lshl_add_u32 v15, v10, 3, v15
    s_mul_i32 s50, s48, 20480
    s_mul_i32 s51, s49, 1280
    s_add_u32 s50, s50, s51
    s_mul_i32 s51, s3, 640
    s_add_u32 s50, s50, s51
    s_add_u32 s50, s50, 12595712
    s_lshl_b32 s51, s47, 12
    s_lshl_b32 s52, s3, 11
    s_add_u32 s51, s51, s52
    s_xor_b32 s52, s51, 4096
    s_add_u32 s51, s51, 11612672
    s_add_u32 s52, s52, 11612672
    s_mov_b32 s44, 0x00ff00ff
    s_mov_b32 s45, s44
    s_lshl_b32 s46, s3, 5
    s_add_u32 s46, s46, 11350016
    s_mul_i32 s55, s49, 640
    v_lshlrev_b32 v10, 3, v5
    v_mov_b32 v6, 2
    s_mov_b32 s54, 0x200000
    .ga_lw55:
    ds_read_b32 v36, v3 offset:132
    s_sub_u32 s54, s54, 1
    s_waitcnt lgkmcnt(0)
    v_readfirstlane_b32 s53, v36
    s_cmp_eq_u32 s54, 0
    s_cbranch_scc1 .ga_lwd56
    s_cmp_ge_u32 s53, 8
    s_cbranch_scc1 .ga_lwd56
    s_sleep 1
    s_branch .ga_lw55
    .ga_lwd56:
    ds_read_b64_tr_b16 v[80:81], v11 offset:0
    ds_read_b64_tr_b16 v[82:83], v11 offset:2560
    ds_read_b64_tr_b16 v[84:85], v11 offset:20480
    ds_read_b64_tr_b16 v[86:87], v11 offset:23040
    ds_read_b64_tr_b16 v[88:89], v11 offset:32
    ds_read_b64_tr_b16 v[90:91], v11 offset:2592
    ds_read_b64_tr_b16 v[92:93], v11 offset:20512
    ds_read_b64_tr_b16 v[94:95], v11 offset:23072
    s_waitcnt lgkmcnt(8)
    ds_read_b64_tr_b16 v[96:97], v11 offset:64
    ds_read_b64_tr_b16 v[98:99], v11 offset:2624
    ds_read_b64_tr_b16 v[100:101], v11 offset:20544
    ds_read_b64_tr_b16 v[102:103], v11 offset:23104
    s_waitcnt lgkmcnt(8)
    ds_read_b64_tr_b16 v[104:105], v11 offset:96
    ds_read_b64_tr_b16 v[106:107], v11 offset:2656
    ds_read_b64_tr_b16 v[108:109], v11 offset:20576
    ds_read_b64_tr_b16 v[110:111], v11 offset:23136
    s_waitcnt lgkmcnt(8)
    ds_read_b64_tr_b16 v[112:113], v11 offset:128
    ds_read_b64_tr_b16 v[114:115], v11 offset:2688
    ds_read_b64_tr_b16 v[116:117], v11 offset:20608
    ds_read_b64_tr_b16 v[118:119], v11 offset:23168
    s_waitcnt lgkmcnt(8)
    ds_read_b64_tr_b16 v[120:121], v11 offset:160
    ds_read_b64_tr_b16 v[122:123], v11 offset:2720
    ds_read_b64_tr_b16 v[124:125], v11 offset:20640
    ds_read_b64_tr_b16 v[126:127], v11 offset:23200
    s_waitcnt lgkmcnt(8)
    ds_read_b64_tr_b16 v[128:129], v11 offset:192
    ds_read_b64_tr_b16 v[130:131], v11 offset:2752
    ds_read_b64_tr_b16 v[132:133], v11 offset:20672
    ds_read_b64_tr_b16 v[134:135], v11 offset:23232
    s_waitcnt lgkmcnt(8)
    ds_read_b64_tr_b16 v[136:137], v11 offset:224
    ds_read_b64_tr_b16 v[138:139], v11 offset:2784
    ds_read_b64_tr_b16 v[140:141], v11 offset:20704
    ds_read_b64_tr_b16 v[142:143], v11 offset:23264
    s_waitcnt lgkmcnt(8)
    ds_read_b64_tr_b16 v[144:145], v11 offset:256
    ds_read_b64_tr_b16 v[146:147], v11 offset:2816
    ds_read_b64_tr_b16 v[148:149], v11 offset:20736
    ds_read_b64_tr_b16 v[150:151], v11 offset:23296
    s_waitcnt lgkmcnt(8)
    ds_read_b64_tr_b16 v[152:153], v11 offset:288
    ds_read_b64_tr_b16 v[154:155], v11 offset:2848
    ds_read_b64_tr_b16 v[156:157], v11 offset:20768
    ds_read_b64_tr_b16 v[158:159], v11 offset:23328
    s_waitcnt lgkmcnt(0)
    s_mov_b64 exec, 1
    ds_add_u32 v3, v6 offset:12
    s_mov_b64 exec, -1
    s_mov_b32 s53, 0x40000
    .a_sl:
    buffer_load_dwordx2 v[36:37], v10, s[20:23], s46 offen sc1
    s_sub_u32 s53, s53, 1
    s_waitcnt vmcnt(0)
    v_cmp_ne_u32 vcc, v1, v37
    s_cmp_eq_u32 s53, 0
    s_cbranch_scc1 .a_slok
    s_cbranch_vccz .a_slok
    s_sleep 4
    s_branch .a_sl
    .a_slok:
    v_mul_u32_u24 v36, 1280, v36
    v_add_u32 v36, s55, v36
    s_mul_i32 s37, s3, 2624
    s_mov_b32 exec_hi, 0xff
    v_readlane_b32 s56, v36, 0
    v_readlane_b32 s57, v36, 1
    v_readlane_b32 s58, v36, 2
    v_readlane_b32 s59, v36, 3
    s_nop 3
    s_add_u32 m0, s37, 131072
    s_nop 0
    buffer_load_dwordx4 v7, s[12:15], s56 offen lds
    s_add_u32 m0, s37, 131728
    s_nop 0
    buffer_load_dwordx4 v7, s[12:15], s57 offen lds
    s_add_u32 m0, s37, 132384
    s_nop 0
    buffer_load_dwordx4 v7, s[12:15], s58 offen lds
    s_add_u32 m0, s37, 133040
    s_nop 0
    buffer_load_dwordx4 v7, s[12:15], s59 offen lds
    s_mov_b64 exec, -1
    s_waitcnt vmcnt(0)
    s_mov_b64 exec, 1
    ds_add_u32 v3, v0 offset:128
    s_mov_b64 exec, -1
    s_mov_b32 s54, 0x200000
    .ga_lw57:
    ds_read_b32 v36, v3 offset:128
    s_sub_u32 s54, s54, 1
    s_waitcnt lgkmcnt(0)
    v_readfirstlane_b32 s53, v36
    s_cmp_eq_u32 s54, 0
    s_cbranch_scc1 .ga_lwd58
    s_cmp_ge_u32 s53, 10
    s_cbranch_scc1 .ga_lwd58
    s_sleep 0
    s_branch .ga_lw57
    .ga_lwd58:
    ds_read_b128 v[40:43], v13 offset:0
    ds_read_b128 v[44:47], v13 offset:64
    ds_read_b128 v[48:51], v13 offset:128
    ds_read_b128 v[52:55], v13 offset:192
    ds_read_b128 v[56:59], v13 offset:256
    ds_read_b128 v[60:63], v13 offset:320
    ds_read_b128 v[64:67], v13 offset:384
    ds_read_b128 v[68:71], v13 offset:448
    ds_read_b128 v[72:75], v13 offset:512
    ds_read_b128 v[76:79], v13 offset:576
    ds_read_b64_tr_b16 v[160:161], v32 offset:0
    ds_read_b64_tr_b16 v[162:163], v32 offset:512
    ds_read_b64_tr_b16 v[164:165], v33 offset:0
    ds_read_b64_tr_b16 v[166:167], v33 offset:512
    s_waitcnt lgkmcnt(2)
    v_mfma_f32_16x16x32_bf16 v[16:19], v[160:163], v[40:43], 0
    ds_read_b64_tr_b16 v[160:161], v34 offset:0
    ds_read_b64_tr_b16 v[162:163], v34 offset:512
    s_waitcnt lgkmcnt(2)
    v_mfma_f32_16x16x32_bf16 v[20:23], v[164:167], v[40:43], 0
    ds_read_b64_tr_b16 v[164:165], v35 offset:0
    ds_read_b64_tr_b16 v[166:167], v35 offset:512
    s_waitcnt lgkmcnt(2)
    v_mfma_f32_16x16x32_bf16 v[24:27], v[160:163], v[40:43], 0
    ds_read_b64_tr_b16 v[160:161], v32 offset:4096
    ds_read_b64_tr_b16 v[162:163], v32 offset:4608
    s_waitcnt lgkmcnt(2)
    v_mfma_f32_16x16x32_bf16 v[28:31], v[164:167], v[40:43], 0
    ds_read_b64_tr_b16 v[164:165], v33 offset:4096
    ds_read_b64_tr_b16 v[166:167], v33 offset:4608
    s_waitcnt lgkmcnt(2)
    v_mfma_f32_16x16x32_bf16 v[16:19], v[160:163], v[44:47], v[16:19]
    ds_read_b64_tr_b16 v[160:161], v34 offset:4096
    ds_read_b64_tr_b16 v[162:163], v34 offset:4608
    s_waitcnt lgkmcnt(2)
    v_mfma_f32_16x16x32_bf16 v[20:23], v[164:167], v[44:47], v[20:23]
    ds_read_b64_tr_b16 v[164:165], v35 offset:4096
    ds_read_b64_tr_b16 v[166:167], v35 offset:4608
    s_waitcnt lgkmcnt(2)
    v_mfma_f32_16x16x32_bf16 v[24:27], v[160:163], v[44:47], v[24:27]
    ds_read_b64_tr_b16 v[160:161], v32 offset:8192
    ds_read_b64_tr_b16 v[162:163], v32 offset:8704
    s_waitcnt lgkmcnt(2)
    v_mfma_f32_16x16x32_bf16 v[28:31], v[164:167], v[44:47], v[28:31]
    ds_read_b64_tr_b16 v[164:165], v33 offset:8192
    ds_read_b64_tr_b16 v[166:167], v33 offset:8704
    s_waitcnt lgkmcnt(2)
    v_mfma_f32_16x16x32_bf16 v[16:19], v[160:163], v[48:51], v[16:19]
    ds_read_b64_tr_b16 v[160:161], v34 offset:8192
    ds_read_b64_tr_b16 v[162:163], v34 offset:8704
    s_waitcnt lgkmcnt(2)
    v_mfma_f32_16x16x32_bf16 v[20:23], v[164:167], v[48:51], v[20:23]
    ds_read_b64_tr_b16 v[164:165], v35 offset:8192
    ds_read_b64_tr_b16 v[166:167], v35 offset:8704
    s_waitcnt lgkmcnt(2)
    v_mfma_f32_16x16x32_bf16 v[24:27], v[160:163], v[48:51], v[24:27]
    ds_read_b64_tr_b16 v[160:161], v32 offset:12288
    ds_read_b64_tr_b16 v[162:163], v32 offset:12800
    s_waitcnt lgkmcnt(2)
    v_mfma_f32_16x16x32_bf16 v[28:31], v[164:167], v[48:51], v[28:31]
    ds_read_b64_tr_b16 v[164:165], v33 offset:12288
    ds_read_b64_tr_b16 v[166:167], v33 offset:12800
    s_waitcnt lgkmcnt(2)
    v_mfma_f32_16x16x32_bf16 v[16:19], v[160:163], v[52:55], v[16:19]
    ds_read_b64_tr_b16 v[160:161], v34 offset:12288
    ds_read_b64_tr_b16 v[162:163], v34 offset:12800
    s_waitcnt lgkmcnt(2)
    v_mfma_f32_16x16x32_bf16 v[20:23], v[164:167], v[52:55], v[20:23]
    ds_read_b64_tr_b16 v[164:165], v35 offset:12288
    ds_read_b64_tr_b16 v[166:167], v35 offset:12800
    s_waitcnt lgkmcnt(2)
    v_mfma_f32_16x16x32_bf16 v[24:27], v[160:163], v[52:55], v[24:27]
    ds_read_b64_tr_b16 v[160:161], v32 offset:16384
    ds_read_b64_tr_b16 v[162:163], v32 offset:16896
    s_waitcnt lgkmcnt(2)
    v_mfma_f32_16x16x32_bf16 v[28:31], v[164:167], v[52:55], v[28:31]
    ds_read_b64_tr_b16 v[164:165], v33 offset:16384
    ds_read_b64_tr_b16 v[166:167], v33 offset:16896
    s_waitcnt lgkmcnt(2)
    v_mfma_f32_16x16x32_bf16 v[16:19], v[160:163], v[56:59], v[16:19]
    ds_read_b64_tr_b16 v[160:161], v34 offset:16384
    ds_read_b64_tr_b16 v[162:163], v34 offset:16896
    s_waitcnt lgkmcnt(2)
    v_mfma_f32_16x16x32_bf16 v[20:23], v[164:167], v[56:59], v[20:23]
    ds_read_b64_tr_b16 v[164:165], v35 offset:16384
    ds_read_b64_tr_b16 v[166:167], v35 offset:16896
    s_waitcnt lgkmcnt(2)
    v_mfma_f32_16x16x32_bf16 v[24:27], v[160:163], v[56:59], v[24:27]
    ds_read_b64_tr_b16 v[160:161], v32 offset:20480
    ds_read_b64_tr_b16 v[162:163], v32 offset:20992
    s_waitcnt lgkmcnt(2)
    v_mfma_f32_16x16x32_bf16 v[28:31], v[164:167], v[56:59], v[28:31]
    ds_read_b64_tr_b16 v[164:165], v33 offset:20480
    ds_read_b64_tr_b16 v[166:167], v33 offset:20992
    s_waitcnt lgkmcnt(2)
    v_mfma_f32_16x16x32_bf16 v[16:19], v[160:163], v[60:63], v[16:19]
    ds_read_b64_tr_b16 v[160:161], v34 offset:20480
    ds_read_b64_tr_b16 v[162:163], v34 offset:20992
    s_waitcnt lgkmcnt(2)
    v_mfma_f32_16x16x32_bf16 v[20:23], v[164:167], v[60:63], v[20:23]
    ds_read_b64_tr_b16 v[164:165], v35 offset:20480
    ds_read_b64_tr_b16 v[166:167], v35 offset:20992
    s_waitcnt lgkmcnt(2)
    v_mfma_f32_16x16x32_bf16 v[24:27], v[160:163], v[60:63], v[24:27]
    ds_read_b64_tr_b16 v[160:161], v32 offset:24576
    ds_read_b64_tr_b16 v[162:163], v32 offset:25088
    s_waitcnt lgkmcnt(2)
    v_mfma_f32_16x16x32_bf16 v[28:31], v[164:167], v[60:63], v[28:31]
    ds_read_b64_tr_b16 v[164:165], v33 offset:24576
    ds_read_b64_tr_b16 v[166:167], v33 offset:25088
    s_waitcnt lgkmcnt(2)
    v_mfma_f32_16x16x32_bf16 v[16:19], v[160:163], v[64:67], v[16:19]
    ds_read_b64_tr_b16 v[160:161], v34 offset:24576
    ds_read_b64_tr_b16 v[162:163], v34 offset:25088
    s_waitcnt lgkmcnt(2)
    v_mfma_f32_16x16x32_bf16 v[20:23], v[164:167], v[64:67], v[20:23]
    ds_read_b64_tr_b16 v[164:165], v35 offset:24576
    ds_read_b64_tr_b16 v[166:167], v35 offset:25088
    s_waitcnt lgkmcnt(2)
    v_mfma_f32_16x16x32_bf16 v[24:27], v[160:163], v[64:67], v[24:27]
    ds_read_b64_tr_b16 v[160:161], v32 offset:28672
    ds_read_b64_tr_b16 v[162:163], v32 offset:29184
    s_waitcnt lgkmcnt(2)
    v_mfma_f32_16x16x32_bf16 v[28:31], v[164:167], v[64:67], v[28:31]
    ds_read_b64_tr_b16 v[164:165], v33 offset:28672
    ds_read_b64_tr_b16 v[166:167], v33 offset:29184
    s_waitcnt lgkmcnt(2)
    v_mfma_f32_16x16x32_bf16 v[16:19], v[160:163], v[68:71], v[16:19]
    ds_read_b64_tr_b16 v[160:161], v34 offset:28672
    ds_read_b64_tr_b16 v[162:163], v34 offset:29184
    s_waitcnt lgkmcnt(2)
    v_mfma_f32_16x16x32_bf16 v[20:23], v[164:167], v[68:71], v[20:23]
    ds_read_b64_tr_b16 v[164:165], v35 offset:28672
    ds_read_b64_tr_b16 v[166:167], v35 offset:29184
    s_waitcnt lgkmcnt(2)
    v_mfma_f32_16x16x32_bf16 v[24:27], v[160:163], v[68:71], v[24:27]
    ds_read_b64_tr_b16 v[160:161], v32 offset:32768
    ds_read_b64_tr_b16 v[162:163], v32 offset:33280
    s_waitcnt lgkmcnt(2)
    v_mfma_f32_16x16x32_bf16 v[28:31], v[164:167], v[68:71], v[28:31]
    ds_read_b64_tr_b16 v[164:165], v33 offset:32768
    ds_read_b64_tr_b16 v[166:167], v33 offset:33280
    s_waitcnt lgkmcnt(2)
    v_mfma_f32_16x16x32_bf16 v[16:19], v[160:163], v[72:75], v[16:19]
    ds_read_b64_tr_b16 v[160:161], v34 offset:32768
    ds_read_b64_tr_b16 v[162:163], v34 offset:33280
    s_waitcnt lgkmcnt(2)
    v_mfma_f32_16x16x32_bf16 v[20:23], v[164:167], v[72:75], v[20:23]
    ds_read_b64_tr_b16 v[164:165], v35 offset:32768
    ds_read_b64_tr_b16 v[166:167], v35 offset:33280
    s_waitcnt lgkmcnt(2)
    v_mfma_f32_16x16x32_bf16 v[24:27], v[160:163], v[72:75], v[24:27]
    ds_read_b64_tr_b16 v[160:161], v32 offset:36864
    ds_read_b64_tr_b16 v[162:163], v32 offset:37376
    s_waitcnt lgkmcnt(2)
    v_mfma_f32_16x16x32_bf16 v[28:31], v[164:167], v[72:75], v[28:31]
    ds_read_b64_tr_b16 v[164:165], v33 offset:36864
    ds_read_b64_tr_b16 v[166:167], v33 offset:37376
    s_waitcnt lgkmcnt(2)
    v_mfma_f32_16x16x32_bf16 v[16:19], v[160:163], v[76:79], v[16:19]
    ds_read_b64_tr_b16 v[160:161], v34 offset:36864
    ds_read_b64_tr_b16 v[162:163], v34 offset:37376
    s_waitcnt lgkmcnt(2)
    v_mfma_f32_16x16x32_bf16 v[20:23], v[164:167], v[76:79], v[20:23]
    ds_read_b64_tr_b16 v[164:165], v35 offset:36864
    ds_read_b64_tr_b16 v[166:167], v35 offset:37376
    s_waitcnt lgkmcnt(2)
    v_mfma_f32_16x16x32_bf16 v[24:27], v[160:163], v[76:79], v[24:27]
    s_waitcnt lgkmcnt(0)
    v_mfma_f32_16x16x32_bf16 v[28:31], v[164:167], v[76:79], v[28:31]
    s_mov_b64 exec, 1
    ds_add_u32 v3, v0 offset:8
    s_mov_b64 exec, -1
    v_mov_b32 v41, v1
    v_mov_b32 v43, v1
    v_mov_b32 v45, v1
    v_mov_b32 v47, v1
    v_mov_b32 v49, v1
    v_mov_b32 v51, v1
    v_mov_b32 v53, v1
    v_mov_b32 v55, v1
    v_cvt_pk_bf16_f32 v40, v16, v17
    v_cvt_pk_bf16_f32 v42, v18, v19
    v_cvt_pk_bf16_f32 v44, v20, v21
    v_cvt_pk_bf16_f32 v46, v22, v23
    v_cvt_pk_bf16_f32 v48, v24, v25
    v_cvt_pk_bf16_f32 v50, v26, v27
    v_cvt_pk_bf16_f32 v52, v28, v29
    v_cvt_pk_bf16_f32 v54, v30, v31
    s_mov_b64 exec, s[44:45]
    buffer_store_dwordx4 v[40:43], v14, s[20:23], s51 offen offset:0 sc1
    buffer_store_dwordx4 v[44:47], v14, s[20:23], s51 offen offset:512 sc1
    buffer_store_dwordx4 v[48:51], v14, s[20:23], s51 offen offset:1024 sc1
    buffer_store_dwordx4 v[52:55], v14, s[20:23], s51 offen offset:1536 sc1
    s_waitcnt vmcnt(0)
    s_mov_b32 s53, 0x20000
    .ga_tg59:
    buffer_load_dwordx4 v[56:59], v14, s[20:23], s52 offen offset:0 sc1
    buffer_load_dwordx4 v[60:63], v14, s[20:23], s52 offen offset:512 sc1
    buffer_load_dwordx4 v[64:67], v14, s[20:23], s52 offen offset:1024 sc1
    buffer_load_dwordx4 v[68:71], v14, s[20:23], s52 offen offset:1536 sc1
    s_sub_u32 s53, s53, 1
    s_waitcnt vmcnt(3)
    v_and_b32 v36, v57, v59
    v_or_b32 v37, v57, v59
    s_waitcnt vmcnt(2)
    v_bitop3_b32 v36, v36, v61, v63 bitop3:0x80
    v_or3_b32 v37, v37, v61, v63
    s_waitcnt vmcnt(1)
    v_bitop3_b32 v36, v36, v65, v67 bitop3:0x80
    v_or3_b32 v37, v37, v65, v67
    s_waitcnt vmcnt(0)
    v_bitop3_b32 v36, v36, v69, v71 bitop3:0x80
    v_or3_b32 v37, v37, v69, v71
    v_xor_b32 v36, v36, v1
    v_xor_b32 v37, v37, v1
    v_or_b32 v36, v36, v37
    v_cmp_ne_u32 vcc, 0, v36
    s_cmp_eq_u32 s53, 0
    s_cbranch_scc1 .ga_tgd60
    s_cbranch_vccz .ga_tgd60
    s_sleep 2
    s_branch .ga_tg59
    .ga_tgd60:
    v_and_b32 v57, 0xffff0000, v56
    v_lshlrev_b32 v56, 16, v56
    v_and_b32 v59, 0xffff0000, v58
    v_lshlrev_b32 v58, 16, v58
    v_and_b32 v61, 0xffff0000, v60
    v_lshlrev_b32 v60, 16, v60
    v_and_b32 v63, 0xffff0000, v62
    v_lshlrev_b32 v62, 16, v62
    v_and_b32 v65, 0xffff0000, v64
    v_lshlrev_b32 v64, 16, v64
    v_and_b32 v67, 0xffff0000, v66
    v_lshlrev_b32 v66, 16, v66
    v_and_b32 v69, 0xffff0000, v68
    v_lshlrev_b32 v68, 16, v68
    v_and_b32 v71, 0xffff0000, v70
    v_lshlrev_b32 v70, 16, v70
    v_pk_add_f32 v[16:17], v[16:17], v[56:57]
    v_pk_add_f32 v[18:19], v[18:19], v[58:59]
    v_pk_add_f32 v[20:21], v[20:21], v[60:61]
    v_pk_add_f32 v[22:23], v[22:23], v[62:63]
    v_pk_add_f32 v[24:25], v[24:25], v[64:65]
    v_pk_add_f32 v[26:27], v[26:27], v[66:67]
    v_pk_add_f32 v[28:29], v[28:29], v[68:69]
    v_pk_add_f32 v[30:31], v[30:31], v[70:71]
    v_cvt_pk_bf16_f32 v16, 0, v16
    v_cvt_pk_bf16_f32 v17, 0, v17
    v_cvt_pk_bf16_f32 v18, 0, v18
    v_cvt_pk_bf16_f32 v19, 0, v19
    v_cvt_pk_bf16_f32 v20, 0, v20
    v_cvt_pk_bf16_f32 v21, 0, v21
    v_cvt_pk_bf16_f32 v22, 0, v22
    v_cvt_pk_bf16_f32 v23, 0, v23
    v_cvt_pk_bf16_f32 v24, 0, v24
    v_cvt_pk_bf16_f32 v25, 0, v25
    v_cvt_pk_bf16_f32 v26, 0, v26
    v_cvt_pk_bf16_f32 v27, 0, v27
    v_cvt_pk_bf16_f32 v28, 0, v28
    v_cvt_pk_bf16_f32 v29, 0, v29
    v_cvt_pk_bf16_f32 v30, 0, v30
    v_cvt_pk_bf16_f32 v31, 0, v31
    v_mul_f32 v56, 0xbfb8aa3b, v16
    v_mul_f32 v57, 0xbfb8aa3b, v17
    v_mul_f32 v58, 0xbfb8aa3b, v18
    v_mul_f32 v59, 0xbfb8aa3b, v19
    v_mul_f32 v60, 0xbfb8aa3b, v20
    v_mul_f32 v61, 0xbfb8aa3b, v21
    v_mul_f32 v62, 0xbfb8aa3b, v22
    v_mul_f32 v63, 0xbfb8aa3b, v23
    v_exp_f32 v56, v56
    v_exp_f32 v57, v57
    v_exp_f32 v58, v58
    v_exp_f32 v59, v59
    v_exp_f32 v60, v60
    v_exp_f32 v61, v61
    v_exp_f32 v62, v62
    v_exp_f32 v63, v63
    v_add_f32 v56, 1.0, v56
    v_add_f32 v57, 1.0, v57
    v_add_f32 v58, 1.0, v58
    v_add_f32 v59, 1.0, v59
    v_add_f32 v60, 1.0, v60
    v_add_f32 v61, 1.0, v61
    v_add_f32 v62, 1.0, v62
    v_add_f32 v63, 1.0, v63
    v_rcp_f32 v56, v56
    v_rcp_f32 v57, v57
    v_rcp_f32 v58, v58
    v_rcp_f32 v59, v59
    v_rcp_f32 v60, v60
    v_rcp_f32 v61, v61
    v_rcp_f32 v62, v62
    v_rcp_f32 v63, v63
    v_mul_f32 v16, v16, v56
    v_mul_f32 v17, v17, v57
    v_mul_f32 v18, v18, v58
    v_mul_f32 v19, v19, v59
    v_mul_f32 v20, v20, v60
    v_mul_f32 v21, v21, v61
    v_mul_f32 v22, v22, v62
    v_mul_f32 v23, v23, v63
    v_cvt_pk_bf16_f32 v16, 0, v16
    v_cvt_pk_bf16_f32 v17, 0, v17
    v_cvt_pk_bf16_f32 v18, 0, v18
    v_cvt_pk_bf16_f32 v19, 0, v19
    v_cvt_pk_bf16_f32 v20, 0, v20
    v_cvt_pk_bf16_f32 v21, 0, v21
    v_cvt_pk_bf16_f32 v22, 0, v22
    v_cvt_pk_bf16_f32 v23, 0, v23
    v_mul_f32 v16, v16, v24
    v_mul_f32 v17, v17, v25
    v_mul_f32 v18, v18, v26
    v_mul_f32 v19, v19, v27
    v_mul_f32 v20, v20, v28
    v_mul_f32 v21, v21, v29
    v_mul_f32 v22, v22, v30
    v_mul_f32 v23, v23, v31
    v_cvt_pk_bf16_f32 v16, v16, v17
    v_cvt_pk_bf16_f32 v17, v18, v19
    v_cvt_pk_bf16_f32 v18, v20, v21
    v_cvt_pk_bf16_f32 v19, v22, v23
    ds_write_b64 v8, v[16:17]
    ds_write_b64 v8, v[18:19] offset:32
    s_mov_b64 exec, 1
    ds_add_u32 v3, v0 offset:128
    s_mov_b64 exec, -1
    s_mov_b32 s54, 0x200000
    .ga_lw61:
    ds_read_b32 v36, v3 offset:128
    s_sub_u32 s54, s54, 1
    s_waitcnt lgkmcnt(0)
    v_readfirstlane_b32 s53, v36
    s_cmp_eq_u32 s54, 0
    s_cbranch_scc1 .ga_lwd62
    s_cmp_ge_u32 s53, 12
    s_cbranch_scc1 .ga_lwd62
    s_sleep 0
    s_branch .ga_lw61
    .ga_lwd62:
    ds_read_b128 v[16:19], v9
    ds_read_b128 v[20:23], v9 offset:64
    s_waitcnt lgkmcnt(0)
    v_mfma_f32_16x16x32_bf16 v[40:43], v[80:83], v[16:19], 0
    v_mfma_f32_16x16x32_bf16 v[44:47], v[88:91], v[16:19], 0
    v_mfma_f32_16x16x32_bf16 v[48:51], v[96:99], v[16:19], 0
    v_mfma_f32_16x16x32_bf16 v[52:55], v[104:107], v[16:19], 0
    v_mfma_f32_16x16x32_bf16 v[56:59], v[112:115], v[16:19], 0
    v_mfma_f32_16x16x32_bf16 v[60:63], v[120:123], v[16:19], 0
    v_mfma_f32_16x16x32_bf16 v[64:67], v[128:131], v[16:19], 0
    v_mfma_f32_16x16x32_bf16 v[68:71], v[136:139], v[16:19], 0
    v_mfma_f32_16x16x32_bf16 v[72:75], v[144:147], v[16:19], 0
    v_mfma_f32_16x16x32_bf16 v[76:79], v[152:155], v[16:19], 0
    v_mfma_f32_16x16x32_bf16 v[40:43], v[84:87], v[20:23], v[40:43]
    v_mfma_f32_16x16x32_bf16 v[44:47], v[92:95], v[20:23], v[44:47]
    v_mfma_f32_16x16x32_bf16 v[48:51], v[100:103], v[20:23], v[48:51]
    v_mfma_f32_16x16x32_bf16 v[52:55], v[108:111], v[20:23], v[52:55]
    v_mfma_f32_16x16x32_bf16 v[56:59], v[116:119], v[20:23], v[56:59]
    v_mfma_f32_16x16x32_bf16 v[60:63], v[124:127], v[20:23], v[60:63]
    v_mfma_f32_16x16x32_bf16 v[64:67], v[132:135], v[20:23], v[64:67]
    v_mfma_f32_16x16x32_bf16 v[68:71], v[140:143], v[20:23], v[68:71]
    v_mfma_f32_16x16x32_bf16 v[72:75], v[148:151], v[20:23], v[72:75]
    v_mfma_f32_16x16x32_bf16 v[76:79], v[156:159], v[20:23], v[76:79]
    v_cndmask_b32 v40, v44, v40, s[44:45]
    v_cndmask_b32 v41, v45, v41, s[44:45]
    v_cndmask_b32 v42, v46, v42, s[44:45]
    v_cndmask_b32 v43, v47, v43, s[44:45]
    v_cvt_pk_bf16_f32 v40, v40, v41
    v_cvt_pk_bf16_f32 v42, v42, v43
    v_mov_b32 v41, v1
    v_mov_b32 v43, v1
    buffer_store_dwordx4 v[40:43], v15, s[20:23], s50 offen offset:0 sc1
    v_cndmask_b32 v48, v52, v48, s[44:45]
    v_cndmask_b32 v49, v53, v49, s[44:45]
    v_cndmask_b32 v50, v54, v50, s[44:45]
    v_cndmask_b32 v51, v55, v51, s[44:45]
    v_cvt_pk_bf16_f32 v48, v48, v49
    v_cvt_pk_bf16_f32 v50, v50, v51
    v_mov_b32 v49, v1
    v_mov_b32 v51, v1
    buffer_store_dwordx4 v[48:51], v15, s[20:23], s50 offen offset:128 sc1
    v_cndmask_b32 v56, v60, v56, s[44:45]
    v_cndmask_b32 v57, v61, v57, s[44:45]
    v_cndmask_b32 v58, v62, v58, s[44:45]
    v_cndmask_b32 v59, v63, v59, s[44:45]
    v_cvt_pk_bf16_f32 v56, v56, v57
    v_cvt_pk_bf16_f32 v58, v58, v59
    v_mov_b32 v57, v1
    v_mov_b32 v59, v1
    buffer_store_dwordx4 v[56:59], v15, s[20:23], s50 offen offset:256 sc1
    v_cndmask_b32 v64, v68, v64, s[44:45]
    v_cndmask_b32 v65, v69, v65, s[44:45]
    v_cndmask_b32 v66, v70, v66, s[44:45]
    v_cndmask_b32 v67, v71, v67, s[44:45]
    v_cvt_pk_bf16_f32 v64, v64, v65
    v_cvt_pk_bf16_f32 v66, v66, v67
    v_mov_b32 v65, v1
    v_mov_b32 v67, v1
    buffer_store_dwordx4 v[64:67], v15, s[20:23], s50 offen offset:384 sc1
    v_cndmask_b32 v72, v76, v72, s[44:45]
    v_cndmask_b32 v73, v77, v73, s[44:45]
    v_cndmask_b32 v74, v78, v74, s[44:45]
    v_cndmask_b32 v75, v79, v75, s[44:45]
    v_cvt_pk_bf16_f32 v72, v72, v73
    v_cvt_pk_bf16_f32 v74, v74, v75
    v_mov_b32 v73, v1
    v_mov_b32 v75, v1
    buffer_store_dwordx4 v[72:75], v15, s[20:23], s50 offen offset:512 sc1
    s_branch .b_aux
.a_free:
    v_and_b32 v3, 15, v2
    v_lshrrev_b32 v4, 4, v2
    v_lshlrev_b32 v6, 4, v3
    v_lshlrev_b32 v7, 4, v2
    v_mov_b32 v26, 161792
    v_mov_b32 v27, 1
    s_lshl_b32 s58, s24, 3
    s_add_u32 s58, s58, s25
    s_sub_u32 s58, s58, 24
    s_lshl_b32 s59, s58, 3
    s_add_u32 s59, s59, s3
    s_mul_i32 s59, s59, 5120
    s_add_u32 s59, s59, 5242880
    s_waitcnt lgkmcnt(0)
    s_mov_b32 s20, s8
    s_mov_b32 s21, s9
    s_barrier
    s_cmp_ge_u32 s25, 30
    s_cbranch_scc1 .a_pack
    s_load_dwordx4 s[12:15], s[0:1], 40
    s_load_dwordx2 s[16:17], s[0:1], 56
    s_mul_i32 s47, s24, 6
    s_add_u32 s47, s47, s25
    s_sub_u32 s47, s47, 24
    s_lshr_b32 s48, s47, 1
    s_and_b32 s49, s47, 1
    v_lshrrev_b32 v8, 3, v2
    v_mul_u32_u24 v8, 3072, v8
    v_and_b32 v12, 7, v2
    v_and_b32 v9, 1, v4
    v_lshlrev_b32 v9, 1, v9
    v_xor_b32 v9, v9, v12
    v_lshlrev_b32 v9, 4, v9
    s_and_b32 s28, s3, 1
    s_lshl_b32 s28, s28, 6
    v_xor_b32 v9, s28, v9
    v_xor_b32 v10, 64, v9
    v_add_u32 v9, v8, v9
    v_add_u32 v8, v8, v10
    s_lshl_b32 s28, s49, 3
    s_add_u32 s28, s28, s3
    s_mul_i32 s28, s28, 122880
    s_lshl_b32 s29, s48, 7
    s_add_u32 s28, s28, s29
    s_mul_i32 s31, s3, 5120
    s_lshl_b32 s29, s48, 3
    s_add_u32 s29, s29, s3
    s_mul_i32 s29, s29, 10240
    s_mul_i32 s30, s49, 640
    s_add_u32 s29, s29, s30
    s_mov_b32 s34, 1966080
    s_mov_b32 s35, 0x20000
    s_mov_b32 s42, 1966080
    s_mov_b32 s43, 0x20000
    s_mov_b32 s18, 1966080
    s_mov_b32 s19, 0x20000
    s_waitcnt lgkmcnt(0)
    s_mov_b32 s20, s8
    s_mov_b32 s21, s9
    s_mov_b32 s32, s12
    s_mov_b32 s33, s13
    s_mov_b32 s40, s14
    s_mov_b32 s41, s15
    v_add_u32 v10, 0, v2
    v_mul_u32_u24 v11, 1639, v10
    v_lshrrev_b32 v11, 16, v11
    v_mul_u32_u24 v11, 640, v11
    v_lshl_add_u32 v10, v10, 4, v11
    s_add_u32 m0, s31, 0
    s_nop 0
    buffer_load_dwordx4 v10, s[16:19], s29 offen lds
    v_add_u32 v10, 64, v2
    v_mul_u32_u24 v11, 1639, v10
    v_lshrrev_b32 v11, 16, v11
    v_mul_u32_u24 v11, 640, v11
    v_lshl_add_u32 v10, v10, 4, v11
    s_add_u32 m0, s31, 1024
    s_nop 0
    buffer_load_dwordx4 v10, s[16:19], s29 offen lds
    v_add_u32 v10, 128, v2
    v_mul_u32_u24 v11, 1639, v10
    v_lshrrev_b32 v11, 16, v11
    v_mul_u32_u24 v11, 640, v11
    v_lshl_add_u32 v10, v10, 4, v11
    s_add_u32 m0, s31, 2048
    s_nop 0
    buffer_load_dwordx4 v10, s[16:19], s29 offen lds
    v_add_u32 v10, 192, v2
    v_mul_u32_u24 v11, 1639, v10
    v_lshrrev_b32 v11, 16, v11
    v_mul_u32_u24 v11, 640, v11
    v_lshl_add_u32 v10, v10, 4, v11
    s_add_u32 m0, s31, 3072
    s_nop 0
    buffer_load_dwordx4 v10, s[16:19], s29 offen lds
    v_add_u32 v10, 256, v2
    v_mul_u32_u24 v11, 1639, v10
    v_lshrrev_b32 v11, 16, v11
    v_mul_u32_u24 v11, 640, v11
    v_lshl_add_u32 v10, v10, 4, v11
    s_add_u32 m0, s31, 4096
    s_nop 0
    buffer_load_dwordx4 v10, s[16:19], s29 offen lds
    s_add_u32 m0, s31, 49152
    s_add_u32 s30, s28, 0
    buffer_load_dwordx4 v9, s[32:35], s30 offen lds
    s_add_u32 m0, s31, 50176
    s_add_u32 s30, s28, 24576
    buffer_load_dwordx4 v8, s[32:35], s30 offen lds
    s_add_u32 m0, s31, 51200
    s_add_u32 s30, s28, 49152
    buffer_load_dwordx4 v9, s[32:35], s30 offen lds
    s_add_u32 m0, s31, 52224
    s_add_u32 s30, s28, 73728
    buffer_load_dwordx4 v8, s[32:35], s30 offen lds
    s_add_u32 m0, s31, 53248
    s_add_u32 s30, s28, 98304
    buffer_load_dwordx4 v9, s[32:35], s30 offen lds
    s_add_u32 m0, s31, 90112
    s_add_u32 s30, s28, 0
    buffer_load_dwordx4 v9, s[40:43], s30 offen lds
    s_add_u32 m0, s31, 91136
    s_add_u32 s30, s28, 24576
    buffer_load_dwordx4 v8, s[40:43], s30 offen lds
    s_add_u32 m0, s31, 92160
    s_add_u32 s30, s28, 49152
    buffer_load_dwordx4 v9, s[40:43], s30 offen lds
    s_add_u32 m0, s31, 93184
    s_add_u32 s30, s28, 73728
    buffer_load_dwordx4 v8, s[40:43], s30 offen lds
    s_add_u32 m0, s31, 94208
    s_add_u32 s30, s28, 98304
    buffer_load_dwordx4 v9, s[40:43], s30 offen lds
    s_waitcnt vmcnt(10)
    s_mov_b64 exec, 1
    ds_add_u32 v26, v27 offset:132
    s_mov_b64 exec, -1
    s_waitcnt vmcnt(0)
    s_mov_b64 exec, 1
    ds_add_u32 v26, v27 offset:128
    s_mov_b64 exec, -1
.a_fz:
    v_mov_b32 v100, -1
    v_mov_b32 v101, -1
    v_mov_b32 v102, -1
    v_mov_b32 v103, -1
    buffer_store_dwordx4 v[100:103], v7, s[20:23], s59 offen offset:0 sc1
    buffer_store_dwordx4 v[100:103], v7, s[20:23], s59 offen offset:1024 sc1
    buffer_store_dwordx4 v[100:103], v7, s[20:23], s59 offen offset:2048 sc1
    buffer_store_dwordx4 v[100:103], v7, s[20:23], s59 offen offset:3072 sc1
    s_add_u32 s59, s59, 4096
    buffer_store_dwordx4 v[100:103], v7, s[20:23], s59 offen offset:0 sc1
    s_mov_b32 s54, 0x200000
    .ga_lw64:
    ds_read_b32 v25, v26 offset:48
    s_sub_u32 s54, s54, 1
    s_waitcnt lgkmcnt(0)
    v_readfirstlane_b32 s53, v25
    s_cmp_eq_u32 s54, 0
    s_cbranch_scc1 .ga_lwd65
    s_cmp_ge_u32 s53, 1
    s_cbranch_scc1 .ga_lwd65
    s_sleep 1
    s_branch .ga_lw64
    .ga_lwd65:
    s_lshl_b32 s58, s58, 7
    s_add_u32 s58, s58, 11391488
    v_lshlrev_b32 v24, 2, v2
    s_mov_b64 exec, 1
    s_waitcnt vmcnt(0)
    ds_add_rtn_u32 v23, v26, v27 offset:40
    s_waitcnt lgkmcnt(0)
    v_readfirstlane_b32 s59, v23
    s_cmp_lg_u32 s59, 7
    s_cbranch_scc1 .ga_pz63
    s_mov_b32 exec_lo, -1
    buffer_store_dword v25, v24, s[20:23], s58 offen sc1
    .ga_pz63:
    s_mov_b64 exec, -1
    s_branch .b_attn
.a_pack:
    s_load_dwordx2 s[16:17], s[0:1], 16
    s_lshl_b32 s26, s24, 1
    s_add_u32 s26, s26, s25
    s_sub_u32 s26, s26, 30
    s_mul_i32 s33, s3, 7168
    s_mul_i32 s34, s26, 51200
    s_add_u32 s34, s34, s33
    s_mov_b32 m0, s33
    s_add_u32 s35, s34, 4096
    s_mov_b32 s18, 819200
    s_mov_b32 s19, 0x20000
    s_waitcnt lgkmcnt(0)
    s_mov_b32 m0, s33
    s_nop 0
    buffer_load_dwordx4 v7, s[16:19], s34 offen offset:0 lds
    buffer_load_dwordx4 v7, s[16:19], s34 offen offset:1024 lds
    buffer_load_dwordx4 v7, s[16:19], s34 offen offset:2048 lds
    buffer_load_dwordx4 v7, s[16:19], s34 offen offset:3072 lds
    s_add_u32 m0, s33, 4096
    s_nop 0
    buffer_load_dwordx4 v7, s[16:19], s35 offen offset:0 lds
    buffer_load_dwordx4 v7, s[16:19], s35 offen offset:1024 lds
    buffer_load_dwordx4 v7, s[16:19], s35 offen offset:2048 lds
    s_mov_b32 s55, 1
    s_cmp_eq_u32 s2, 248
    s_cbranch_scc1 .a_candok
    .a_selgo:
    s_mov_b32 s54, 0x200000
    .ga_lw66:
    ds_read_b32 v31, v26 offset:48
    s_sub_u32 s54, s54, 1
    s_waitcnt lgkmcnt(0)
    v_readfirstlane_b32 s53, v31
    s_cmp_eq_u32 s54, 0
    s_cbranch_scc1 .ga_lwd67
    s_cmp_ge_u32 s53, 1
    s_cbranch_scc1 .ga_lwd67
    s_sleep 1
    s_branch .ga_lw66
    .ga_lwd67:
    v_bfe_u32 v14, v2, 2, 2
    v_and_b32 v15, 3, v2
    v_mul_u32_u24 v16, 1280, v14
    s_mul_i32 s33, s3, 160
    v_add_u32 v16, s33, v16
    v_lshl_add_u32 v17, v15, 4, v16
    v_lshrrev_b32 v18, 1, v4
    v_lshl_add_u32 v17, v18, 6, v17
    v_lshl_add_u32 v19, v4, 1, v18
    v_and_b32 v18, 1, v4
    v_lshl_add_u32 v17, v18, 3, v17
    v_lshl_add_u32 v18, v15, 3, v16
    v_mul_u32_u24 v19, 5120, v19
    v_add_u32 v19, v19, v18
    v_lshl_add_u32 v20, v4, 10, v6
    s_mul_i32 s35, s3, 102400
    s_add_u32 s35, s35, 10485760
    s_mul_i32 s36, s26, 5120
    s_add_u32 s36, s36, s35
    s_lshr_b32 s37, s26, 2
    s_mulk_i32 s37, 5120
    s_add_u32 s37, s37, s35
    s_and_b32 s38, s26, 3
    s_lshl_b32 s38, s38, 8
    s_add_u32 s37, s37, s38
    s_add_u32 s37, s37, 81920
    s_add_u32 s38, s36, 4096
    s_add_u32 s39, s37, 4096
    s_waitcnt vmcnt(0)
    s_mov_b64 exec, 1
    ds_add_u32 v26, v27 offset:128
    s_mov_b64 exec, -1
    s_mov_b32 s54, 0x200000
    .ga_lw68:
    ds_read_b32 v28, v26 offset:128
    s_sub_u32 s54, s54, 1
    s_waitcnt lgkmcnt(0)
    v_readfirstlane_b32 s53, v28
    s_cmp_eq_u32 s54, 0
    s_cbranch_scc1 .ga_lwd69
    s_cmp_ge_u32 s53, 8
    s_cbranch_scc1 .ga_lwd69
    s_sleep 1
    s_branch .ga_lw68
    .ga_lwd69:
    ds_read_b64_tr_b16 v[64:65], v17 offset:0
    ds_read_b64_tr_b16 v[66:67], v17 offset:5120
    ds_read_b64_tr_b16 v[68:69], v17 offset:10240
    ds_read_b64_tr_b16 v[70:71], v17 offset:15360
    ds_read_b64_tr_b16 v[72:73], v17 offset:25600
    ds_read_b64_tr_b16 v[74:75], v17 offset:30720
    ds_read_b64_tr_b16 v[76:77], v17 offset:35840
    ds_read_b64_tr_b16 v[78:79], v17 offset:40960
    ds_read_b64_tr_b16 v[80:81], v17 offset:20480
    ds_read_b64_tr_b16 v[82:83], v17 offset:46080
    ds_read_b64_tr_b16 v[84:85], v19 offset:128
    ds_read_b64_tr_b16 v[86:87], v19 offset:5248
    ds_read_b64_tr_b16 v[88:89], v18 offset:20608
    ds_read_b64_tr_b16 v[90:91], v18 offset:46208
    s_waitcnt lgkmcnt(12)
    buffer_store_dwordx4 v[64:67], v20, s[20:23], s36 offen offset:0 sc1
    s_waitcnt lgkmcnt(10)
    buffer_store_dwordx4 v[68:71], v20, s[20:23], s36 offen offset:256 sc1
    s_waitcnt lgkmcnt(8)
    buffer_store_dwordx4 v[72:75], v20, s[20:23], s36 offen offset:512 sc1
    s_waitcnt lgkmcnt(6)
    buffer_store_dwordx4 v[76:79], v20, s[20:23], s36 offen offset:768 sc1
    s_waitcnt lgkmcnt(4)
    buffer_store_dwordx4 v[80:83], v20, s[20:23], s37 offen sc1
    s_waitcnt lgkmcnt(0)
    buffer_store_dwordx4 v[84:87], v7, s[20:23], s38 offen sc1
    s_mov_b64 exec, 0xffff
    buffer_store_dwordx4 v[88:91], v6, s[20:23], s39 offen sc1
    s_mov_b64 exec, -1
    s_waitcnt vmcnt(0)
    s_mov_b64 exec, 1
    ds_add_u32 v26, v27 offset:128
    s_mov_b64 exec, -1
    s_cmp_lg_u32 s3, 0
    s_cbranch_scc1 .a_pk3
    s_mov_b32 s54, 0x200000
    .ga_lw70:
    ds_read_b32 v28, v26 offset:128
    s_sub_u32 s54, s54, 1
    s_waitcnt lgkmcnt(0)
    v_readfirstlane_b32 s53, v28
    s_cmp_eq_u32 s54, 0
    s_cbranch_scc1 .ga_lwd71
    s_cmp_ge_u32 s53, 16
    s_cbranch_scc1 .ga_lwd71
    s_sleep 1
    s_branch .ga_lw70
    .ga_lwd71:
    s_lshl_b32 s36, s26, 11
    s_add_u32 s36, s36, 11352448
    v_lshlrev_b32 v24, 2, v2
    v_mov_b32 v27, 4
    s_mov_b32 exec_lo, -1
    s_mov_b32 exec_hi, 0
    buffer_store_dword v31, v24, s[20:23], s36 offen sc1
    s_mov_b64 exec, -1
    ds_write_b32 v26, v27 offset:12
    v_mov_b32 v27, 1
    .a_pk3:
    s_cmp_lg_u32 s2, 248
    s_cbranch_scc1 .a_nosel
    s_lshl_b32 s60, s3, 12
    s_add_u32 s60, s60, 11309056
    s_mov_b32 s53, 0x20000
    s_mov_b32 s62, 0xaaaaaaaa
    s_mov_b32 s63, s62
    s_mov_b32 s64, 0xcccccccc
    s_mov_b32 s65, s64
    s_mov_b32 s55, 0
    s_mov_b32 s54, 0x200000
    .ga_lw72:
    ds_read_b32 v28, v26 offset:56
    s_sub_u32 s54, s54, 1
    s_waitcnt lgkmcnt(0)
    v_readfirstlane_b32 s53, v28
    s_cmp_eq_u32 s54, 0
    s_cbranch_scc1 .ga_lwd73
    s_cmp_ge_u32 s53, 12
    s_cbranch_scc1 .ga_lwd73
    s_sleep 1
    s_branch .ga_lw72
    .ga_lwd73:
    s_mov_b32 s53, 0x20000
    .a_cand:
    buffer_load_dwordx2 v[32:33], v7, s[20:23], s60 offen offset:0 sc1
    buffer_load_dwordx2 v[34:35], v7, s[20:23], s60 offen offset:1024 sc1
    buffer_load_dwordx2 v[36:37], v7, s[20:23], s60 offen offset:2048 sc1
    buffer_load_dwordx2 v[38:39], v7, s[20:23], s60 offen offset:3072 sc1
    s_sub_u32 s53, s53, 1
    s_waitcnt vmcnt(0)
    v_xor_b32 v33, v33, v31
    v_xor_b32 v35, v35, v31
    v_xor_b32 v37, v37, v31
    v_xor_b32 v39, v39, v31
    v_or3_b32 v33, v33, v35, v37
    v_or_b32 v33, v33, v39
    v_cmp_ne_u32 vcc, 0, v33
    s_cmp_eq_u32 s53, 0
    s_cbranch_scc1 .a_candok
    s_cbranch_vccz .a_candok
    s_sleep 2
    s_branch .a_cand
    .a_candok:
    s_nop 0
    v_max_u32_dpp v33, v32, v32 quad_perm:[1,0,3,2] row_mask:0xf bank_mask:0xf
    v_min_u32_dpp v40, v32, v32 quad_perm:[1,0,3,2] row_mask:0xf bank_mask:0xf
    v_max_u32_dpp v35, v34, v34 quad_perm:[1,0,3,2] row_mask:0xf bank_mask:0xf
    v_min_u32_dpp v41, v34, v34 quad_perm:[1,0,3,2] row_mask:0xf bank_mask:0xf
    v_max_u32_dpp v37, v36, v36 quad_perm:[1,0,3,2] row_mask:0xf bank_mask:0xf
    v_min_u32_dpp v42, v36, v36 quad_perm:[1,0,3,2] row_mask:0xf bank_mask:0xf
    v_max_u32_dpp v39, v38, v38 quad_perm:[1,0,3,2] row_mask:0xf bank_mask:0xf
    v_min_u32_dpp v43, v38, v38 quad_perm:[1,0,3,2] row_mask:0xf bank_mask:0xf
    v_cndmask_b32 v32, v33, v40, s[62:63]
    v_cndmask_b32 v34, v35, v41, s[62:63]
    v_cndmask_b32 v36, v37, v42, s[62:63]
    v_cndmask_b32 v38, v39, v43, s[62:63]
    s_nop 0
    v_max_u32_dpp v33, v32, v32 quad_perm:[3,2,1,0] row_mask:0xf bank_mask:0xf
    v_min_u32_dpp v40, v32, v32 quad_perm:[3,2,1,0] row_mask:0xf bank_mask:0xf
    v_max_u32_dpp v35, v34, v34 quad_perm:[3,2,1,0] row_mask:0xf bank_mask:0xf
    v_min_u32_dpp v41, v34, v34 quad_perm:[3,2,1,0] row_mask:0xf bank_mask:0xf
    v_max_u32_dpp v37, v36, v36 quad_perm:[3,2,1,0] row_mask:0xf bank_mask:0xf
    v_min_u32_dpp v42, v36, v36 quad_perm:[3,2,1,0] row_mask:0xf bank_mask:0xf
    v_max_u32_dpp v39, v38, v38 quad_perm:[3,2,1,0] row_mask:0xf bank_mask:0xf
    v_min_u32_dpp v43, v38, v38 quad_perm:[3,2,1,0] row_mask:0xf bank_mask:0xf
    v_cndmask_b32 v32, v33, v40, s[64:65]
    v_cndmask_b32 v34, v35, v41, s[64:65]
    v_cndmask_b32 v36, v37, v42, s[64:65]
    v_cndmask_b32 v38, v39, v43, s[64:65]
    s_nop 0
    v_max_u32_dpp v33, v32, v32 quad_perm:[1,0,3,2] row_mask:0xf bank_mask:0xf
    v_min_u32_dpp v40, v32, v32 quad_perm:[1,0,3,2] row_mask:0xf bank_mask:0xf
    v_max_u32_dpp v35, v34, v34 quad_perm:[1,0,3,2] row_mask:0xf bank_mask:0xf
    v_min_u32_dpp v41, v34, v34 quad_perm:[1,0,3,2] row_mask:0xf bank_mask:0xf
    v_max_u32_dpp v37, v36, v36 quad_perm:[1,0,3,2] row_mask:0xf bank_mask:0xf
    v_min_u32_dpp v42, v36, v36 quad_perm:[1,0,3,2] row_mask:0xf bank_mask:0xf
    v_max_u32_dpp v39, v38, v38 quad_perm:[1,0,3,2] row_mask:0xf bank_mask:0xf
    v_min_u32_dpp v43, v38, v38 quad_perm:[1,0,3,2] row_mask:0xf bank_mask:0xf
    v_cndmask_b32 v32, v33, v40, s[62:63]
    v_cndmask_b32 v34, v35, v41, s[62:63]
    v_cndmask_b32 v36, v37, v42, s[62:63]
    v_cndmask_b32 v38, v39, v43, s[62:63]
    s_nop 0
    v_max_u32_dpp v33, v32, v32 row_half_mirror row_mask:0xf bank_mask:0x5
    v_min_u32_dpp v33, v32, v32 row_half_mirror row_mask:0xf bank_mask:0xa
    v_max_u32_dpp v35, v34, v34 row_half_mirror row_mask:0xf bank_mask:0x5
    v_min_u32_dpp v35, v34, v34 row_half_mirror row_mask:0xf bank_mask:0xa
    v_max_u32_dpp v37, v36, v36 row_half_mirror row_mask:0xf bank_mask:0x5
    v_min_u32_dpp v37, v36, v36 row_half_mirror row_mask:0xf bank_mask:0xa
    v_max_u32_dpp v39, v38, v38 row_half_mirror row_mask:0xf bank_mask:0x5
    v_min_u32_dpp v39, v38, v38 row_half_mirror row_mask:0xf bank_mask:0xa
    s_nop 0
    v_max_u32_dpp v32, v33, v33 quad_perm:[2,3,0,1] row_mask:0xf bank_mask:0xf
    v_min_u32_dpp v40, v33, v33 quad_perm:[2,3,0,1] row_mask:0xf bank_mask:0xf
    v_max_u32_dpp v34, v35, v35 quad_perm:[2,3,0,1] row_mask:0xf bank_mask:0xf
    v_min_u32_dpp v41, v35, v35 quad_perm:[2,3,0,1] row_mask:0xf bank_mask:0xf
    v_max_u32_dpp v36, v37, v37 quad_perm:[2,3,0,1] row_mask:0xf bank_mask:0xf
    v_min_u32_dpp v42, v37, v37 quad_perm:[2,3,0,1] row_mask:0xf bank_mask:0xf
    v_max_u32_dpp v38, v39, v39 quad_perm:[2,3,0,1] row_mask:0xf bank_mask:0xf
    v_min_u32_dpp v43, v39, v39 quad_perm:[2,3,0,1] row_mask:0xf bank_mask:0xf
    v_cndmask_b32 v33, v32, v40, s[64:65]
    v_cndmask_b32 v35, v34, v41, s[64:65]
    v_cndmask_b32 v37, v36, v42, s[64:65]
    v_cndmask_b32 v39, v38, v43, s[64:65]
    s_nop 0
    v_max_u32_dpp v32, v33, v33 quad_perm:[1,0,3,2] row_mask:0xf bank_mask:0xf
    v_min_u32_dpp v40, v33, v33 quad_perm:[1,0,3,2] row_mask:0xf bank_mask:0xf
    v_max_u32_dpp v34, v35, v35 quad_perm:[1,0,3,2] row_mask:0xf bank_mask:0xf
    v_min_u32_dpp v41, v35, v35 quad_perm:[1,0,3,2] row_mask:0xf bank_mask:0xf
    v_max_u32_dpp v36, v37, v37 quad_perm:[1,0,3,2] row_mask:0xf bank_mask:0xf
    v_min_u32_dpp v42, v37, v37 quad_perm:[1,0,3,2] row_mask:0xf bank_mask:0xf
    v_max_u32_dpp v38, v39, v39 quad_perm:[1,0,3,2] row_mask:0xf bank_mask:0xf
    v_min_u32_dpp v43, v39, v39 quad_perm:[1,0,3,2] row_mask:0xf bank_mask:0xf
    v_cndmask_b32 v33, v32, v40, s[62:63]
    v_cndmask_b32 v35, v34, v41, s[62:63]
    v_cndmask_b32 v37, v36, v42, s[62:63]
    v_cndmask_b32 v39, v38, v43, s[62:63]
    s_nop 1
    v_max_u32_dpp v33, v37, v33 row_half_mirror row_mask:0xf bank_mask:0xf
    v_max_u32_dpp v35, v39, v35 row_half_mirror row_mask:0xf bank_mask:0xf
    s_nop 0
    v_max_u32_dpp v37, v33, v33 row_shl:4 row_mask:0xf bank_mask:0x5
    v_min_u32_dpp v37, v33, v33 row_shr:4 row_mask:0xf bank_mask:0xa
    v_max_u32_dpp v39, v35, v35 row_shl:4 row_mask:0xf bank_mask:0x5
    v_min_u32_dpp v39, v35, v35 row_shr:4 row_mask:0xf bank_mask:0xa
    s_nop 0
    v_max_u32_dpp v33, v37, v37 quad_perm:[2,3,0,1] row_mask:0xf bank_mask:0xf
    v_min_u32_dpp v40, v37, v37 quad_perm:[2,3,0,1] row_mask:0xf bank_mask:0xf
    v_max_u32_dpp v35, v39, v39 quad_perm:[2,3,0,1] row_mask:0xf bank_mask:0xf
    v_min_u32_dpp v41, v39, v39 quad_perm:[2,3,0,1] row_mask:0xf bank_mask:0xf
    v_cndmask_b32 v37, v33, v40, s[64:65]
    v_cndmask_b32 v39, v35, v41, s[64:65]
    s_nop 0
    v_max_u32_dpp v33, v37, v37 quad_perm:[1,0,3,2] row_mask:0xf bank_mask:0xf
    v_min_u32_dpp v40, v37, v37 quad_perm:[1,0,3,2] row_mask:0xf bank_mask:0xf
    v_max_u32_dpp v35, v39, v39 quad_perm:[1,0,3,2] row_mask:0xf bank_mask:0xf
    v_min_u32_dpp v41, v39, v39 quad_perm:[1,0,3,2] row_mask:0xf bank_mask:0xf
    v_cndmask_b32 v37, v33, v40, s[62:63]
    v_cndmask_b32 v39, v35, v41, s[62:63]
    s_nop 1
    v_max_u32_dpp v37, v39, v37 row_half_mirror row_mask:0xf bank_mask:0xf
    s_nop 1
    v_max_u32_dpp v40, v37, v37 row_shl:4 row_mask:0xf bank_mask:0x5
    v_min_u32_dpp v40, v37, v37 row_shr:4 row_mask:0xf bank_mask:0xa
    s_nop 1
    v_max_u32_dpp v37, v40, v40 quad_perm:[2,3,0,1] row_mask:0xf bank_mask:0xf
    v_min_u32_dpp v41, v40, v40 quad_perm:[2,3,0,1] row_mask:0xf bank_mask:0xf
    v_cndmask_b32 v40, v37, v41, s[64:65]
    s_nop 1
    v_max_u32_dpp v37, v40, v40 quad_perm:[1,0,3,2] row_mask:0xf bank_mask:0xf
    v_min_u32_dpp v41, v40, v40 quad_perm:[1,0,3,2] row_mask:0xf bank_mask:0xf
    v_cndmask_b32 v40, v37, v41, s[62:63]
    s_nop 1
    v_max_u32_dpp v40, v40, v40 row_mirror row_mask:0xf bank_mask:0xf
    s_nop 1
    v_max_u32_dpp v37, v40, v40 row_shl:4 row_mask:0xf bank_mask:0x5
    v_min_u32_dpp v37, v40, v40 row_shr:4 row_mask:0xf bank_mask:0xa
    s_nop 1
    v_max_u32_dpp v40, v37, v37 quad_perm:[2,3,0,1] row_mask:0xf bank_mask:0xf
    v_min_u32_dpp v41, v37, v37 quad_perm:[2,3,0,1] row_mask:0xf bank_mask:0xf
    v_cndmask_b32 v37, v40, v41, s[64:65]
    s_nop 1
    v_max_u32_dpp v40, v37, v37 quad_perm:[1,0,3,2] row_mask:0xf bank_mask:0xf
    v_min_u32_dpp v41, v37, v37 quad_perm:[1,0,3,2] row_mask:0xf bank_mask:0xf
    v_cndmask_b32 v37, v40, v41, s[62:63]
    v_mov_b32 v39, v37
    s_nop 1
    v_permlane16_swap_b32 v37, v39
    s_nop 1
    v_max_u32_dpp v37, v39, v37 row_half_mirror row_mask:0xf bank_mask:0xf
    s_nop 1
    v_max_u32_dpp v40, v37, v37 row_shl:4 row_mask:0xf bank_mask:0x5
    v_min_u32_dpp v40, v37, v37 row_shr:4 row_mask:0xf bank_mask:0xa
    s_nop 1
    v_max_u32_dpp v37, v40, v40 quad_perm:[2,3,0,1] row_mask:0xf bank_mask:0xf
    v_min_u32_dpp v41, v40, v40 quad_perm:[2,3,0,1] row_mask:0xf bank_mask:0xf
    v_cndmask_b32 v40, v37, v41, s[64:65]
    s_nop 1
    v_max_u32_dpp v37, v40, v40 quad_perm:[1,0,3,2] row_mask:0xf bank_mask:0xf
    v_min_u32_dpp v41, v40, v40 quad_perm:[1,0,3,2] row_mask:0xf bank_mask:0xf
    v_cndmask_b32 v40, v37, v41, s[62:63]
    v_mov_b32 v39, v40
    s_nop 1
    v_permlane32_swap_b32 v40, v39
    s_nop 1
    v_max_u32_dpp v40, v39, v40 row_half_mirror row_mask:0xf bank_mask:0xf
    s_nop 1
    v_max_u32_dpp v37, v40, v40 row_shl:4 row_mask:0xf bank_mask:0x5
    v_min_u32_dpp v37, v40, v40 row_shr:4 row_mask:0xf bank_mask:0xa
    s_nop 1
    v_max_u32_dpp v40, v37, v37 quad_perm:[2,3,0,1] row_mask:0xf bank_mask:0xf
    v_min_u32_dpp v41, v37, v37 quad_perm:[2,3,0,1] row_mask:0xf bank_mask:0xf
    v_cndmask_b32 v37, v40, v41, s[64:65]
    s_nop 1
    v_max_u32_dpp v40, v37, v37 quad_perm:[1,0,3,2] row_mask:0xf bank_mask:0xf
    v_min_u32_dpp v41, v37, v37 quad_perm:[1,0,3,2] row_mask:0xf bank_mask:0xf
    v_cndmask_b32 v37, v40, v41, s[62:63]
    s_cmp_eq_u32 s55, 1
    s_cbranch_scc1 .a_sel2
    s_lshl_b32 s60, s3, 5
    s_add_u32 s60, s60, 160768
    v_lshlrev_b32 v44, 2, v2
    v_add_u32 v45, s60, v44
    s_mov_b64 exec, 0xff
    ds_write_b32 v45, v37
    s_mov_b64 exec, 1
    ds_add_u32 v26, v27 offset:132
    s_mov_b64 exec, -1
    s_cmp_lg_u32 s3, 1
    s_cbranch_scc1 .a_nosel
    s_mov_b32 s54, 0x200000
    .ga_lw74:
    ds_read_b32 v32, v26 offset:132
    s_sub_u32 s54, s54, 1
    s_waitcnt lgkmcnt(0)
    v_readfirstlane_b32 s53, v32
    s_cmp_eq_u32 s54, 0
    s_cbranch_scc1 .ga_lwd75
    s_cmp_ge_u32 s53, 8
    s_cbranch_scc1 .ga_lwd75
    s_sleep 0
    s_branch .ga_lw74
    .ga_lwd75:
    v_add_u32 v45, 160768, v44
    ds_read_b32 v32, v45
    s_waitcnt lgkmcnt(0)
.a_sel2:
    s_nop 1
    v_max_u32_dpp v32, v32, v32 row_mirror row_mask:0xf bank_mask:0xf
    s_nop 1
    v_max_u32_dpp v33, v32, v32 row_shl:4 row_mask:0xf bank_mask:0x5
    v_min_u32_dpp v33, v32, v32 row_shr:4 row_mask:0xf bank_mask:0xa
    s_nop 1
    v_max_u32_dpp v32, v33, v33 quad_perm:[2,3,0,1] row_mask:0xf bank_mask:0xf
    v_min_u32_dpp v34, v33, v33 quad_perm:[2,3,0,1] row_mask:0xf bank_mask:0xf
    v_cndmask_b32 v33, v32, v34, s[64:65]
    s_nop 1
    v_max_u32_dpp v32, v33, v33 quad_perm:[1,0,3,2] row_mask:0xf bank_mask:0xf
    v_min_u32_dpp v34, v33, v33 quad_perm:[1,0,3,2] row_mask:0xf bank_mask:0xf
    v_cndmask_b32 v33, v32, v34, s[62:63]
    v_mov_b32 v35, v33
    s_nop 1
    v_permlane16_swap_b32 v33, v35
    s_nop 1
    v_max_u32_dpp v33, v35, v33 row_half_mirror row_mask:0xf bank_mask:0xf
    s_nop 1
    v_max_u32_dpp v32, v33, v33 row_shl:4 row_mask:0xf bank_mask:0x5
    v_min_u32_dpp v32, v33, v33 row_shr:4 row_mask:0xf bank_mask:0xa
    s_nop 1
    v_max_u32_dpp v33, v32, v32 quad_perm:[2,3,0,1] row_mask:0xf bank_mask:0xf
    v_min_u32_dpp v34, v32, v32 quad_perm:[2,3,0,1] row_mask:0xf bank_mask:0xf
    v_cndmask_b32 v32, v33, v34, s[64:65]
    s_nop 1
    v_max_u32_dpp v33, v32, v32 quad_perm:[1,0,3,2] row_mask:0xf bank_mask:0xf
    v_min_u32_dpp v34, v32, v32 quad_perm:[1,0,3,2] row_mask:0xf bank_mask:0xf
    v_cndmask_b32 v32, v33, v34, s[62:63]
    v_mov_b32 v35, v32
    s_nop 1
    v_permlane32_swap_b32 v32, v35
    s_nop 1
    v_max_u32_dpp v32, v35, v32 row_half_mirror row_mask:0xf bank_mask:0xf
    s_nop 1
    v_max_u32_dpp v33, v32, v32 row_shl:4 row_mask:0xf bank_mask:0x5
    v_min_u32_dpp v33, v32, v32 row_shr:4 row_mask:0xf bank_mask:0xa
    s_nop 1
    v_max_u32_dpp v32, v33, v33 quad_perm:[2,3,0,1] row_mask:0xf bank_mask:0xf
    v_min_u32_dpp v34, v33, v33 quad_perm:[2,3,0,1] row_mask:0xf bank_mask:0xf
    v_cndmask_b32 v33, v32, v34, s[64:65]
    s_nop 1
    v_max_u32_dpp v32, v33, v33 quad_perm:[1,0,3,2] row_mask:0xf bank_mask:0xf
    v_min_u32_dpp v34, v33, v33 quad_perm:[1,0,3,2] row_mask:0xf bank_mask:0xf
    v_cndmask_b32 v33, v32, v34, s[62:63]
    v_and_b32 v36, 0xffff, v33
    v_sub_u32 v36, 2047, v36
    v_and_b32 v37, 0xffff0000, v33
    v_ashrrev_i32 v38, 31, v37
    v_not_b32 v38, v38
    v_or_b32 v38, 0x80000000, v38
    v_xor_b32 v37, v37, v38
    v_and_b32 v37, 0xffff0000, v37
    v_mul_f32 v37, 0xbfb8aa3b, v37
    v_exp_f32 v37, v37
    v_lshlrev_b32 v39, 3, v2
    v_add_f32 v37, 1.0, v37
    v_rcp_f32 v37, v37
    v_cmp_gt_u32 vcc, 8, v2
    v_cvt_pk_bf16_f32 v37, 0, v37
    s_mov_b32 s53, 11350016
    v_cndmask_b32 v30, v37, v36, vcc
    s_cmp_eq_u32 s55, 1
    s_cbranch_scc1 .a_selgo
    s_mov_b64 exec, 0xffff
    buffer_store_dwordx2 v[30:31], v39, s[20:23], s53 offen sc1
    s_mov_b64 exec, -1
    .a_nosel:
    s_branch .a_fz
.code_hot_end:
.bc_slow:
    s_waitcnt vmcnt(0)
    v_cmp_eq_u32 vcc, 1, v5
    v_mov_b32 v11, 0x3f80
    v_mov_b32 v34, 0
    v_mov_b32 v35, 0
    v_mov_b32 v38, 0
    v_mov_b32 v39, 0
    v_mov_b32 v146, 0
    v_mov_b32 v147, 0
    v_mov_b32 v150, 0
    v_mov_b32 v151, 0
    v_cndmask_b32 v20, v20, v11, vcc
    ds_read_b128 v[24:27], v8 offset:0
    ds_read_b64 v[32:33], v9 offset:0
    ds_read_b128 v[28:31], v8 offset:4096
    ds_read_b64 v[36:37], v9 offset:4096
    ds_read_b128 v[136:139], v8 offset:512
    ds_read_b64 v[144:145], v9 offset:512
    ds_read_b128 v[140:143], v8 offset:1024
    ds_read_b64 v[148:149], v9 offset:1024
    s_waitcnt lgkmcnt(6)
    v_mfma_f32_32x32x16_bf16 v[40:55], v[24:27], v[16:19], 0
    v_mfma_f32_32x32x16_bf16 v[40:55], v[32:35], v[20:23], v[40:55]
    ds_read_b128 v[24:27], v8 offset:1536
    ds_read_b64 v[32:33], v9 offset:1536
    s_waitcnt lgkmcnt(6)
    v_mfma_f32_32x32x16_bf16 v[152:167], v[28:31], v[16:19], 0
    v_mfma_f32_32x32x16_bf16 v[152:167], v[36:39], v[20:23], v[152:167]
    ds_read_b128 v[28:31], v8 offset:2048
    ds_read_b64 v[36:37], v9 offset:2048
    s_waitcnt lgkmcnt(6)
    v_mfma_f32_32x32x16_bf16 v[56:71], v[136:139], v[16:19], 0
    v_mfma_f32_32x32x16_bf16 v[56:71], v[144:147], v[20:23], v[56:71]
    ds_read_b128 v[136:139], v8 offset:2560
    ds_read_b64 v[144:145], v9 offset:2560
    s_waitcnt lgkmcnt(6)
    v_mfma_f32_32x32x16_bf16 v[72:87], v[140:143], v[16:19], 0
    v_mfma_f32_32x32x16_bf16 v[72:87], v[148:151], v[20:23], v[72:87]
    s_nop 1
    v_cndmask_b32 v40, v40, v152, s[48:49]
    v_cndmask_b32 v41, v41, v153, s[50:51]
    v_cndmask_b32 v42, v42, v154, s[52:53]
    v_cndmask_b32 v43, v43, v155, s[54:55]
    v_cndmask_b32 v44, v44, v156, s[56:57]
    v_cndmask_b32 v45, v45, v157, s[58:59]
    v_cndmask_b32 v46, v46, v158, s[60:61]
    v_cndmask_b32 v47, v47, v159, s[62:63]
    v_cndmask_b32 v48, v48, v160, s[64:65]
    v_cndmask_b32 v49, v49, v161, s[66:67]
    v_cndmask_b32 v50, v50, v162, s[68:69]
    v_cndmask_b32 v51, v51, v163, s[70:71]
    v_cndmask_b32 v52, v52, v164, s[72:73]
    v_cndmask_b32 v53, v53, v165, s[74:75]
    v_cndmask_b32 v54, v54, v166, s[76:77]
    v_cndmask_b32 v55, v55, v167, s[78:79]
    v_max_f32 v12, v40, v41
    v_max_f32 v13, v42, v43
    v_max3_f32 v12, v12, v44, v45
    v_max3_f32 v13, v13, v46, v47
    v_max3_f32 v12, v12, v48, v49
    v_max3_f32 v13, v13, v50, v51
    v_max3_f32 v12, v12, v52, v53
    v_max3_f32 v13, v13, v54, v55
    s_waitcnt lgkmcnt(4)
    v_mfma_f32_32x32x16_bf16 v[88:103], v[24:27], v[16:19], 0
    v_mfma_f32_32x32x16_bf16 v[88:103], v[32:35], v[20:23], v[88:103]
    ds_read_b128 v[24:27], v8 offset:3072
    ds_read_b64 v[32:33], v9 offset:3072
    v_max3_f32 v12, v12, v56, v57
    v_max3_f32 v13, v13, v58, v59
    v_max3_f32 v12, v12, v60, v61
    v_max3_f32 v13, v13, v62, v63
    v_max3_f32 v12, v12, v64, v65
    v_max3_f32 v13, v13, v66, v67
    v_max3_f32 v12, v12, v68, v69
    v_max3_f32 v13, v13, v70, v71
    s_waitcnt lgkmcnt(4)
    v_mfma_f32_32x32x16_bf16 v[104:119], v[28:31], v[16:19], 0
    v_mfma_f32_32x32x16_bf16 v[104:119], v[36:39], v[20:23], v[104:119]
    ds_read_b128 v[28:31], v8 offset:3584
    ds_read_b64 v[36:37], v9 offset:3584
    v_max3_f32 v12, v12, v72, v73
    v_max3_f32 v13, v13, v74, v75
    v_max3_f32 v12, v12, v76, v77
    v_max3_f32 v13, v13, v78, v79
    v_max3_f32 v12, v12, v80, v81
    v_max3_f32 v13, v13, v82, v83
    v_max3_f32 v12, v12, v84, v85
    v_max3_f32 v13, v13, v86, v87
    s_waitcnt lgkmcnt(4)
    v_mfma_f32_32x32x16_bf16 v[120:135], v[136:139], v[16:19], 0
    v_mfma_f32_32x32x16_bf16 v[120:135], v[144:147], v[20:23], v[120:135]
    v_max3_f32 v12, v12, v88, v89
    v_max3_f32 v13, v13, v90, v91
    v_max3_f32 v12, v12, v92, v93
    v_max3_f32 v13, v13, v94, v95
    v_max3_f32 v12, v12, v96, v97
    v_max3_f32 v13, v13, v98, v99
    v_max3_f32 v12, v12, v100, v101
    v_max3_f32 v13, v13, v102, v103
    s_waitcnt lgkmcnt(2)
    v_mfma_f32_32x32x16_bf16 v[136:151], v[24:27], v[16:19], 0
    v_mfma_f32_32x32x16_bf16 v[136:151], v[32:35], v[20:23], v[136:151]
    v_max3_f32 v12, v12, v104, v105
    v_max3_f32 v13, v13, v106, v107
    v_max3_f32 v12, v12, v108, v109
    v_max3_f32 v13, v13, v110, v111
    v_max3_f32 v12, v12, v112, v113
    v_max3_f32 v13, v13, v114, v115
    v_max3_f32 v12, v12, v116, v117
    v_max3_f32 v13, v13, v118, v119
    s_waitcnt lgkmcnt(0)
    v_mfma_f32_32x32x16_bf16 v[152:167], v[28:31], v[16:19], 0
    v_mfma_f32_32x32x16_bf16 v[152:167], v[36:39], v[20:23], v[152:167]
    v_max3_f32 v12, v12, v120, v121
    v_max3_f32 v13, v13, v122, v123
    v_max3_f32 v12, v12, v124, v125
    v_max3_f32 v13, v13, v126, v127
    v_max3_f32 v12, v12, v128, v129
    v_max3_f32 v13, v13, v130, v131
    v_max3_f32 v12, v12, v132, v133
    v_max3_f32 v13, v13, v134, v135
    v_max3_f32 v12, v12, v136, v137
    v_max3_f32 v13, v13, v138, v139
    v_max3_f32 v12, v12, v140, v141
    v_max3_f32 v13, v13, v142, v143
    v_max3_f32 v12, v12, v144, v145
    v_max3_f32 v13, v13, v146, v147
    v_max3_f32 v12, v12, v148, v149
    v_max3_f32 v13, v13, v150, v151
    ds_read_b128 v[24:27], v10 offset:1344
    ds_read_b128 v[28:31], v10 offset:2016
    ds_read_b128 v[32:35], v10 offset:2688
    ds_read_b128 v[36:39], v10 offset:3360
    v_max3_f32 v12, v12, v152, v153
    v_max3_f32 v13, v13, v154, v155
    v_max3_f32 v12, v12, v156, v157
    v_max3_f32 v13, v13, v158, v159
    v_max3_f32 v12, v12, v160, v161
    v_max3_f32 v13, v13, v162, v163
    v_max3_f32 v12, v12, v164, v165
    v_max3_f32 v13, v13, v166, v167
    v_max_f32 v12, v12, v13
    v_mov_b32 v13, v12
    s_nop 1
    v_permlane32_swap_b32 v12, v13
    s_nop 1
    v_max_f32 v12, v12, v13
    v_pk_add_f32 v[56:57], v[56:57], v[12:13] op_sel_hi:[1,0] neg_lo:[0,1] neg_hi:[0,1]
    v_pk_add_f32 v[58:59], v[58:59], v[12:13] op_sel_hi:[1,0] neg_lo:[0,1] neg_hi:[0,1]
    v_pk_add_f32 v[60:61], v[60:61], v[12:13] op_sel_hi:[1,0] neg_lo:[0,1] neg_hi:[0,1]
    v_pk_add_f32 v[62:63], v[62:63], v[12:13] op_sel_hi:[1,0] neg_lo:[0,1] neg_hi:[0,1]
    v_pk_add_f32 v[64:65], v[64:65], v[12:13] op_sel_hi:[1,0] neg_lo:[0,1] neg_hi:[0,1]
    v_pk_add_f32 v[66:67], v[66:67], v[12:13] op_sel_hi:[1,0] neg_lo:[0,1] neg_hi:[0,1]
    v_pk_add_f32 v[68:69], v[68:69], v[12:13] op_sel_hi:[1,0] neg_lo:[0,1] neg_hi:[0,1]
    v_pk_add_f32 v[70:71], v[70:71], v[12:13] op_sel_hi:[1,0] neg_lo:[0,1] neg_hi:[0,1]
    v_exp_f32 v56, v56
    v_exp_f32 v57, v57
    v_exp_f32 v58, v58
    v_exp_f32 v59, v59
    v_exp_f32 v60, v60
    v_exp_f32 v61, v61
    v_exp_f32 v62, v62
    v_exp_f32 v63, v63
    v_exp_f32 v64, v64
    v_exp_f32 v65, v65
    v_exp_f32 v66, v66
    v_exp_f32 v67, v67
    v_exp_f32 v68, v68
    v_exp_f32 v69, v69
    v_exp_f32 v70, v70
    v_exp_f32 v71, v71
    v_cvt_pk_bf16_f32 v56, v56, v57
    v_cvt_pk_bf16_f32 v57, v58, v59
    v_cvt_pk_bf16_f32 v58, v60, v61
    v_cvt_pk_bf16_f32 v59, v62, v63
    v_cvt_pk_bf16_f32 v60, v64, v65
    v_cvt_pk_bf16_f32 v61, v66, v67
    v_cvt_pk_bf16_f32 v62, v68, v69
    v_cvt_pk_bf16_f32 v63, v70, v71
    v_pk_add_f32 v[72:73], v[72:73], v[12:13] op_sel_hi:[1,0] neg_lo:[0,1] neg_hi:[0,1]
    v_pk_add_f32 v[74:75], v[74:75], v[12:13] op_sel_hi:[1,0] neg_lo:[0,1] neg_hi:[0,1]
    v_pk_add_f32 v[76:77], v[76:77], v[12:13] op_sel_hi:[1,0] neg_lo:[0,1] neg_hi:[0,1]
    v_pk_add_f32 v[78:79], v[78:79], v[12:13] op_sel_hi:[1,0] neg_lo:[0,1] neg_hi:[0,1]
    v_pk_add_f32 v[80:81], v[80:81], v[12:13] op_sel_hi:[1,0] neg_lo:[0,1] neg_hi:[0,1]
    v_pk_add_f32 v[82:83], v[82:83], v[12:13] op_sel_hi:[1,0] neg_lo:[0,1] neg_hi:[0,1]
    v_pk_add_f32 v[84:85], v[84:85], v[12:13] op_sel_hi:[1,0] neg_lo:[0,1] neg_hi:[0,1]
    v_pk_add_f32 v[86:87], v[86:87], v[12:13] op_sel_hi:[1,0] neg_lo:[0,1] neg_hi:[0,1]
    v_exp_f32 v72, v72
    v_exp_f32 v73, v73
    v_exp_f32 v74, v74
    v_exp_f32 v75, v75
    v_exp_f32 v76, v76
    v_exp_f32 v77, v77
    v_exp_f32 v78, v78
    v_exp_f32 v79, v79
    v_exp_f32 v80, v80
    v_exp_f32 v81, v81
    v_exp_f32 v82, v82
    v_exp_f32 v83, v83
    v_exp_f32 v84, v84
    v_exp_f32 v85, v85
    v_exp_f32 v86, v86
    v_exp_f32 v87, v87
    v_cvt_pk_bf16_f32 v64, v72, v73
    v_cvt_pk_bf16_f32 v65, v74, v75
    v_cvt_pk_bf16_f32 v66, v76, v77
    v_cvt_pk_bf16_f32 v67, v78, v79
    v_cvt_pk_bf16_f32 v68, v80, v81
    v_cvt_pk_bf16_f32 v69, v82, v83
    v_cvt_pk_bf16_f32 v70, v84, v85
    v_cvt_pk_bf16_f32 v71, v86, v87
    s_waitcnt lgkmcnt(2)
    s_nop 0
    v_mfma_f32_32x32x16_bf16 v[72:87], v[24:27], v[56:59], 0
    v_mfma_f32_32x32x16_bf16 v[72:87], v[28:31], v[60:63], v[72:87]
    ds_read_b128 v[24:27], v10 offset:4032
    ds_read_b128 v[28:31], v10 offset:4704
    s_waitcnt lgkmcnt(2)
    v_mfma_f32_32x32x16_bf16 v[72:87], v[32:35], v[64:67], v[72:87]
    v_mfma_f32_32x32x16_bf16 v[72:87], v[36:39], v[68:71], v[72:87]
    ds_read_b128 v[32:35], v10 offset:5376
    ds_read_b128 v[36:39], v10 offset:6048
    v_pk_add_f32 v[88:89], v[88:89], v[12:13] op_sel_hi:[1,0] neg_lo:[0,1] neg_hi:[0,1]
    v_pk_add_f32 v[90:91], v[90:91], v[12:13] op_sel_hi:[1,0] neg_lo:[0,1] neg_hi:[0,1]
    v_pk_add_f32 v[92:93], v[92:93], v[12:13] op_sel_hi:[1,0] neg_lo:[0,1] neg_hi:[0,1]
    v_pk_add_f32 v[94:95], v[94:95], v[12:13] op_sel_hi:[1,0] neg_lo:[0,1] neg_hi:[0,1]
    v_pk_add_f32 v[96:97], v[96:97], v[12:13] op_sel_hi:[1,0] neg_lo:[0,1] neg_hi:[0,1]
    v_pk_add_f32 v[98:99], v[98:99], v[12:13] op_sel_hi:[1,0] neg_lo:[0,1] neg_hi:[0,1]
    v_pk_add_f32 v[100:101], v[100:101], v[12:13] op_sel_hi:[1,0] neg_lo:[0,1] neg_hi:[0,1]
    v_pk_add_f32 v[102:103], v[102:103], v[12:13] op_sel_hi:[1,0] neg_lo:[0,1] neg_hi:[0,1]
    v_exp_f32 v88, v88
    v_exp_f32 v89, v89
    v_exp_f32 v90, v90
    v_exp_f32 v91, v91
    v_exp_f32 v92, v92
    v_exp_f32 v93, v93
    v_exp_f32 v94, v94
    v_exp_f32 v95, v95
    v_exp_f32 v96, v96
    v_exp_f32 v97, v97
    v_exp_f32 v98, v98
    v_exp_f32 v99, v99
    v_exp_f32 v100, v100
    v_exp_f32 v101, v101
    v_exp_f32 v102, v102
    v_exp_f32 v103, v103
    v_cvt_pk_bf16_f32 v88, v88, v89
    v_cvt_pk_bf16_f32 v89, v90, v91
    v_cvt_pk_bf16_f32 v90, v92, v93
    v_cvt_pk_bf16_f32 v91, v94, v95
    v_cvt_pk_bf16_f32 v92, v96, v97
    v_cvt_pk_bf16_f32 v93, v98, v99
    v_cvt_pk_bf16_f32 v94, v100, v101
    v_cvt_pk_bf16_f32 v95, v102, v103
    s_waitcnt lgkmcnt(2)
    s_nop 0
    v_mfma_f32_32x32x16_bf16 v[72:87], v[24:27], v[88:91], v[72:87]
    v_mfma_f32_32x32x16_bf16 v[72:87], v[28:31], v[92:95], v[72:87]
    ds_read_b128 v[24:27], v10 offset:6720
    ds_read_b128 v[28:31], v10 offset:7392
    v_pk_add_f32 v[104:105], v[104:105], v[12:13] op_sel_hi:[1,0] neg_lo:[0,1] neg_hi:[0,1]
    v_pk_add_f32 v[106:107], v[106:107], v[12:13] op_sel_hi:[1,0] neg_lo:[0,1] neg_hi:[0,1]
    v_pk_add_f32 v[108:109], v[108:109], v[12:13] op_sel_hi:[1,0] neg_lo:[0,1] neg_hi:[0,1]
    v_pk_add_f32 v[110:111], v[110:111], v[12:13] op_sel_hi:[1,0] neg_lo:[0,1] neg_hi:[0,1]
    v_pk_add_f32 v[112:113], v[112:113], v[12:13] op_sel_hi:[1,0] neg_lo:[0,1] neg_hi:[0,1]
    v_pk_add_f32 v[114:115], v[114:115], v[12:13] op_sel_hi:[1,0] neg_lo:[0,1] neg_hi:[0,1]
    v_pk_add_f32 v[116:117], v[116:117], v[12:13] op_sel_hi:[1,0] neg_lo:[0,1] neg_hi:[0,1]
    v_pk_add_f32 v[118:119], v[118:119], v[12:13] op_sel_hi:[1,0] neg_lo:[0,1] neg_hi:[0,1]
    v_exp_f32 v104, v104
    v_exp_f32 v105, v105
    v_exp_f32 v106, v106
    v_exp_f32 v107, v107
    v_exp_f32 v108, v108
    v_exp_f32 v109, v109
    v_exp_f32 v110, v110
    v_exp_f32 v111, v111
    v_exp_f32 v112, v112
    v_exp_f32 v113, v113
    v_exp_f32 v114, v114
    v_exp_f32 v115, v115
    v_exp_f32 v116, v116
    v_exp_f32 v117, v117
    v_exp_f32 v118, v118
    v_exp_f32 v119, v119
    v_cvt_pk_bf16_f32 v104, v104, v105
    v_cvt_pk_bf16_f32 v105, v106, v107
    v_cvt_pk_bf16_f32 v106, v108, v109
    v_cvt_pk_bf16_f32 v107, v110, v111
    v_cvt_pk_bf16_f32 v108, v112, v113
    v_cvt_pk_bf16_f32 v109, v114, v115
    v_cvt_pk_bf16_f32 v110, v116, v117
    v_cvt_pk_bf16_f32 v111, v118, v119
    s_waitcnt lgkmcnt(2)
    s_nop 0
    v_mfma_f32_32x32x16_bf16 v[72:87], v[32:35], v[104:107], v[72:87]
    v_mfma_f32_32x32x16_bf16 v[72:87], v[36:39], v[108:111], v[72:87]
    ds_read_b128 v[32:35], v10 offset:8064
    ds_read_b128 v[36:39], v10 offset:8736
    v_pk_add_f32 v[120:121], v[120:121], v[12:13] op_sel_hi:[1,0] neg_lo:[0,1] neg_hi:[0,1]
    v_pk_add_f32 v[122:123], v[122:123], v[12:13] op_sel_hi:[1,0] neg_lo:[0,1] neg_hi:[0,1]
    v_pk_add_f32 v[124:125], v[124:125], v[12:13] op_sel_hi:[1,0] neg_lo:[0,1] neg_hi:[0,1]
    v_pk_add_f32 v[126:127], v[126:127], v[12:13] op_sel_hi:[1,0] neg_lo:[0,1] neg_hi:[0,1]
    v_pk_add_f32 v[128:129], v[128:129], v[12:13] op_sel_hi:[1,0] neg_lo:[0,1] neg_hi:[0,1]
    v_pk_add_f32 v[130:131], v[130:131], v[12:13] op_sel_hi:[1,0] neg_lo:[0,1] neg_hi:[0,1]
    v_pk_add_f32 v[132:133], v[132:133], v[12:13] op_sel_hi:[1,0] neg_lo:[0,1] neg_hi:[0,1]
    v_pk_add_f32 v[134:135], v[134:135], v[12:13] op_sel_hi:[1,0] neg_lo:[0,1] neg_hi:[0,1]
    v_exp_f32 v120, v120
    v_exp_f32 v121, v121
    v_exp_f32 v122, v122
    v_exp_f32 v123, v123
    v_exp_f32 v124, v124
    v_exp_f32 v125, v125
    v_exp_f32 v126, v126
    v_exp_f32 v127, v127
    v_exp_f32 v128, v128
    v_exp_f32 v129, v129
    v_exp_f32 v130, v130
    v_exp_f32 v131, v131
    v_exp_f32 v132, v132
    v_exp_f32 v133, v133
    v_exp_f32 v134, v134
    v_exp_f32 v135, v135
    v_cvt_pk_bf16_f32 v120, v120, v121
    v_cvt_pk_bf16_f32 v121, v122, v123
    v_cvt_pk_bf16_f32 v122, v124, v125
    v_cvt_pk_bf16_f32 v123, v126, v127
    v_cvt_pk_bf16_f32 v124, v128, v129
    v_cvt_pk_bf16_f32 v125, v130, v131
    v_cvt_pk_bf16_f32 v126, v132, v133
    v_cvt_pk_bf16_f32 v127, v134, v135
    s_waitcnt lgkmcnt(2)
    s_nop 0
    v_mfma_f32_32x32x16_bf16 v[72:87], v[24:27], v[120:123], v[72:87]
    v_mfma_f32_32x32x16_bf16 v[72:87], v[28:31], v[124:127], v[72:87]
    ds_read_b128 v[24:27], v10 offset:9408
    ds_read_b128 v[28:31], v10 offset:10080
    v_pk_add_f32 v[136:137], v[136:137], v[12:13] op_sel_hi:[1,0] neg_lo:[0,1] neg_hi:[0,1]
    v_pk_add_f32 v[138:139], v[138:139], v[12:13] op_sel_hi:[1,0] neg_lo:[0,1] neg_hi:[0,1]
    v_pk_add_f32 v[140:141], v[140:141], v[12:13] op_sel_hi:[1,0] neg_lo:[0,1] neg_hi:[0,1]
    v_pk_add_f32 v[142:143], v[142:143], v[12:13] op_sel_hi:[1,0] neg_lo:[0,1] neg_hi:[0,1]
    v_pk_add_f32 v[144:145], v[144:145], v[12:13] op_sel_hi:[1,0] neg_lo:[0,1] neg_hi:[0,1]
    v_pk_add_f32 v[146:147], v[146:147], v[12:13] op_sel_hi:[1,0] neg_lo:[0,1] neg_hi:[0,1]
    v_pk_add_f32 v[148:149], v[148:149], v[12:13] op_sel_hi:[1,0] neg_lo:[0,1] neg_hi:[0,1]
    v_pk_add_f32 v[150:151], v[150:151], v[12:13] op_sel_hi:[1,0] neg_lo:[0,1] neg_hi:[0,1]
    v_exp_f32 v136, v136
    v_exp_f32 v137, v137
    v_exp_f32 v138, v138
    v_exp_f32 v139, v139
    v_exp_f32 v140, v140
    v_exp_f32 v141, v141
    v_exp_f32 v142, v142
    v_exp_f32 v143, v143
    v_exp_f32 v144, v144
    v_exp_f32 v145, v145
    v_exp_f32 v146, v146
    v_exp_f32 v147, v147
    v_exp_f32 v148, v148
    v_exp_f32 v149, v149
    v_exp_f32 v150, v150
    v_exp_f32 v151, v151
    v_cvt_pk_bf16_f32 v136, v136, v137
    v_cvt_pk_bf16_f32 v137, v138, v139
    v_cvt_pk_bf16_f32 v138, v140, v141
    v_cvt_pk_bf16_f32 v139, v142, v143
    v_cvt_pk_bf16_f32 v140, v144, v145
    v_cvt_pk_bf16_f32 v141, v146, v147
    v_cvt_pk_bf16_f32 v142, v148, v149
    v_cvt_pk_bf16_f32 v143, v150, v151
    s_waitcnt lgkmcnt(2)
    s_nop 0
    v_mfma_f32_32x32x16_bf16 v[72:87], v[32:35], v[136:139], v[72:87]
    v_mfma_f32_32x32x16_bf16 v[72:87], v[36:39], v[140:143], v[72:87]
    ds_read_b128 v[32:35], v10 offset:0
    ds_read_b128 v[36:39], v10 offset:672
    v_pk_add_f32 v[152:153], v[152:153], v[12:13] op_sel_hi:[1,0] neg_lo:[0,1] neg_hi:[0,1]
    v_pk_add_f32 v[154:155], v[154:155], v[12:13] op_sel_hi:[1,0] neg_lo:[0,1] neg_hi:[0,1]
    v_pk_add_f32 v[156:157], v[156:157], v[12:13] op_sel_hi:[1,0] neg_lo:[0,1] neg_hi:[0,1]
    v_pk_add_f32 v[158:159], v[158:159], v[12:13] op_sel_hi:[1,0] neg_lo:[0,1] neg_hi:[0,1]
    v_pk_add_f32 v[160:161], v[160:161], v[12:13] op_sel_hi:[1,0] neg_lo:[0,1] neg_hi:[0,1]
    v_pk_add_f32 v[162:163], v[162:163], v[12:13] op_sel_hi:[1,0] neg_lo:[0,1] neg_hi:[0,1]
    v_pk_add_f32 v[164:165], v[164:165], v[12:13] op_sel_hi:[1,0] neg_lo:[0,1] neg_hi:[0,1]
    v_pk_add_f32 v[166:167], v[166:167], v[12:13] op_sel_hi:[1,0] neg_lo:[0,1] neg_hi:[0,1]
    v_exp_f32 v152, v152
    v_exp_f32 v153, v153
    v_exp_f32 v154, v154
    v_exp_f32 v155, v155
    v_exp_f32 v156, v156
    v_exp_f32 v157, v157
    v_exp_f32 v158, v158
    v_exp_f32 v159, v159
    v_exp_f32 v160, v160
    v_exp_f32 v161, v161
    v_exp_f32 v162, v162
    v_exp_f32 v163, v163
    v_exp_f32 v164, v164
    v_exp_f32 v165, v165
    v_exp_f32 v166, v166
    v_exp_f32 v167, v167
    v_cvt_pk_bf16_f32 v152, v152, v153
    v_cvt_pk_bf16_f32 v153, v154, v155
    v_cvt_pk_bf16_f32 v154, v156, v157
    v_cvt_pk_bf16_f32 v155, v158, v159
    v_cvt_pk_bf16_f32 v156, v160, v161
    v_cvt_pk_bf16_f32 v157, v162, v163
    v_cvt_pk_bf16_f32 v158, v164, v165
    v_cvt_pk_bf16_f32 v159, v166, v167
    s_waitcnt lgkmcnt(2)
    s_nop 0
    v_mfma_f32_32x32x16_bf16 v[72:87], v[24:27], v[152:155], v[72:87]
    v_mfma_f32_32x32x16_bf16 v[72:87], v[28:31], v[156:159], v[72:87]
    ds_read_b128 v[24:27], v10 offset:10752
    ds_read_b128 v[28:31], v10 offset:11424
    v_pk_add_f32 v[40:41], v[40:41], v[12:13] op_sel_hi:[1,0] neg_lo:[0,1] neg_hi:[0,1]
    v_pk_add_f32 v[42:43], v[42:43], v[12:13] op_sel_hi:[1,0] neg_lo:[0,1] neg_hi:[0,1]
    v_pk_add_f32 v[44:45], v[44:45], v[12:13] op_sel_hi:[1,0] neg_lo:[0,1] neg_hi:[0,1]
    v_pk_add_f32 v[46:47], v[46:47], v[12:13] op_sel_hi:[1,0] neg_lo:[0,1] neg_hi:[0,1]
    v_pk_add_f32 v[48:49], v[48:49], v[12:13] op_sel_hi:[1,0] neg_lo:[0,1] neg_hi:[0,1]
    v_pk_add_f32 v[50:51], v[50:51], v[12:13] op_sel_hi:[1,0] neg_lo:[0,1] neg_hi:[0,1]
    v_pk_add_f32 v[52:53], v[52:53], v[12:13] op_sel_hi:[1,0] neg_lo:[0,1] neg_hi:[0,1]
    v_pk_add_f32 v[54:55], v[54:55], v[12:13] op_sel_hi:[1,0] neg_lo:[0,1] neg_hi:[0,1]
    v_exp_f32 v40, v40
    v_exp_f32 v41, v41
    v_exp_f32 v42, v42
    v_exp_f32 v43, v43
    v_exp_f32 v44, v44
    v_exp_f32 v45, v45
    v_exp_f32 v46, v46
    v_exp_f32 v47, v47
    v_exp_f32 v48, v48
    v_exp_f32 v49, v49
    v_exp_f32 v50, v50
    v_exp_f32 v51, v51
    v_exp_f32 v52, v52
    v_exp_f32 v53, v53
    v_exp_f32 v54, v54
    v_exp_f32 v55, v55
    v_cndmask_b32 v88, 0, v40, s[48:49]
    v_cndmask_b32 v89, 0, v41, s[50:51]
    v_cndmask_b32 v90, 0, v42, s[52:53]
    v_cndmask_b32 v91, 0, v43, s[54:55]
    v_cndmask_b32 v92, 0, v44, s[56:57]
    v_cndmask_b32 v93, 0, v45, s[58:59]
    v_cndmask_b32 v94, 0, v46, s[60:61]
    v_cndmask_b32 v95, 0, v47, s[62:63]
    v_cndmask_b32 v96, 0, v48, s[64:65]
    v_cndmask_b32 v97, 0, v49, s[66:67]
    v_cndmask_b32 v98, 0, v50, s[68:69]
    v_cndmask_b32 v99, 0, v51, s[70:71]
    v_cndmask_b32 v100, 0, v52, s[72:73]
    v_cndmask_b32 v101, 0, v53, s[74:75]
    v_cndmask_b32 v102, 0, v54, s[76:77]
    v_cndmask_b32 v103, 0, v55, s[78:79]
    v_cvt_pk_bf16_f32 v40, v40, v41
    v_cvt_pk_bf16_f32 v41, v42, v43
    v_cvt_pk_bf16_f32 v42, v44, v45
    v_cvt_pk_bf16_f32 v43, v46, v47
    v_cvt_pk_bf16_f32 v44, v48, v49
    v_cvt_pk_bf16_f32 v45, v50, v51
    v_cvt_pk_bf16_f32 v46, v52, v53
    v_cvt_pk_bf16_f32 v47, v54, v55
    v_cvt_pk_bf16_f32 v88, v88, v89
    v_cvt_pk_bf16_f32 v89, v90, v91
    v_cvt_pk_bf16_f32 v90, v92, v93
    v_cvt_pk_bf16_f32 v91, v94, v95
    v_cvt_pk_bf16_f32 v92, v96, v97
    v_cvt_pk_bf16_f32 v93, v98, v99
    v_cvt_pk_bf16_f32 v94, v100, v101
    v_cvt_pk_bf16_f32 v95, v102, v103
    v_xor_b32 v40, v40, v88
    v_xor_b32 v41, v41, v89
    v_xor_b32 v42, v42, v90
    v_xor_b32 v43, v43, v91
    v_xor_b32 v44, v44, v92
    v_xor_b32 v45, v45, v93
    v_xor_b32 v46, v46, v94
    v_xor_b32 v47, v47, v95
    s_waitcnt lgkmcnt(0)
    s_nop 0
    v_mfma_f32_32x32x16_bf16 v[72:87], v[24:27], v[88:91], v[72:87]
    v_mfma_f32_32x32x16_bf16 v[72:87], v[28:31], v[92:95], v[72:87]
    v_mfma_f32_32x32x16_bf16 v[72:87], v[32:35], v[40:43], v[72:87]
    v_mfma_f32_32x32x16_bf16 v[72:87], v[36:39], v[44:47], v[72:87]
    s_nop 11
    s_branch .bc_norm
.section .rodata,"a"
.p2align 6
.amdhsa_kernel gated_mix__sliding_block__moe_arch_mod__prompt_kernel
  .amdhsa_next_free_vgpr 168
  .amdhsa_next_free_sgpr 102
  .amdhsa_accum_offset 168
  .amdhsa_group_segment_fixed_size 0
  .amdhsa_kernarg_size 96
  .amdhsa_user_sgpr_count 2
  .amdhsa_user_sgpr_kernarg_segment_ptr 1
  .amdhsa_system_sgpr_workgroup_id_x 1
.end_amdhsa_kernel
.text
.code_end:
```
